```python
import torch

def _softmax(x, axis=-1):
    return torch.softmax(x, dim=axis)

def _gelu(x):
    return torch.nn.functional.gelu(x, approximate='tanh')

def _silu(x):
    return torch.nn.functional.silu(x)

def _sigmoid(x):
    return torch.sigmoid(x)

def _layernorm(x, axis=-1, eps=1e-05):
    m = x.mean(dim=axis, keepdim=True)
    v = x.var(dim=axis, keepdim=True, unbiased=False)
    return (x - m) / torch.sqrt(v + eps)

def _scatter_add(tgt, idx, src, axis=0):
    return tgt.clone().index_add_(axis, idx, src)

def _segment_sum(src, seg, n):
    out = torch.zeros((n,) + src.shape[1:], dtype=src.dtype)
    return out.index_add_(0, seg, src)

def _pad(x, pw):
    flat = tuple((v for pair in reversed(pw) for v in pair))
    return torch.nn.functional.pad(x, flat)
kernel_name = 'recurrent_scan__mha_block_cached__mixer_gmlp__prompt'

def setup_inputs():

    _w = lambda a: (lambda t: t.to(torch.bfloat16) if t.is_floating_point() else t)(torch.as_tensor(a))

    def _A_setup():
        B, Sq, D = (1, 2048, 448)
        H, Sk, Dh = (16, 2048, 256)
        return {'x': _w((lambda *s: torch.randn(*s, dtype=torch.bfloat16) * 0.05)(B, Sq, D)), 'k_cache': _w((lambda *s: torch.randn(*s, dtype=torch.bfloat16) * 0.8)(B, H, Sk, Dh)), 'v_cache': _w((lambda *s: torch.randn(*s, dtype=torch.bfloat16) * 0.2)(B, H, Sk, Dh)), 'wq': _w((lambda *s: torch.randn(*s, dtype=torch.bfloat16) * 0.8)(D, H * Dh) * D ** (-0.5)), 'wo': _w((lambda *s: torch.randn(*s, dtype=torch.bfloat16) * 0.2)(H * Dh, D) * (H * Dh) ** (-0.5))}
    _A_in = _A_setup()

    def _B_setup():
        B, S, D, F = (1, 2048, 448, 1792)
        Fh = F // 2
        return {'x': _w((lambda *s: torch.randn(*s, dtype=torch.bfloat16) * 0.05)(B, S, D)), 'w_in': _w((lambda *s: torch.randn(*s, dtype=torch.bfloat16) * 0.4)(D, 2 * Fh)), 'w_sp': _w(0.01 * (lambda *s: torch.randn(*s, dtype=torch.bfloat16) * 0.4)(S, S)), 'b_sp': _w(1.0 + 0.01 * (lambda *s: torch.randn(*s, dtype=torch.bfloat16) * 0.1)(S)), 'w_out': _w((lambda *s: torch.randn(*s, dtype=torch.bfloat16) * 0.1)(Fh, D))}
    _B_in = _B_setup()
    return {'A_x': _A_in['x'], 'A_k_cache': _A_in['k_cache'], 'A_v_cache': _A_in['v_cache'], 'A_wq': _A_in['wq'], 'A_wo': _A_in['wo'], 'B_x': _B_in['x'], 'B_w_in': _B_in['w_in'], 'B_w_sp': _B_in['w_sp'], 'B_b_sp': _B_in['b_sp'], 'B_w_out': _B_in['w_out']}

def reference(A_x, A_k_cache, A_v_cache, A_wq, A_wo, B_x, B_w_in, B_w_sp, B_b_sp, B_w_out):

    def _A_ref(x, k_cache, v_cache, wq, wo):
        B, Sq, D = x.shape
        H, Dh = (16, 256)
        q = (lambda x, *d: x.permute(*d))((x @ wq).reshape(B, Sq, H, Dh), 0, 2, 1, 3)
        scores = torch.einsum('bhqd,bhkd->bhqk', q, k_cache) * Dh ** (-0.5)
        p = _softmax(scores, axis=-1)
        o = torch.einsum('bhqk,bhkd->bhqd', p, v_cache)
        return (lambda x, *d: x.permute(*d))(o, 0, 2, 1, 3).reshape(B, Sq, H * Dh) @ wo

    def _B_ref(x, w_in, w_sp, b_sp, w_out):
        B, S, D = x.shape
        F = w_in.shape[-1]
        Fh = F // 2
        z = _gelu(torch.einsum('bsd,df->bsf', x, w_in))
        z1 = z[..., :Fh].clone()
        z2 = _layernorm(z[..., Fh:], axis=-1)
        g = torch.einsum('ts,bsf->btf', w_sp, z2) + b_sp[None, :, None]
        return torch.einsum('bsf,fd->bsd', z1 * g, w_out)
    x = A_x
    xn = _layernorm(x, axis=-1)
    s = _A_ref(xn, A_k_cache, A_v_cache, A_wq, A_wo)
    g = _silu(_B_ref(xn, B_w_in, B_w_sp, B_b_sp, B_w_out))
    return x + s * g
```

```asm
; @launch kernel=ln_kernel grid=(512,1,1) block=(256,1,1) lds=0
; @launch kernel=front_kernel grid=(480,1,1) block=(256,1,1) lds=163840
; @launch kernel=ln2_kernel grid=(512,1,1) block=(256,1,1) lds=0
; @launch kernel=g2_kernel grid=(224,1,1) block=(512,1,1) lds=147456
; @launch kernel=fin_kernel grid=(224,1,1) block=(512,1,1) lds=131072
.amdgcn_target "amdgcn-amd-amdhsa--gfx950"
.text
.globl ln_kernel
.p2align 8
.type ln_kernel,@function
ln_kernel:
    s_cmp_ge_u32 s2, 512
    s_cbranch_scc1 L_ln_done
    s_load_dwordx2 s[4:5], s[0:1], 0
    s_load_dwordx2 s[6:7], s[0:1], 96
    v_lshrrev_b32 v1, 6, v0
    v_and_b32 v2, 63, v0
    s_lshl_b32 s3, s2, 2
    v_add_u32 v1, s3, v1
    v_mul_u32_u24 v3, 896, v1
    v_lshl_add_u32 v3, v2, 4, v3
    v_cmp_gt_u32 vcc, 56, v2
    v_mov_b32 v4, 0x7ffffff0
    s_nop 1
    v_cndmask_b32 v3, v4, v3, vcc
    s_waitcnt lgkmcnt(0)
    s_mov_b32 s8, s4
    s_mov_b32 s9, s5
    s_mov_b32 s10, 1835008
    s_mov_b32 s11, 0x00020000
    s_add_u32 s12, s6, 0
    s_addc_u32 s13, s7, 0
    s_mov_b32 s14, 1835008
    s_mov_b32 s15, 0x00020000
    buffer_load_dwordx4 v[8:11], v3, s[8:11], 0 offen
    s_load_dwordx2 s[16:17], s[0:1], 24
    s_load_dwordx2 s[18:19], s[0:1], 48
    v_mov_b32 v31, 0x7fffff00
    s_waitcnt lgkmcnt(0)
    s_mov_b32 s20, s16
    s_mov_b32 s21, s17
    s_mov_b32 s22, 3670016
    s_mov_b32 s23, 0x00020000
    v_mul_u32_u24 v30, 14, v1
    v_add_u32 v30, v30, v2
    v_lshlrev_b32 v30, 7, v30
    v_cmp_gt_u32 s[24:25], 14, v2
    s_nop 1
    v_cndmask_b32 v30, v31, v30, s[24:25]
    buffer_load_dword v27, v30, s[20:23], 0 offen
    s_mov_b32 s20, s18
    s_mov_b32 s21, s19
    s_mov_b32 s22, 1605632
    s_mov_b32 s23, 0x00020000
    v_mul_u32_u24 v30, 7, v1
    v_add_u32 v30, v30, v2
    v_lshlrev_b32 v30, 7, v30
    v_cmp_gt_u32 s[24:25], 7, v2
    s_nop 1
    v_cndmask_b32 v30, v31, v30, s[24:25]
    buffer_load_dword v27, v30, s[20:23], 0 offen
    v_lshrrev_b32 v28, 5, v1
    v_mul_u32_u24 v28, 28672, v28
    v_lshrrev_b32 v29, 1, v2
    v_lshl_add_u32 v28, v29, 10, v28
    v_and_b32 v29, 1, v2
    v_lshl_add_u32 v28, v29, 9, v28
    v_and_b32 v29, 31, v1
    v_lshl_add_u32 v28, v29, 4, v28
    v_cndmask_b32 v28, v4, v28, vcc
    s_waitcnt vmcnt(2)
    v_lshlrev_b32 v16, 16, v8
    v_and_b32 v17, 0xffff0000, v8
    v_lshlrev_b32 v18, 16, v9
    v_and_b32 v19, 0xffff0000, v9
    v_lshlrev_b32 v20, 16, v10
    v_and_b32 v21, 0xffff0000, v10
    v_lshlrev_b32 v22, 16, v11
    v_and_b32 v23, 0xffff0000, v11
    v_add_f32 v5, v16, v17
    v_add_f32 v5, v5, v18
    v_add_f32 v5, v5, v19
    v_add_f32 v5, v5, v20
    v_add_f32 v5, v5, v21
    v_add_f32 v5, v5, v22
    v_add_f32 v5, v5, v23
    s_nop 1
    v_add_f32_dpp v5, v5, v5 row_shr:1 row_mask:0xf bank_mask:0xf bound_ctrl:0
    s_nop 1
    v_add_f32_dpp v5, v5, v5 row_shr:2 row_mask:0xf bank_mask:0xf bound_ctrl:0
    s_nop 1
    v_add_f32_dpp v5, v5, v5 row_shr:4 row_mask:0xf bank_mask:0xf bound_ctrl:0
    s_nop 1
    v_add_f32_dpp v5, v5, v5 row_shr:8 row_mask:0xf bank_mask:0xf bound_ctrl:0
    s_nop 1
    v_add_f32_dpp v5, v5, v5 row_bcast:15 row_mask:0xa bank_mask:0xf
    s_nop 1
    v_add_f32_dpp v5, v5, v5 row_bcast:31 row_mask:0xc bank_mask:0xf
    s_nop 1
    v_readlane_b32 s26, v5, 63
    s_nop 1
    v_mov_b32 v5, s26
    v_mul_f32 v5, 0x3b124925, v5
    v_mov_b32 v7, 0
    v_sub_f32 v24, v16, v5
    v_fmac_f32 v7, v24, v24
    v_sub_f32 v24, v17, v5
    v_fmac_f32 v7, v24, v24
    v_sub_f32 v24, v18, v5
    v_fmac_f32 v7, v24, v24
    v_sub_f32 v24, v19, v5
    v_fmac_f32 v7, v24, v24
    v_sub_f32 v24, v20, v5
    v_fmac_f32 v7, v24, v24
    v_sub_f32 v24, v21, v5
    v_fmac_f32 v7, v24, v24
    v_sub_f32 v24, v22, v5
    v_fmac_f32 v7, v24, v24
    v_sub_f32 v24, v23, v5
    v_fmac_f32 v7, v24, v24
    v_cndmask_b32 v7, 0, v7, vcc
    s_nop 1
    v_add_f32_dpp v7, v7, v7 row_shr:1 row_mask:0xf bank_mask:0xf bound_ctrl:0
    s_nop 1
    v_add_f32_dpp v7, v7, v7 row_shr:2 row_mask:0xf bank_mask:0xf bound_ctrl:0
    s_nop 1
    v_add_f32_dpp v7, v7, v7 row_shr:4 row_mask:0xf bank_mask:0xf bound_ctrl:0
    s_nop 1
    v_add_f32_dpp v7, v7, v7 row_shr:8 row_mask:0xf bank_mask:0xf bound_ctrl:0
    s_nop 1
    v_add_f32_dpp v7, v7, v7 row_bcast:15 row_mask:0xa bank_mask:0xf
    s_nop 1
    v_add_f32_dpp v7, v7, v7 row_bcast:31 row_mask:0xc bank_mask:0xf
    s_nop 1
    v_readlane_b32 s26, v7, 63
    s_nop 1
    v_mov_b32 v7, s26
    v_mul_f32 v7, 0x3b124925, v7
    v_cvt_pk_bf16_f32 v5, v5, v5
    v_and_b32 v5, 0xffff0000, v5
    v_cvt_pk_bf16_f32 v7, v7, v7
    v_and_b32 v7, 0xffff0000, v7
    v_add_f32 v7, 0x3727c5ac, v7
    v_cvt_pk_bf16_f32 v7, v7, v7
    v_and_b32 v7, 0xffff0000, v7
    v_sqrt_f32 v7, v7
    s_nop 0
    v_cvt_pk_bf16_f32 v7, v7, v7
    v_and_b32 v7, 0xffff0000, v7
    v_rcp_f32 v7, v7
    s_nop 0
    v_sub_f32 v24, v16, v5
    v_sub_f32 v25, v17, v5
    v_cvt_pk_bf16_f32 v26, v24, v25
    v_lshlrev_b32 v24, 16, v26
    v_and_b32 v25, 0xffff0000, v26
    v_mul_f32 v24, v24, v7
    v_mul_f32 v25, v25, v7
    v_cvt_pk_bf16_f32 v8, v24, v25
    v_sub_f32 v24, v18, v5
    v_sub_f32 v25, v19, v5
    v_cvt_pk_bf16_f32 v26, v24, v25
    v_lshlrev_b32 v24, 16, v26
    v_and_b32 v25, 0xffff0000, v26
    v_mul_f32 v24, v24, v7
    v_mul_f32 v25, v25, v7
    v_cvt_pk_bf16_f32 v9, v24, v25
    v_sub_f32 v24, v20, v5
    v_sub_f32 v25, v21, v5
    v_cvt_pk_bf16_f32 v26, v24, v25
    v_lshlrev_b32 v24, 16, v26
    v_and_b32 v25, 0xffff0000, v26
    v_mul_f32 v24, v24, v7
    v_mul_f32 v25, v25, v7
    v_cvt_pk_bf16_f32 v10, v24, v25
    v_sub_f32 v24, v22, v5
    v_sub_f32 v25, v23, v5
    v_cvt_pk_bf16_f32 v26, v24, v25
    v_lshlrev_b32 v24, 16, v26
    v_and_b32 v25, 0xffff0000, v26
    v_mul_f32 v24, v24, v7
    v_mul_f32 v25, v25, v7
    v_cvt_pk_bf16_f32 v11, v24, v25
    buffer_store_dwordx4 v[8:11], v28, s[12:15], 0 offen
L_ln_done:
    s_endpgm
.globl front_kernel
.p2align 8
.type front_kernel,@function
front_kernel:
    s_cmp_ge_u32 s2, 480
    s_cbranch_scc1 L_g1_done
    s_cmp_lt_u32 s2, 224
    s_cbranch_scc1 L_front_g1
    s_sub_u32 s2, s2, 224
    s_load_dwordx2 s[70:71], s[0:1], 88
    s_load_dwordx2 s[4:5], s[0:1], 8
    s_load_dwordx2 s[6:7], s[0:1], 16
    s_load_dwordx2 s[8:9], s[0:1], 24
    s_load_dwordx2 s[10:11], s[0:1], 96
    s_and_b32 s14, s2, 7
    s_lshr_b32 s15, s2, 3
    s_lshr_b32 s12, s15, 4
    s_lshl_b32 s14, s14, 1
    s_add_u32 s12, s12, s14
    s_and_b32 s13, s15, 15
    v_and_b32 v1, 63, v0
    v_and_b32 v2, 31, v0
    v_bfe_u32 v3, v0, 5, 1
    v_lshrrev_b32 v4, 6, v0
    s_nop 0
    v_readfirstlane_b32 s3, v4
    s_nop 3
    s_lshl_b32 s40, s3, 12
    s_add_u32 s42, s40, 0
    s_add_u32 s45, s40, 49152
    s_add_u32 s43, s40, 16384
    s_add_u32 s46, s40, 65536
    s_add_u32 s44, s40, 32768
    s_add_u32 s47, s40, 81920
    s_waitcnt lgkmcnt(0)
    s_lshl_b32 s14, s12, 20
    s_add_u32 s16, s4, s14
    s_addc_u32 s17, s5, 0
    s_mov_b32 s18, 1048576
    s_mov_b32 s19, 0x00020000
    s_add_u32 s20, s6, s14
    s_addc_u32 s21, s7, 0
    s_mov_b32 s22, 1048576
    s_mov_b32 s23, 0x00020000
    s_mov_b32 s24, s8
    s_mov_b32 s25, s9
    s_mov_b32 s26, 3670016
    s_mov_b32 s27, 0x00020000
    s_add_u32 s28, s10, 0
    s_addc_u32 s29, s11, 0
    s_mov_b32 s30, 1835008
    s_mov_b32 s31, 0x00020000
    s_add_u32 s32, s10, 2097152
    s_addc_u32 s33, s11, 0
    s_mov_b32 s34, 16777216
    s_mov_b32 s35, 0x00020000
    v_and_b32 v5, 15, v2
    v_lshlrev_b32 v6, 9, v2
    v_add_u32 v7, 0, v3
    v_xor_b32 v7, v7, v5
    v_lshl_add_u32 v8, v7, 4, v6
    v_add_u32 v7, 2, v3
    v_xor_b32 v7, v7, v5
    v_lshl_add_u32 v9, v7, 4, v6
    v_add_u32 v7, 4, v3
    v_xor_b32 v7, v7, v5
    v_lshl_add_u32 v10, v7, 4, v6
    v_add_u32 v7, 6, v3
    v_xor_b32 v7, v7, v5
    v_lshl_add_u32 v11, v7, 4, v6
    v_add_u32 v7, 8, v3
    v_xor_b32 v7, v7, v5
    v_lshl_add_u32 v12, v7, 4, v6
    v_add_u32 v7, 10, v3
    v_xor_b32 v7, v7, v5
    v_lshl_add_u32 v13, v7, 4, v6
    v_add_u32 v7, 12, v3
    v_xor_b32 v7, v7, v5
    v_lshl_add_u32 v14, v7, 4, v6
    v_add_u32 v7, 14, v3
    v_xor_b32 v7, v7, v5
    v_lshl_add_u32 v15, v7, 4, v6
    v_bfe_u32 v5, v1, 2, 2
    v_and_b32 v6, 3, v1
    v_bfe_u32 v7, v1, 4, 1
    v_lshlrev_b32 v46, 3, v6
    v_lshl_add_u32 v46, v7, 5, v46
    v_lshl_add_u32 v47, v3, 2, v5
    v_lshl_add_u32 v45, v3, 3, v5
    v_xor_b32 v7, 0, v5
    v_lshl_add_u32 v7, v7, 6, v46
    v_lshl_add_u32 v16, v47, 9, v7
    v_add_u32 v16, 49152, v16
    v_lshl_add_u32 v20, v45, 9, v7
    v_add_u32 v20, 49152, v20
    v_xor_b32 v7, 1, v5
    v_lshl_add_u32 v7, v7, 6, v46
    v_lshl_add_u32 v17, v47, 9, v7
    v_add_u32 v17, 49152, v17
    v_lshl_add_u32 v21, v45, 9, v7
    v_add_u32 v21, 49152, v21
    v_xor_b32 v7, 2, v5
    v_lshl_add_u32 v7, v7, 6, v46
    v_lshl_add_u32 v18, v47, 9, v7
    v_add_u32 v18, 49152, v18
    v_lshl_add_u32 v22, v45, 9, v7
    v_add_u32 v22, 49152, v22
    v_xor_b32 v7, 3, v5
    v_lshl_add_u32 v7, v7, 6, v46
    v_lshl_add_u32 v19, v47, 9, v7
    v_add_u32 v19, 49152, v19
    v_lshl_add_u32 v23, v45, 9, v7
    v_add_u32 v23, 49152, v23
    s_and_b32 s14, s3, 1
    s_lshl_b32 s14, s14, 3
    v_xor_b32 v5, s14, v2
    v_xor_b32 v5, v5, v3
    v_lshlrev_b32 v6, 9, v3
    v_add_u32 v6, s40, v6
    v_xor_b32 v7, 0, v5
    v_lshl_add_u32 v24, v7, 4, v6
    v_xor_b32 v7, 2, v5
    v_lshl_add_u32 v25, v7, 4, v6
    v_xor_b32 v7, 4, v5
    v_lshl_add_u32 v26, v7, 4, v6
    v_xor_b32 v7, 6, v5
    v_lshl_add_u32 v27, v7, 4, v6
    v_add_u32 v7, 0, v3
    v_lshlrev_b32 v7, 2, v7
    v_xor_b32 v7, v7, v2
    v_lshl_add_u32 v28, v7, 4, v6
    v_add_u32 v7, 2, v3
    v_lshlrev_b32 v7, 2, v7
    v_xor_b32 v7, v7, v2
    v_lshl_add_u32 v29, v7, 4, v6
    s_lshl_b32 s14, s3, 16
    v_lshlrev_b32 v6, 13, v3
    v_add_u32 v6, s14, v6
    v_add_u32 v7, 0, v3
    v_lshlrev_b32 v7, 2, v7
    v_xor_b32 v7, v7, v2
    v_lshl_add_u32 v30, v7, 4, v6
    v_add_u32 v30, 0, v30
    v_add_u32 v7, 2, v3
    v_lshlrev_b32 v7, 2, v7
    v_xor_b32 v7, v7, v2
    v_lshl_add_u32 v31, v7, 4, v6
    v_add_u32 v31, 16384, v31
    v_add_u32 v7, 0, v3
    v_lshlrev_b32 v7, 2, v7
    v_xor_b32 v7, v7, v2
    v_lshl_add_u32 v32, v7, 4, v6
    v_add_u32 v32, 32768, v32
    v_add_u32 v7, 2, v3
    v_lshlrev_b32 v7, 2, v7
    v_xor_b32 v7, v7, v2
    v_lshl_add_u32 v33, v7, 4, v6
    v_add_u32 v33, 49152, v33
    s_lshl_b32 s39, s12, 9
    s_mov_b32 s36, 0
    s_mov_b32 s37, 0
    s_lshl_b32 s14, s13, 2
    s_add_u32 s14, s14, s3
    s_mul_i32 s15, s14, 28672
    v_lshlrev_b32 v4, 4, v1
    s_add_u32 m0, s45, 0
    s_nop 0
    buffer_load_dwordx4 v30, s[24:27], s39 offen lds
    s_add_u32 m0, s45, 1024
    s_nop 0
    buffer_load_dwordx4 v31, s[24:27], s39 offen lds
    s_add_u32 m0, s45, 2048
    s_nop 0
    buffer_load_dwordx4 v32, s[24:27], s39 offen lds
    s_add_u32 m0, s45, 3072
    s_nop 0
    buffer_load_dwordx4 v33, s[24:27], s39 offen lds
    s_add_u32 s39, s39, 262144
    buffer_load_dwordx4 v[128:131], v4, s[28:31], s15 offen offset:0
    buffer_load_dwordx4 v[132:135], v4, s[28:31], s15 offen offset:1024
    s_add_u32 m0, s45, 16384
    s_nop 0
    buffer_load_dwordx4 v30, s[24:27], s39 offen lds
    s_add_u32 m0, s45, 17408
    s_nop 0
    buffer_load_dwordx4 v31, s[24:27], s39 offen lds
    s_add_u32 m0, s45, 18432
    s_nop 0
    buffer_load_dwordx4 v32, s[24:27], s39 offen lds
    s_add_u32 m0, s45, 19456
    s_nop 0
    buffer_load_dwordx4 v33, s[24:27], s39 offen lds
    s_add_u32 s39, s39, 262144
    buffer_load_dwordx4 v[136:139], v4, s[28:31], s15 offen offset:2048
    buffer_load_dwordx4 v[140:143], v4, s[28:31], s15 offen offset:3072
    s_add_u32 s15, s15, 4096
    s_add_u32 m0, s45, 32768
    s_nop 0
    buffer_load_dwordx4 v30, s[24:27], s39 offen lds
    s_add_u32 m0, s45, 33792
    s_nop 0
    buffer_load_dwordx4 v31, s[24:27], s39 offen lds
    s_add_u32 m0, s45, 34816
    s_nop 0
    buffer_load_dwordx4 v32, s[24:27], s39 offen lds
    s_add_u32 m0, s45, 35840
    s_nop 0
    buffer_load_dwordx4 v33, s[24:27], s39 offen lds
    s_add_u32 s39, s39, 262144
    buffer_load_dwordx4 v[144:147], v4, s[28:31], s15 offen offset:0
    buffer_load_dwordx4 v[148:151], v4, s[28:31], s15 offen offset:1024
    s_lshl_b32 s48, s14, 18
    s_lshl_b32 s14, s12, 14
    s_add_u32 s48, s48, s14
    v_add_u32 v56, 0x10000, v20
    v_add_u32 v57, 0x10000, v21
    v_add_u32 v58, 0x10000, v22
    v_add_u32 v59, 0x10000, v23
    s_waitcnt vmcnt(14)
    s_waitcnt lgkmcnt(0)
    s_barrier
    ds_read_b64_tr_b16 a[192:193], v20 offset:0
    ds_read_b64_tr_b16 a[194:195], v20 offset:2048
    ds_read_b64_tr_b16 a[196:197], v21 offset:0
    ds_read_b64_tr_b16 a[198:199], v21 offset:2048
    s_add_u32 m0, s45, 49152
    s_nop 0
    buffer_load_dwordx4 v30, s[24:27], s39 offen lds
    ds_read_b64_tr_b16 a[200:201], v22 offset:0
    ds_read_b64_tr_b16 a[202:203], v22 offset:2048
    ds_read_b64_tr_b16 a[204:205], v23 offset:0
    ds_read_b64_tr_b16 a[206:207], v23 offset:2048
    s_add_u32 m0, s45, 50176
    s_nop 0
    buffer_load_dwordx4 v31, s[24:27], s39 offen lds
    ds_read_b64_tr_b16 a[208:209], v20 offset:256
    ds_read_b64_tr_b16 a[210:211], v20 offset:2304
    ds_read_b64_tr_b16 a[212:213], v21 offset:256
    ds_read_b64_tr_b16 a[214:215], v21 offset:2304
    s_add_u32 m0, s45, 51200
    s_nop 0
    buffer_load_dwordx4 v32, s[24:27], s39 offen lds
    ds_read_b64_tr_b16 a[216:217], v22 offset:256
    ds_read_b64_tr_b16 a[218:219], v22 offset:2304
    ds_read_b64_tr_b16 a[220:221], v23 offset:256
    ds_read_b64_tr_b16 a[222:223], v23 offset:2304
    s_add_u32 m0, s45, 52224
    s_nop 0
    buffer_load_dwordx4 v33, s[24:27], s39 offen lds
    s_add_u32 s39, s39, 262144
    ds_read_b64_tr_b16 a[224:225], v20 offset:8192
    ds_read_b64_tr_b16 a[226:227], v20 offset:10240
    ds_read_b64_tr_b16 a[228:229], v21 offset:8192
    ds_read_b64_tr_b16 a[230:231], v21 offset:10240
    buffer_load_dwordx4 v[152:155], v4, s[28:31], s15 offen offset:2048
    ds_read_b64_tr_b16 a[232:233], v22 offset:8192
    ds_read_b64_tr_b16 a[234:235], v22 offset:10240
    ds_read_b64_tr_b16 a[236:237], v23 offset:8192
    ds_read_b64_tr_b16 a[238:239], v23 offset:10240
    buffer_load_dwordx4 v[156:159], v4, s[28:31], s15 offen offset:3072
    s_add_u32 s15, s15, 4096
    ds_read_b64_tr_b16 a[240:241], v20 offset:8448
    ds_read_b64_tr_b16 a[242:243], v20 offset:10496
    ds_read_b64_tr_b16 a[244:245], v21 offset:8448
    ds_read_b64_tr_b16 a[246:247], v21 offset:10496
    ds_read_b64_tr_b16 a[248:249], v22 offset:8448
    ds_read_b64_tr_b16 a[250:251], v22 offset:10496
    ds_read_b64_tr_b16 a[252:253], v23 offset:8448
    ds_read_b64_tr_b16 a[254:255], v23 offset:10496
    s_waitcnt vmcnt(18)
    s_waitcnt vmcnt(14)
    s_waitcnt lgkmcnt(0)
    s_barrier
    ds_read_b64_tr_b16 a[128:129], v20 offset:16384
    ds_read_b64_tr_b16 a[130:131], v20 offset:18432
    v_mfma_f32_32x32x16_bf16 a[0:15], a[192:195], v[128:131], 0
    ds_read_b64_tr_b16 a[132:133], v21 offset:16384
    ds_read_b64_tr_b16 a[134:135], v21 offset:18432
    v_mfma_f32_32x32x16_bf16 a[16:31], a[196:199], v[128:131], 0
    s_add_u32 m0, s45, 65536
    s_nop 0
    buffer_load_dwordx4 v30, s[24:27], s39 offen lds
    ds_read_b64_tr_b16 a[136:137], v22 offset:16384
    ds_read_b64_tr_b16 a[138:139], v22 offset:18432
    v_mfma_f32_32x32x16_bf16 a[32:47], a[200:203], v[128:131], 0
    ds_read_b64_tr_b16 a[140:141], v23 offset:16384
    ds_read_b64_tr_b16 a[142:143], v23 offset:18432
    v_mfma_f32_32x32x16_bf16 a[48:63], a[204:207], v[128:131], 0
    s_add_u32 m0, s45, 66560
    s_nop 0
    buffer_load_dwordx4 v31, s[24:27], s39 offen lds
    ds_read_b64_tr_b16 a[144:145], v20 offset:16640
    ds_read_b64_tr_b16 a[146:147], v20 offset:18688
    v_mfma_f32_32x32x16_bf16 a[64:79], a[208:211], v[128:131], 0
    ds_read_b64_tr_b16 a[148:149], v21 offset:16640
    ds_read_b64_tr_b16 a[150:151], v21 offset:18688
    v_mfma_f32_32x32x16_bf16 a[80:95], a[212:215], v[128:131], 0
    s_add_u32 m0, s45, 67584
    s_nop 0
    buffer_load_dwordx4 v32, s[24:27], s39 offen lds
    ds_read_b64_tr_b16 a[152:153], v22 offset:16640
    ds_read_b64_tr_b16 a[154:155], v22 offset:18688
    v_mfma_f32_32x32x16_bf16 a[96:111], a[216:219], v[128:131], 0
    ds_read_b64_tr_b16 a[156:157], v23 offset:16640
    ds_read_b64_tr_b16 a[158:159], v23 offset:18688
    v_mfma_f32_32x32x16_bf16 a[112:127], a[220:223], v[128:131], 0
    s_add_u32 m0, s45, 68608
    s_nop 0
    buffer_load_dwordx4 v33, s[24:27], s39 offen lds
    s_add_u32 s39, s39, 262144
    ds_read_b64_tr_b16 a[160:161], v20 offset:24576
    ds_read_b64_tr_b16 a[162:163], v20 offset:26624
    v_mfma_f32_32x32x16_bf16 a[0:15], a[224:227], v[132:135], a[0:15]
    ds_read_b64_tr_b16 a[164:165], v21 offset:24576
    ds_read_b64_tr_b16 a[166:167], v21 offset:26624
    v_mfma_f32_32x32x16_bf16 a[16:31], a[228:231], v[132:135], a[16:31]
    buffer_load_dwordx4 v[160:163], v4, s[28:31], s15 offen offset:0
    ds_read_b64_tr_b16 a[168:169], v22 offset:24576
    ds_read_b64_tr_b16 a[170:171], v22 offset:26624
    v_mfma_f32_32x32x16_bf16 a[32:47], a[232:235], v[132:135], a[32:47]
    ds_read_b64_tr_b16 a[172:173], v23 offset:24576
    ds_read_b64_tr_b16 a[174:175], v23 offset:26624
    v_mfma_f32_32x32x16_bf16 a[48:63], a[236:239], v[132:135], a[48:63]
    buffer_load_dwordx4 v[164:167], v4, s[28:31], s15 offen offset:1024
    ds_read_b64_tr_b16 a[176:177], v20 offset:24832
    ds_read_b64_tr_b16 a[178:179], v20 offset:26880
    v_mfma_f32_32x32x16_bf16 a[64:79], a[240:243], v[132:135], a[64:79]
    ds_read_b64_tr_b16 a[180:181], v21 offset:24832
    ds_read_b64_tr_b16 a[182:183], v21 offset:26880
    v_mfma_f32_32x32x16_bf16 a[80:95], a[244:247], v[132:135], a[80:95]
    ds_read_b64_tr_b16 a[184:185], v22 offset:24832
    ds_read_b64_tr_b16 a[186:187], v22 offset:26880
    v_mfma_f32_32x32x16_bf16 a[96:111], a[248:251], v[132:135], a[96:111]
    ds_read_b64_tr_b16 a[188:189], v23 offset:24832
    ds_read_b64_tr_b16 a[190:191], v23 offset:26880
    v_mfma_f32_32x32x16_bf16 a[112:127], a[252:255], v[132:135], a[112:127]
    s_waitcnt vmcnt(18)
    s_waitcnt vmcnt(14)
    s_waitcnt lgkmcnt(0)
    s_barrier
    ds_read_b64_tr_b16 a[192:193], v20 offset:32768
    ds_read_b64_tr_b16 a[194:195], v20 offset:34816
    v_mfma_f32_32x32x16_bf16 a[0:15], a[128:131], v[136:139], a[0:15]
    ds_read_b64_tr_b16 a[196:197], v21 offset:32768
    ds_read_b64_tr_b16 a[198:199], v21 offset:34816
    v_mfma_f32_32x32x16_bf16 a[16:31], a[132:135], v[136:139], a[16:31]
    s_add_u32 m0, s45, 81920
    s_nop 0
    buffer_load_dwordx4 v30, s[24:27], s39 offen lds
    ds_read_b64_tr_b16 a[200:201], v22 offset:32768
    ds_read_b64_tr_b16 a[202:203], v22 offset:34816
    v_mfma_f32_32x32x16_bf16 a[32:47], a[136:139], v[136:139], a[32:47]
    ds_read_b64_tr_b16 a[204:205], v23 offset:32768
    ds_read_b64_tr_b16 a[206:207], v23 offset:34816
    v_mfma_f32_32x32x16_bf16 a[48:63], a[140:143], v[136:139], a[48:63]
    s_add_u32 m0, s45, 82944
    s_nop 0
    buffer_load_dwordx4 v31, s[24:27], s39 offen lds
    ds_read_b64_tr_b16 a[208:209], v20 offset:33024
    ds_read_b64_tr_b16 a[210:211], v20 offset:35072
    v_mfma_f32_32x32x16_bf16 a[64:79], a[144:147], v[136:139], a[64:79]
    ds_read_b64_tr_b16 a[212:213], v21 offset:33024
    ds_read_b64_tr_b16 a[214:215], v21 offset:35072
    v_mfma_f32_32x32x16_bf16 a[80:95], a[148:151], v[136:139], a[80:95]
    s_add_u32 m0, s45, 83968
    s_nop 0
    buffer_load_dwordx4 v32, s[24:27], s39 offen lds
    ds_read_b64_tr_b16 a[216:217], v22 offset:33024
    ds_read_b64_tr_b16 a[218:219], v22 offset:35072
    v_mfma_f32_32x32x16_bf16 a[96:111], a[152:155], v[136:139], a[96:111]
    ds_read_b64_tr_b16 a[220:221], v23 offset:33024
    ds_read_b64_tr_b16 a[222:223], v23 offset:35072
    v_mfma_f32_32x32x16_bf16 a[112:127], a[156:159], v[136:139], a[112:127]
    s_add_u32 m0, s45, 84992
    s_nop 0
    buffer_load_dwordx4 v33, s[24:27], s39 offen lds
    s_add_u32 s39, s39, 262144
    ds_read_b64_tr_b16 a[224:225], v20 offset:40960
    ds_read_b64_tr_b16 a[226:227], v20 offset:43008
    v_mfma_f32_32x32x16_bf16 a[0:15], a[160:163], v[140:143], a[0:15]
    ds_read_b64_tr_b16 a[228:229], v21 offset:40960
    ds_read_b64_tr_b16 a[230:231], v21 offset:43008
    v_mfma_f32_32x32x16_bf16 a[16:31], a[164:167], v[140:143], a[16:31]
    buffer_load_dwordx4 v[168:171], v4, s[28:31], s15 offen offset:2048
    ds_read_b64_tr_b16 a[232:233], v22 offset:40960
    ds_read_b64_tr_b16 a[234:235], v22 offset:43008
    v_mfma_f32_32x32x16_bf16 a[32:47], a[168:171], v[140:143], a[32:47]
    ds_read_b64_tr_b16 a[236:237], v23 offset:40960
    ds_read_b64_tr_b16 a[238:239], v23 offset:43008
    v_mfma_f32_32x32x16_bf16 a[48:63], a[172:175], v[140:143], a[48:63]
    buffer_load_dwordx4 v[172:175], v4, s[28:31], s15 offen offset:3072
    s_add_u32 s15, s15, 4096
    ds_read_b64_tr_b16 a[240:241], v20 offset:41216
    ds_read_b64_tr_b16 a[242:243], v20 offset:43264
    v_mfma_f32_32x32x16_bf16 a[64:79], a[176:179], v[140:143], a[64:79]
    ds_read_b64_tr_b16 a[244:245], v21 offset:41216
    ds_read_b64_tr_b16 a[246:247], v21 offset:43264
    v_mfma_f32_32x32x16_bf16 a[80:95], a[180:183], v[140:143], a[80:95]
    s_mov_b32 m0, s42
    s_nop 0
    buffer_load_dwordx4 v24, s[16:19], s36 offen offset:0 lds
    ds_read_b64_tr_b16 a[248:249], v22 offset:41216
    ds_read_b64_tr_b16 a[250:251], v22 offset:43264
    v_mfma_f32_32x32x16_bf16 a[96:111], a[184:187], v[140:143], a[96:111]
    ds_read_b64_tr_b16 a[252:253], v23 offset:41216
    ds_read_b64_tr_b16 a[254:255], v23 offset:43264
    v_mfma_f32_32x32x16_bf16 a[112:127], a[188:191], v[140:143], a[112:127]
    s_mov_b32 m0, s42
    s_nop 0
    buffer_load_dwordx4 v25, s[16:19], s36 offen offset:1024 lds
    s_waitcnt vmcnt(20)
    s_waitcnt vmcnt(16)
    s_waitcnt lgkmcnt(0)
    s_barrier
    ds_read_b64_tr_b16 a[128:129], v20 offset:49152
    ds_read_b64_tr_b16 a[130:131], v20 offset:51200
    v_mfma_f32_32x32x16_bf16 a[0:15], a[192:195], v[144:147], a[0:15]
    ds_read_b64_tr_b16 a[132:133], v21 offset:49152
    ds_read_b64_tr_b16 a[134:135], v21 offset:51200
    v_mfma_f32_32x32x16_bf16 a[16:31], a[196:199], v[144:147], a[16:31]
    s_add_u32 m0, s45, 98304
    s_nop 0
    buffer_load_dwordx4 v30, s[24:27], s39 offen lds
    ds_read_b64_tr_b16 a[136:137], v22 offset:49152
    ds_read_b64_tr_b16 a[138:139], v22 offset:51200
    v_mfma_f32_32x32x16_bf16 a[32:47], a[200:203], v[144:147], a[32:47]
    ds_read_b64_tr_b16 a[140:141], v23 offset:49152
    ds_read_b64_tr_b16 a[142:143], v23 offset:51200
    v_mfma_f32_32x32x16_bf16 a[48:63], a[204:207], v[144:147], a[48:63]
    s_add_u32 m0, s45, 99328
    s_nop 0
    buffer_load_dwordx4 v31, s[24:27], s39 offen lds
    ds_read_b64_tr_b16 a[144:145], v20 offset:49408
    ds_read_b64_tr_b16 a[146:147], v20 offset:51456
    v_mfma_f32_32x32x16_bf16 a[64:79], a[208:211], v[144:147], a[64:79]
    ds_read_b64_tr_b16 a[148:149], v21 offset:49408
    ds_read_b64_tr_b16 a[150:151], v21 offset:51456
    v_mfma_f32_32x32x16_bf16 a[80:95], a[212:215], v[144:147], a[80:95]
    s_add_u32 m0, s45, 100352
    s_nop 0
    buffer_load_dwordx4 v32, s[24:27], s39 offen lds
    ds_read_b64_tr_b16 a[152:153], v22 offset:49408
    ds_read_b64_tr_b16 a[154:155], v22 offset:51456
    v_mfma_f32_32x32x16_bf16 a[96:111], a[216:219], v[144:147], a[96:111]
    ds_read_b64_tr_b16 a[156:157], v23 offset:49408
    ds_read_b64_tr_b16 a[158:159], v23 offset:51456
    v_mfma_f32_32x32x16_bf16 a[112:127], a[220:223], v[144:147], a[112:127]
    s_add_u32 m0, s45, 101376
    s_nop 0
    buffer_load_dwordx4 v33, s[24:27], s39 offen lds
    s_add_u32 s39, s39, 262144
    ds_read_b64_tr_b16 a[160:161], v20 offset:57344
    ds_read_b64_tr_b16 a[162:163], v20 offset:59392
    v_mfma_f32_32x32x16_bf16 a[0:15], a[224:227], v[148:151], a[0:15]
    ds_read_b64_tr_b16 a[164:165], v21 offset:57344
    ds_read_b64_tr_b16 a[166:167], v21 offset:59392
    v_mfma_f32_32x32x16_bf16 a[16:31], a[228:231], v[148:151], a[16:31]
    buffer_load_dwordx4 v[176:179], v4, s[28:31], s15 offen offset:0
    ds_read_b64_tr_b16 a[168:169], v22 offset:57344
    ds_read_b64_tr_b16 a[170:171], v22 offset:59392
    v_mfma_f32_32x32x16_bf16 a[32:47], a[232:235], v[148:151], a[32:47]
    ds_read_b64_tr_b16 a[172:173], v23 offset:57344
    ds_read_b64_tr_b16 a[174:175], v23 offset:59392
    v_mfma_f32_32x32x16_bf16 a[48:63], a[236:239], v[148:151], a[48:63]
    buffer_load_dwordx4 v[180:183], v4, s[28:31], s15 offen offset:1024
    ds_read_b64_tr_b16 a[176:177], v20 offset:57600
    ds_read_b64_tr_b16 a[178:179], v20 offset:59648
    v_mfma_f32_32x32x16_bf16 a[64:79], a[240:243], v[148:151], a[64:79]
    ds_read_b64_tr_b16 a[180:181], v21 offset:57600
    ds_read_b64_tr_b16 a[182:183], v21 offset:59648
    v_mfma_f32_32x32x16_bf16 a[80:95], a[244:247], v[148:151], a[80:95]
    s_mov_b32 m0, s42
    s_nop 0
    buffer_load_dwordx4 v26, s[16:19], s36 offen offset:2048 lds
    ds_read_b64_tr_b16 a[184:185], v22 offset:57600
    ds_read_b64_tr_b16 a[186:187], v22 offset:59648
    v_mfma_f32_32x32x16_bf16 a[96:111], a[248:251], v[148:151], a[96:111]
    ds_read_b64_tr_b16 a[188:189], v23 offset:57600
    ds_read_b64_tr_b16 a[190:191], v23 offset:59648
    v_mfma_f32_32x32x16_bf16 a[112:127], a[252:255], v[148:151], a[112:127]
    s_mov_b32 m0, s42
    s_nop 0
    buffer_load_dwordx4 v27, s[16:19], s36 offen offset:3072 lds
    s_add_u32 s36, s36, 16384
    s_waitcnt vmcnt(22)
    s_waitcnt vmcnt(18)
    s_waitcnt lgkmcnt(0)
    s_barrier
    ds_read_b64_tr_b16 a[192:193], v56 offset:0
    ds_read_b64_tr_b16 a[194:195], v56 offset:2048
    v_mfma_f32_32x32x16_bf16 a[0:15], a[128:131], v[152:155], a[0:15]
    ds_read_b64_tr_b16 a[196:197], v57 offset:0
    ds_read_b64_tr_b16 a[198:199], v57 offset:2048
    v_mfma_f32_32x32x16_bf16 a[16:31], a[132:135], v[152:155], a[16:31]
    s_add_u32 m0, s45, 0
    s_nop 0
    buffer_load_dwordx4 v30, s[24:27], s39 offen lds
    ds_read_b64_tr_b16 a[200:201], v58 offset:0
    ds_read_b64_tr_b16 a[202:203], v58 offset:2048
    v_mfma_f32_32x32x16_bf16 a[32:47], a[136:139], v[152:155], a[32:47]
    ds_read_b64_tr_b16 a[204:205], v59 offset:0
    ds_read_b64_tr_b16 a[206:207], v59 offset:2048
    v_mfma_f32_32x32x16_bf16 a[48:63], a[140:143], v[152:155], a[48:63]
    s_add_u32 m0, s45, 1024
    s_nop 0
    buffer_load_dwordx4 v31, s[24:27], s39 offen lds
    ds_read_b64_tr_b16 a[208:209], v56 offset:256
    ds_read_b64_tr_b16 a[210:211], v56 offset:2304
    v_mfma_f32_32x32x16_bf16 a[64:79], a[144:147], v[152:155], a[64:79]
    ds_read_b64_tr_b16 a[212:213], v57 offset:256
    ds_read_b64_tr_b16 a[214:215], v57 offset:2304
    v_mfma_f32_32x32x16_bf16 a[80:95], a[148:151], v[152:155], a[80:95]
    s_add_u32 m0, s45, 2048
    s_nop 0
    buffer_load_dwordx4 v32, s[24:27], s39 offen lds
    ds_read_b64_tr_b16 a[216:217], v58 offset:256
    ds_read_b64_tr_b16 a[218:219], v58 offset:2304
    v_mfma_f32_32x32x16_bf16 a[96:111], a[152:155], v[152:155], a[96:111]
    ds_read_b64_tr_b16 a[220:221], v59 offset:256
    ds_read_b64_tr_b16 a[222:223], v59 offset:2304
    v_mfma_f32_32x32x16_bf16 a[112:127], a[156:159], v[152:155], a[112:127]
    s_add_u32 m0, s45, 3072
    s_nop 0
    buffer_load_dwordx4 v33, s[24:27], s39 offen lds
    s_add_u32 s39, s39, 262144
    ds_read_b64_tr_b16 a[224:225], v56 offset:8192
    ds_read_b64_tr_b16 a[226:227], v56 offset:10240
    v_mfma_f32_32x32x16_bf16 a[0:15], a[160:163], v[156:159], a[0:15]
    ds_read_b64_tr_b16 a[228:229], v57 offset:8192
    ds_read_b64_tr_b16 a[230:231], v57 offset:10240
    v_mfma_f32_32x32x16_bf16 a[16:31], a[164:167], v[156:159], a[16:31]
    buffer_load_dwordx4 v[184:187], v4, s[28:31], s15 offen offset:2048
    ds_read_b64_tr_b16 a[232:233], v58 offset:8192
    ds_read_b64_tr_b16 a[234:235], v58 offset:10240
    v_mfma_f32_32x32x16_bf16 a[32:47], a[168:171], v[156:159], a[32:47]
    ds_read_b64_tr_b16 a[236:237], v59 offset:8192
    ds_read_b64_tr_b16 a[238:239], v59 offset:10240
    v_mfma_f32_32x32x16_bf16 a[48:63], a[172:175], v[156:159], a[48:63]
    buffer_load_dwordx4 v[188:191], v4, s[28:31], s15 offen offset:3072
    s_add_u32 s15, s15, 4096
    ds_read_b64_tr_b16 a[240:241], v56 offset:8448
    ds_read_b64_tr_b16 a[242:243], v56 offset:10496
    v_mfma_f32_32x32x16_bf16 a[64:79], a[176:179], v[156:159], a[64:79]
    ds_read_b64_tr_b16 a[244:245], v57 offset:8448
    ds_read_b64_tr_b16 a[246:247], v57 offset:10496
    v_mfma_f32_32x32x16_bf16 a[80:95], a[180:183], v[156:159], a[80:95]
    s_mov_b32 m0, s43
    s_nop 0
    buffer_load_dwordx4 v24, s[16:19], s36 offen offset:0 lds
    ds_read_b64_tr_b16 a[248:249], v58 offset:8448
    ds_read_b64_tr_b16 a[250:251], v58 offset:10496
    v_mfma_f32_32x32x16_bf16 a[96:111], a[184:187], v[156:159], a[96:111]
    ds_read_b64_tr_b16 a[252:253], v59 offset:8448
    ds_read_b64_tr_b16 a[254:255], v59 offset:10496
    v_mfma_f32_32x32x16_bf16 a[112:127], a[188:191], v[156:159], a[112:127]
    s_mov_b32 m0, s43
    s_nop 0
    buffer_load_dwordx4 v25, s[16:19], s36 offen offset:1024 lds
    s_waitcnt vmcnt(24)
    s_waitcnt vmcnt(20)
    s_waitcnt lgkmcnt(0)
    s_barrier
    ds_read_b64_tr_b16 a[128:129], v56 offset:16384
    ds_read_b64_tr_b16 a[130:131], v56 offset:18432
    v_mfma_f32_32x32x16_bf16 a[0:15], a[192:195], v[160:163], a[0:15]
    ds_read_b64_tr_b16 a[132:133], v57 offset:16384
    ds_read_b64_tr_b16 a[134:135], v57 offset:18432
    v_mfma_f32_32x32x16_bf16 a[16:31], a[196:199], v[160:163], a[16:31]
    s_add_u32 m0, s45, 16384
    s_nop 0
    buffer_load_dwordx4 v30, s[24:27], s39 offen lds
    ds_read_b64_tr_b16 a[136:137], v58 offset:16384
    ds_read_b64_tr_b16 a[138:139], v58 offset:18432
    v_mfma_f32_32x32x16_bf16 a[32:47], a[200:203], v[160:163], a[32:47]
    ds_read_b64_tr_b16 a[140:141], v59 offset:16384
    ds_read_b64_tr_b16 a[142:143], v59 offset:18432
    v_mfma_f32_32x32x16_bf16 a[48:63], a[204:207], v[160:163], a[48:63]
    s_add_u32 m0, s45, 17408
    s_nop 0
    buffer_load_dwordx4 v31, s[24:27], s39 offen lds
    ds_read_b64_tr_b16 a[144:145], v56 offset:16640
    ds_read_b64_tr_b16 a[146:147], v56 offset:18688
    v_mfma_f32_32x32x16_bf16 a[64:79], a[208:211], v[160:163], a[64:79]
    ds_read_b64_tr_b16 a[148:149], v57 offset:16640
    ds_read_b64_tr_b16 a[150:151], v57 offset:18688
    v_mfma_f32_32x32x16_bf16 a[80:95], a[212:215], v[160:163], a[80:95]
    s_add_u32 m0, s45, 18432
    s_nop 0
    buffer_load_dwordx4 v32, s[24:27], s39 offen lds
    ds_read_b64_tr_b16 a[152:153], v58 offset:16640
    ds_read_b64_tr_b16 a[154:155], v58 offset:18688
    v_mfma_f32_32x32x16_bf16 a[96:111], a[216:219], v[160:163], a[96:111]
    ds_read_b64_tr_b16 a[156:157], v59 offset:16640
    ds_read_b64_tr_b16 a[158:159], v59 offset:18688
    v_mfma_f32_32x32x16_bf16 a[112:127], a[220:223], v[160:163], a[112:127]
    s_add_u32 m0, s45, 19456
    s_nop 0
    buffer_load_dwordx4 v33, s[24:27], s39 offen lds
    s_add_u32 s39, s39, 262144
    ds_read_b64_tr_b16 a[160:161], v56 offset:24576
    ds_read_b64_tr_b16 a[162:163], v56 offset:26624
    v_mfma_f32_32x32x16_bf16 a[0:15], a[224:227], v[164:167], a[0:15]
    ds_read_b64_tr_b16 a[164:165], v57 offset:24576
    ds_read_b64_tr_b16 a[166:167], v57 offset:26624
    v_mfma_f32_32x32x16_bf16 a[16:31], a[228:231], v[164:167], a[16:31]
    buffer_load_dwordx4 v[192:195], v4, s[28:31], s15 offen offset:0
    ds_read_b64_tr_b16 a[168:169], v58 offset:24576
    ds_read_b64_tr_b16 a[170:171], v58 offset:26624
    v_mfma_f32_32x32x16_bf16 a[32:47], a[232:235], v[164:167], a[32:47]
    ds_read_b64_tr_b16 a[172:173], v59 offset:24576
    ds_read_b64_tr_b16 a[174:175], v59 offset:26624
    v_mfma_f32_32x32x16_bf16 a[48:63], a[236:239], v[164:167], a[48:63]
    buffer_load_dwordx4 v[196:199], v4, s[28:31], s15 offen offset:1024
    ds_read_b64_tr_b16 a[176:177], v56 offset:24832
    ds_read_b64_tr_b16 a[178:179], v56 offset:26880
    v_mfma_f32_32x32x16_bf16 a[64:79], a[240:243], v[164:167], a[64:79]
    ds_read_b64_tr_b16 a[180:181], v57 offset:24832
    ds_read_b64_tr_b16 a[182:183], v57 offset:26880
    v_mfma_f32_32x32x16_bf16 a[80:95], a[244:247], v[164:167], a[80:95]
    s_mov_b32 m0, s43
    s_nop 0
    buffer_load_dwordx4 v26, s[16:19], s36 offen offset:2048 lds
    ds_read_b64_tr_b16 a[184:185], v58 offset:24832
    ds_read_b64_tr_b16 a[186:187], v58 offset:26880
    v_mfma_f32_32x32x16_bf16 a[96:111], a[248:251], v[164:167], a[96:111]
    ds_read_b64_tr_b16 a[188:189], v59 offset:24832
    ds_read_b64_tr_b16 a[190:191], v59 offset:26880
    v_mfma_f32_32x32x16_bf16 a[112:127], a[252:255], v[164:167], a[112:127]
    s_mov_b32 m0, s43
    s_nop 0
    buffer_load_dwordx4 v27, s[16:19], s36 offen offset:3072 lds
    s_add_u32 s36, s36, 16384
    s_waitcnt vmcnt(26)
    s_waitcnt vmcnt(20)
    s_waitcnt lgkmcnt(0)
    s_barrier
    ds_read_b64_tr_b16 a[192:193], v56 offset:32768
    ds_read_b64_tr_b16 a[194:195], v56 offset:34816
    v_mfma_f32_32x32x16_bf16 a[0:15], a[128:131], v[168:171], a[0:15]
    ds_read_b64_tr_b16 a[196:197], v57 offset:32768
    ds_read_b64_tr_b16 a[198:199], v57 offset:34816
    v_mfma_f32_32x32x16_bf16 a[16:31], a[132:135], v[168:171], a[16:31]
    s_add_u32 m0, s45, 32768
    s_nop 0
    buffer_load_dwordx4 v30, s[24:27], s39 offen lds
    ds_read_b64_tr_b16 a[200:201], v58 offset:32768
    ds_read_b64_tr_b16 a[202:203], v58 offset:34816
    v_mfma_f32_32x32x16_bf16 a[32:47], a[136:139], v[168:171], a[32:47]
    ds_read_b64_tr_b16 a[204:205], v59 offset:32768
    ds_read_b64_tr_b16 a[206:207], v59 offset:34816
    v_mfma_f32_32x32x16_bf16 a[48:63], a[140:143], v[168:171], a[48:63]
    s_add_u32 m0, s45, 33792
    s_nop 0
    buffer_load_dwordx4 v31, s[24:27], s39 offen lds
    ds_read_b64_tr_b16 a[208:209], v56 offset:33024
    ds_read_b64_tr_b16 a[210:211], v56 offset:35072
    v_mfma_f32_32x32x16_bf16 a[64:79], a[144:147], v[168:171], a[64:79]
    ds_read_b64_tr_b16 a[212:213], v57 offset:33024
    ds_read_b64_tr_b16 a[214:215], v57 offset:35072
    v_mfma_f32_32x32x16_bf16 a[80:95], a[148:151], v[168:171], a[80:95]
    s_add_u32 m0, s45, 34816
    s_nop 0
    buffer_load_dwordx4 v32, s[24:27], s39 offen lds
    ds_read_b64_tr_b16 a[216:217], v58 offset:33024
    ds_read_b64_tr_b16 a[218:219], v58 offset:35072
    v_mfma_f32_32x32x16_bf16 a[96:111], a[152:155], v[168:171], a[96:111]
    ds_read_b64_tr_b16 a[220:221], v59 offset:33024
    ds_read_b64_tr_b16 a[222:223], v59 offset:35072
    v_mfma_f32_32x32x16_bf16 a[112:127], a[156:159], v[168:171], a[112:127]
    s_add_u32 m0, s45, 35840
    s_nop 0
    buffer_load_dwordx4 v33, s[24:27], s39 offen lds
    s_add_u32 s39, s39, 262144
    ds_read_b64_tr_b16 a[224:225], v56 offset:40960
    ds_read_b64_tr_b16 a[226:227], v56 offset:43008
    v_mfma_f32_32x32x16_bf16 a[0:15], a[160:163], v[172:175], a[0:15]
    ds_read_b64_tr_b16 a[228:229], v57 offset:40960
    ds_read_b64_tr_b16 a[230:231], v57 offset:43008
    v_mfma_f32_32x32x16_bf16 a[16:31], a[164:167], v[172:175], a[16:31]
    buffer_load_dwordx4 v[200:203], v4, s[28:31], s15 offen offset:2048
    ds_read_b64_tr_b16 a[232:233], v58 offset:40960
    ds_read_b64_tr_b16 a[234:235], v58 offset:43008
    v_mfma_f32_32x32x16_bf16 a[32:47], a[168:171], v[172:175], a[32:47]
    ds_read_b64_tr_b16 a[236:237], v59 offset:40960
    ds_read_b64_tr_b16 a[238:239], v59 offset:43008
    v_mfma_f32_32x32x16_bf16 a[48:63], a[172:175], v[172:175], a[48:63]
    buffer_load_dwordx4 v[204:207], v4, s[28:31], s15 offen offset:3072
    s_add_u32 s15, s15, 4096
    ds_read_b64_tr_b16 a[240:241], v56 offset:41216
    ds_read_b64_tr_b16 a[242:243], v56 offset:43264
    v_mfma_f32_32x32x16_bf16 a[64:79], a[176:179], v[172:175], a[64:79]
    ds_read_b64_tr_b16 a[244:245], v57 offset:41216
    ds_read_b64_tr_b16 a[246:247], v57 offset:43264
    v_mfma_f32_32x32x16_bf16 a[80:95], a[180:183], v[172:175], a[80:95]
    s_mov_b32 m0, s44
    s_nop 0
    buffer_load_dwordx4 v24, s[16:19], s36 offen offset:0 lds
    ds_read_b64_tr_b16 a[248:249], v58 offset:41216
    ds_read_b64_tr_b16 a[250:251], v58 offset:43264
    v_mfma_f32_32x32x16_bf16 a[96:111], a[184:187], v[172:175], a[96:111]
    ds_read_b64_tr_b16 a[252:253], v59 offset:41216
    ds_read_b64_tr_b16 a[254:255], v59 offset:43264
    v_mfma_f32_32x32x16_bf16 a[112:127], a[188:191], v[172:175], a[112:127]
    s_mov_b32 m0, s44
    s_nop 0
    buffer_load_dwordx4 v25, s[16:19], s36 offen offset:1024 lds
    s_waitcnt vmcnt(26)
    s_waitcnt vmcnt(20)
    s_waitcnt lgkmcnt(0)
    s_barrier
    ds_read_b64_tr_b16 a[128:129], v20 offset:0
    ds_read_b64_tr_b16 a[130:131], v20 offset:2048
    v_mfma_f32_32x32x16_bf16 a[0:15], a[192:195], v[176:179], a[0:15]
    ds_read_b64_tr_b16 a[132:133], v21 offset:0
    ds_read_b64_tr_b16 a[134:135], v21 offset:2048
    v_mfma_f32_32x32x16_bf16 a[16:31], a[196:199], v[176:179], a[16:31]
    s_add_u32 m0, s45, 49152
    s_nop 0
    buffer_load_dwordx4 v30, s[24:27], s39 offen lds
    ds_read_b64_tr_b16 a[136:137], v22 offset:0
    ds_read_b64_tr_b16 a[138:139], v22 offset:2048
    v_mfma_f32_32x32x16_bf16 a[32:47], a[200:203], v[176:179], a[32:47]
    ds_read_b64_tr_b16 a[140:141], v23 offset:0
    ds_read_b64_tr_b16 a[142:143], v23 offset:2048
    v_mfma_f32_32x32x16_bf16 a[48:63], a[204:207], v[176:179], a[48:63]
    s_add_u32 m0, s45, 50176
    s_nop 0
    buffer_load_dwordx4 v31, s[24:27], s39 offen lds
    ds_read_b64_tr_b16 a[144:145], v20 offset:256
    ds_read_b64_tr_b16 a[146:147], v20 offset:2304
    v_mfma_f32_32x32x16_bf16 a[64:79], a[208:211], v[176:179], a[64:79]
    ds_read_b64_tr_b16 a[148:149], v21 offset:256
    ds_read_b64_tr_b16 a[150:151], v21 offset:2304
    v_mfma_f32_32x32x16_bf16 a[80:95], a[212:215], v[176:179], a[80:95]
    s_add_u32 m0, s45, 51200
    s_nop 0
    buffer_load_dwordx4 v32, s[24:27], s39 offen lds
    ds_read_b64_tr_b16 a[152:153], v22 offset:256
    ds_read_b64_tr_b16 a[154:155], v22 offset:2304
    v_mfma_f32_32x32x16_bf16 a[96:111], a[216:219], v[176:179], a[96:111]
    ds_read_b64_tr_b16 a[156:157], v23 offset:256
    ds_read_b64_tr_b16 a[158:159], v23 offset:2304
    v_mfma_f32_32x32x16_bf16 a[112:127], a[220:223], v[176:179], a[112:127]
    s_add_u32 m0, s45, 52224
    s_nop 0
    buffer_load_dwordx4 v33, s[24:27], s39 offen lds
    s_add_u32 s39, s39, 262144
    ds_read_b64_tr_b16 a[160:161], v20 offset:8192
    ds_read_b64_tr_b16 a[162:163], v20 offset:10240
    v_mfma_f32_32x32x16_bf16 a[0:15], a[224:227], v[180:183], a[0:15]
    ds_read_b64_tr_b16 a[164:165], v21 offset:8192
    ds_read_b64_tr_b16 a[166:167], v21 offset:10240
    v_mfma_f32_32x32x16_bf16 a[16:31], a[228:231], v[180:183], a[16:31]
    buffer_load_dwordx4 v[208:211], v4, s[28:31], s15 offen offset:0
    ds_read_b64_tr_b16 a[168:169], v22 offset:8192
    ds_read_b64_tr_b16 a[170:171], v22 offset:10240
    v_mfma_f32_32x32x16_bf16 a[32:47], a[232:235], v[180:183], a[32:47]
    ds_read_b64_tr_b16 a[172:173], v23 offset:8192
    ds_read_b64_tr_b16 a[174:175], v23 offset:10240
    v_mfma_f32_32x32x16_bf16 a[48:63], a[236:239], v[180:183], a[48:63]
    buffer_load_dwordx4 v[212:215], v4, s[28:31], s15 offen offset:1024
    ds_read_b64_tr_b16 a[176:177], v20 offset:8448
    ds_read_b64_tr_b16 a[178:179], v20 offset:10496
    v_mfma_f32_32x32x16_bf16 a[64:79], a[240:243], v[180:183], a[64:79]
    ds_read_b64_tr_b16 a[180:181], v21 offset:8448
    ds_read_b64_tr_b16 a[182:183], v21 offset:10496
    v_mfma_f32_32x32x16_bf16 a[80:95], a[244:247], v[180:183], a[80:95]
    s_mov_b32 m0, s44
    s_nop 0
    buffer_load_dwordx4 v26, s[16:19], s36 offen offset:2048 lds
    ds_read_b64_tr_b16 a[184:185], v22 offset:8448
    ds_read_b64_tr_b16 a[186:187], v22 offset:10496
    v_mfma_f32_32x32x16_bf16 a[96:111], a[248:251], v[180:183], a[96:111]
    ds_read_b64_tr_b16 a[188:189], v23 offset:8448
    ds_read_b64_tr_b16 a[190:191], v23 offset:10496
    v_mfma_f32_32x32x16_bf16 a[112:127], a[252:255], v[180:183], a[112:127]
    s_mov_b32 m0, s44
    s_nop 0
    buffer_load_dwordx4 v27, s[16:19], s36 offen offset:3072 lds
    s_add_u32 s36, s36, 16384
    s_waitcnt vmcnt(26)
    s_waitcnt vmcnt(20)
    s_waitcnt lgkmcnt(0)
    s_barrier
    ds_read_b64_tr_b16 a[192:193], v20 offset:16384
    ds_read_b64_tr_b16 a[194:195], v20 offset:18432
    v_mfma_f32_32x32x16_bf16 a[0:15], a[128:131], v[184:187], a[0:15]
    ds_read_b64_tr_b16 a[196:197], v21 offset:16384
    ds_read_b64_tr_b16 a[198:199], v21 offset:18432
    v_mfma_f32_32x32x16_bf16 a[16:31], a[132:135], v[184:187], a[16:31]
    s_add_u32 m0, s45, 65536
    s_nop 0
    buffer_load_dwordx4 v30, s[24:27], s39 offen lds
    ds_read_b64_tr_b16 a[200:201], v22 offset:16384
    ds_read_b64_tr_b16 a[202:203], v22 offset:18432
    v_mfma_f32_32x32x16_bf16 a[32:47], a[136:139], v[184:187], a[32:47]
    ds_read_b64_tr_b16 a[204:205], v23 offset:16384
    ds_read_b64_tr_b16 a[206:207], v23 offset:18432
    v_mfma_f32_32x32x16_bf16 a[48:63], a[140:143], v[184:187], a[48:63]
    s_add_u32 m0, s45, 66560
    s_nop 0
    buffer_load_dwordx4 v31, s[24:27], s39 offen lds
    ds_read_b64_tr_b16 a[208:209], v20 offset:16640
    ds_read_b64_tr_b16 a[210:211], v20 offset:18688
    v_mfma_f32_32x32x16_bf16 a[64:79], a[144:147], v[184:187], a[64:79]
    ds_read_b64_tr_b16 a[212:213], v21 offset:16640
    ds_read_b64_tr_b16 a[214:215], v21 offset:18688
    v_mfma_f32_32x32x16_bf16 a[80:95], a[148:151], v[184:187], a[80:95]
    s_add_u32 m0, s45, 67584
    s_nop 0
    buffer_load_dwordx4 v32, s[24:27], s39 offen lds
    ds_read_b64_tr_b16 a[216:217], v22 offset:16640
    ds_read_b64_tr_b16 a[218:219], v22 offset:18688
    v_mfma_f32_32x32x16_bf16 a[96:111], a[152:155], v[184:187], a[96:111]
    ds_read_b64_tr_b16 a[220:221], v23 offset:16640
    ds_read_b64_tr_b16 a[222:223], v23 offset:18688
    v_mfma_f32_32x32x16_bf16 a[112:127], a[156:159], v[184:187], a[112:127]
    s_add_u32 m0, s45, 68608
    s_nop 0
    buffer_load_dwordx4 v33, s[24:27], s39 offen lds
    s_add_u32 s39, s39, 262144
    ds_read_b64_tr_b16 a[224:225], v20 offset:24576
    ds_read_b64_tr_b16 a[226:227], v20 offset:26624
    v_mfma_f32_32x32x16_bf16 a[0:15], a[160:163], v[188:191], a[0:15]
    ds_read_b64_tr_b16 a[228:229], v21 offset:24576
    ds_read_b64_tr_b16 a[230:231], v21 offset:26624
    v_mfma_f32_32x32x16_bf16 a[16:31], a[164:167], v[188:191], a[16:31]
    buffer_load_dwordx4 v[216:219], v4, s[28:31], s15 offen offset:2048
    ds_read_b64_tr_b16 a[232:233], v22 offset:24576
    ds_read_b64_tr_b16 a[234:235], v22 offset:26624
    v_mfma_f32_32x32x16_bf16 a[32:47], a[168:171], v[188:191], a[32:47]
    ds_read_b64_tr_b16 a[236:237], v23 offset:24576
    ds_read_b64_tr_b16 a[238:239], v23 offset:26624
    v_mfma_f32_32x32x16_bf16 a[48:63], a[172:175], v[188:191], a[48:63]
    buffer_load_dwordx4 v[220:223], v4, s[28:31], s15 offen offset:3072
    s_add_u32 s15, s15, 4096
    ds_read_b64_tr_b16 a[240:241], v20 offset:24832
    ds_read_b64_tr_b16 a[242:243], v20 offset:26880
    v_mfma_f32_32x32x16_bf16 a[64:79], a[176:179], v[188:191], a[64:79]
    ds_read_b64_tr_b16 a[244:245], v21 offset:24832
    ds_read_b64_tr_b16 a[246:247], v21 offset:26880
    v_mfma_f32_32x32x16_bf16 a[80:95], a[180:183], v[188:191], a[80:95]
    ds_read_b64_tr_b16 a[248:249], v22 offset:24832
    ds_read_b64_tr_b16 a[250:251], v22 offset:26880
    v_mfma_f32_32x32x16_bf16 a[96:111], a[184:187], v[188:191], a[96:111]
    ds_read_b64_tr_b16 a[252:253], v23 offset:24832
    ds_read_b64_tr_b16 a[254:255], v23 offset:26880
    v_mfma_f32_32x32x16_bf16 a[112:127], a[188:191], v[188:191], a[112:127]
    s_waitcnt vmcnt(24)
    s_waitcnt vmcnt(18)
    s_waitcnt lgkmcnt(0)
    s_barrier
    ds_read_b64_tr_b16 a[128:129], v20 offset:32768
    ds_read_b64_tr_b16 a[130:131], v20 offset:34816
    v_mfma_f32_32x32x16_bf16 a[0:15], a[192:195], v[192:195], a[0:15]
    ds_read_b64_tr_b16 a[132:133], v21 offset:32768
    ds_read_b64_tr_b16 a[134:135], v21 offset:34816
    v_mfma_f32_32x32x16_bf16 a[16:31], a[196:199], v[192:195], a[16:31]
    s_add_u32 m0, s45, 81920
    s_nop 0
    buffer_load_dwordx4 v30, s[24:27], s39 offen lds
    ds_read_b64_tr_b16 a[136:137], v22 offset:32768
    ds_read_b64_tr_b16 a[138:139], v22 offset:34816
    v_mfma_f32_32x32x16_bf16 a[32:47], a[200:203], v[192:195], a[32:47]
    ds_read_b64_tr_b16 a[140:141], v23 offset:32768
    ds_read_b64_tr_b16 a[142:143], v23 offset:34816
    v_mfma_f32_32x32x16_bf16 a[48:63], a[204:207], v[192:195], a[48:63]
    s_add_u32 m0, s45, 82944
    s_nop 0
    buffer_load_dwordx4 v31, s[24:27], s39 offen lds
    ds_read_b64_tr_b16 a[144:145], v20 offset:33024
    ds_read_b64_tr_b16 a[146:147], v20 offset:35072
    v_mfma_f32_32x32x16_bf16 a[64:79], a[208:211], v[192:195], a[64:79]
    ds_read_b64_tr_b16 a[148:149], v21 offset:33024
    ds_read_b64_tr_b16 a[150:151], v21 offset:35072
    v_mfma_f32_32x32x16_bf16 a[80:95], a[212:215], v[192:195], a[80:95]
    s_add_u32 m0, s45, 83968
    s_nop 0
    buffer_load_dwordx4 v32, s[24:27], s39 offen lds
    ds_read_b64_tr_b16 a[152:153], v22 offset:33024
    ds_read_b64_tr_b16 a[154:155], v22 offset:35072
    v_mfma_f32_32x32x16_bf16 a[96:111], a[216:219], v[192:195], a[96:111]
    ds_read_b64_tr_b16 a[156:157], v23 offset:33024
    ds_read_b64_tr_b16 a[158:159], v23 offset:35072
    v_mfma_f32_32x32x16_bf16 a[112:127], a[220:223], v[192:195], a[112:127]
    s_add_u32 m0, s45, 84992
    s_nop 0
    buffer_load_dwordx4 v33, s[24:27], s39 offen lds
    s_add_u32 s39, s39, 262144
    ds_read_b64_tr_b16 a[160:161], v20 offset:40960
    ds_read_b64_tr_b16 a[162:163], v20 offset:43008
    v_mfma_f32_32x32x16_bf16 a[0:15], a[224:227], v[196:199], a[0:15]
    ds_read_b64_tr_b16 a[164:165], v21 offset:40960
    ds_read_b64_tr_b16 a[166:167], v21 offset:43008
    v_mfma_f32_32x32x16_bf16 a[16:31], a[228:231], v[196:199], a[16:31]
    buffer_load_dwordx4 v[224:227], v4, s[28:31], s15 offen offset:0
    ds_read_b64_tr_b16 a[168:169], v22 offset:40960
    ds_read_b64_tr_b16 a[170:171], v22 offset:43008
    v_mfma_f32_32x32x16_bf16 a[32:47], a[232:235], v[196:199], a[32:47]
    ds_read_b64_tr_b16 a[172:173], v23 offset:40960
    ds_read_b64_tr_b16 a[174:175], v23 offset:43008
    v_mfma_f32_32x32x16_bf16 a[48:63], a[236:239], v[196:199], a[48:63]
    buffer_load_dwordx4 v[228:231], v4, s[28:31], s15 offen offset:1024
    ds_read_b64_tr_b16 a[176:177], v20 offset:41216
    ds_read_b64_tr_b16 a[178:179], v20 offset:43264
    v_mfma_f32_32x32x16_bf16 a[64:79], a[240:243], v[196:199], a[64:79]
    ds_read_b64_tr_b16 a[180:181], v21 offset:41216
    ds_read_b64_tr_b16 a[182:183], v21 offset:43264
    v_mfma_f32_32x32x16_bf16 a[80:95], a[244:247], v[196:199], a[80:95]
    ds_read_b64_tr_b16 a[184:185], v22 offset:41216
    ds_read_b64_tr_b16 a[186:187], v22 offset:43264
    v_mfma_f32_32x32x16_bf16 a[96:111], a[248:251], v[196:199], a[96:111]
    ds_read_b64_tr_b16 a[188:189], v23 offset:41216
    ds_read_b64_tr_b16 a[190:191], v23 offset:43264
    v_mfma_f32_32x32x16_bf16 a[112:127], a[252:255], v[196:199], a[112:127]
    s_waitcnt vmcnt(22)
    s_waitcnt vmcnt(16)
    s_waitcnt lgkmcnt(0)
    s_barrier
    ds_read_b64_tr_b16 a[192:193], v20 offset:49152
    ds_read_b64_tr_b16 a[194:195], v20 offset:51200
    v_mfma_f32_32x32x16_bf16 a[0:15], a[128:131], v[200:203], a[0:15]
    ds_read_b64_tr_b16 a[196:197], v21 offset:49152
    ds_read_b64_tr_b16 a[198:199], v21 offset:51200
    v_mfma_f32_32x32x16_bf16 a[16:31], a[132:135], v[200:203], a[16:31]
    s_add_u32 m0, s45, 98304
    s_nop 0
    buffer_load_dwordx4 v30, s[24:27], s39 offen lds
    ds_read_b64_tr_b16 a[200:201], v22 offset:49152
    ds_read_b64_tr_b16 a[202:203], v22 offset:51200
    v_mfma_f32_32x32x16_bf16 a[32:47], a[136:139], v[200:203], a[32:47]
    ds_read_b64_tr_b16 a[204:205], v23 offset:49152
    ds_read_b64_tr_b16 a[206:207], v23 offset:51200
    v_mfma_f32_32x32x16_bf16 a[48:63], a[140:143], v[200:203], a[48:63]
    s_add_u32 m0, s45, 99328
    s_nop 0
    buffer_load_dwordx4 v31, s[24:27], s39 offen lds
    ds_read_b64_tr_b16 a[208:209], v20 offset:49408
    ds_read_b64_tr_b16 a[210:211], v20 offset:51456
    v_mfma_f32_32x32x16_bf16 a[64:79], a[144:147], v[200:203], a[64:79]
    ds_read_b64_tr_b16 a[212:213], v21 offset:49408
    ds_read_b64_tr_b16 a[214:215], v21 offset:51456
    v_mfma_f32_32x32x16_bf16 a[80:95], a[148:151], v[200:203], a[80:95]
    s_add_u32 m0, s45, 100352
    s_nop 0
    buffer_load_dwordx4 v32, s[24:27], s39 offen lds
    ds_read_b64_tr_b16 a[216:217], v22 offset:49408
    ds_read_b64_tr_b16 a[218:219], v22 offset:51456
    v_mfma_f32_32x32x16_bf16 a[96:111], a[152:155], v[200:203], a[96:111]
    ds_read_b64_tr_b16 a[220:221], v23 offset:49408
    ds_read_b64_tr_b16 a[222:223], v23 offset:51456
    v_mfma_f32_32x32x16_bf16 a[112:127], a[156:159], v[200:203], a[112:127]
    s_add_u32 m0, s45, 101376
    s_nop 0
    buffer_load_dwordx4 v33, s[24:27], s39 offen lds
    s_add_u32 s39, s39, 262144
    ds_read_b64_tr_b16 a[224:225], v20 offset:57344
    ds_read_b64_tr_b16 a[226:227], v20 offset:59392
    v_mfma_f32_32x32x16_bf16 a[0:15], a[160:163], v[204:207], a[0:15]
    ds_read_b64_tr_b16 a[228:229], v21 offset:57344
    ds_read_b64_tr_b16 a[230:231], v21 offset:59392
    v_mfma_f32_32x32x16_bf16 a[16:31], a[164:167], v[204:207], a[16:31]
    buffer_load_dwordx4 v[232:235], v4, s[28:31], s15 offen offset:2048
    ds_read_b64_tr_b16 a[232:233], v22 offset:57344
    ds_read_b64_tr_b16 a[234:235], v22 offset:59392
    v_mfma_f32_32x32x16_bf16 a[32:47], a[168:171], v[204:207], a[32:47]
    ds_read_b64_tr_b16 a[236:237], v23 offset:57344
    ds_read_b64_tr_b16 a[238:239], v23 offset:59392
    v_mfma_f32_32x32x16_bf16 a[48:63], a[172:175], v[204:207], a[48:63]
    buffer_load_dwordx4 v[236:239], v4, s[28:31], s15 offen offset:3072
    s_add_u32 s15, s15, 4096
    ds_read_b64_tr_b16 a[240:241], v20 offset:57600
    ds_read_b64_tr_b16 a[242:243], v20 offset:59648
    v_mfma_f32_32x32x16_bf16 a[64:79], a[176:179], v[204:207], a[64:79]
    ds_read_b64_tr_b16 a[244:245], v21 offset:57600
    ds_read_b64_tr_b16 a[246:247], v21 offset:59648
    v_mfma_f32_32x32x16_bf16 a[80:95], a[180:183], v[204:207], a[80:95]
    s_mov_b32 m0, s45
    s_nop 0
    buffer_load_dwordx4 v28, s[20:23], s37 offen offset:0 lds
    ds_read_b64_tr_b16 a[248:249], v22 offset:57600
    ds_read_b64_tr_b16 a[250:251], v22 offset:59648
    v_mfma_f32_32x32x16_bf16 a[96:111], a[184:187], v[204:207], a[96:111]
    ds_read_b64_tr_b16 a[252:253], v23 offset:57600
    ds_read_b64_tr_b16 a[254:255], v23 offset:59648
    v_mfma_f32_32x32x16_bf16 a[112:127], a[188:191], v[204:207], a[112:127]
    s_mov_b32 m0, s45
    s_nop 0
    buffer_load_dwordx4 v29, s[20:23], s37 offen offset:1024 lds
    s_waitcnt vmcnt(22)
    s_waitcnt vmcnt(16)
    s_waitcnt lgkmcnt(0)
    s_barrier
    ds_read_b64_tr_b16 a[128:129], v56 offset:0
    ds_read_b64_tr_b16 a[130:131], v56 offset:2048
    v_mfma_f32_32x32x16_bf16 a[0:15], a[192:195], v[208:211], a[0:15]
    ds_read_b64_tr_b16 a[132:133], v57 offset:0
    ds_read_b64_tr_b16 a[134:135], v57 offset:2048
    v_mfma_f32_32x32x16_bf16 a[16:31], a[196:199], v[208:211], a[16:31]
    s_mov_b32 m0, s45
    s_nop 0
    buffer_load_dwordx4 v28, s[20:23], s37 offen offset:2048 lds
    ds_read_b64_tr_b16 a[136:137], v58 offset:0
    ds_read_b64_tr_b16 a[138:139], v58 offset:2048
    v_mfma_f32_32x32x16_bf16 a[32:47], a[200:203], v[208:211], a[32:47]
    ds_read_b64_tr_b16 a[140:141], v59 offset:0
    ds_read_b64_tr_b16 a[142:143], v59 offset:2048
    v_mfma_f32_32x32x16_bf16 a[48:63], a[204:207], v[208:211], a[48:63]
    s_mov_b32 m0, s45
    s_nop 0
    buffer_load_dwordx4 v29, s[20:23], s37 offen offset:3072 lds
    s_add_u32 s37, s37, 16384
    ds_read_b64_tr_b16 a[144:145], v56 offset:256
    ds_read_b64_tr_b16 a[146:147], v56 offset:2304
    v_mfma_f32_32x32x16_bf16 a[64:79], a[208:211], v[208:211], a[64:79]
    ds_read_b64_tr_b16 a[148:149], v57 offset:256
    ds_read_b64_tr_b16 a[150:151], v57 offset:2304
    v_mfma_f32_32x32x16_bf16 a[80:95], a[212:215], v[208:211], a[80:95]
    ds_read_b64_tr_b16 a[152:153], v58 offset:256
    ds_read_b64_tr_b16 a[154:155], v58 offset:2304
    v_mfma_f32_32x32x16_bf16 a[96:111], a[216:219], v[208:211], a[96:111]
    ds_read_b64_tr_b16 a[156:157], v59 offset:256
    ds_read_b64_tr_b16 a[158:159], v59 offset:2304
    v_mfma_f32_32x32x16_bf16 a[112:127], a[220:223], v[208:211], a[112:127]
    ds_read_b64_tr_b16 a[160:161], v56 offset:8192
    ds_read_b64_tr_b16 a[162:163], v56 offset:10240
    v_mfma_f32_32x32x16_bf16 a[0:15], a[224:227], v[212:215], a[0:15]
    ds_read_b64_tr_b16 a[164:165], v57 offset:8192
    ds_read_b64_tr_b16 a[166:167], v57 offset:10240
    v_mfma_f32_32x32x16_bf16 a[16:31], a[228:231], v[212:215], a[16:31]
    ds_read_b64_tr_b16 a[168:169], v58 offset:8192
    ds_read_b64_tr_b16 a[170:171], v58 offset:10240
    v_mfma_f32_32x32x16_bf16 a[32:47], a[232:235], v[212:215], a[32:47]
    ds_read_b64_tr_b16 a[172:173], v59 offset:8192
    ds_read_b64_tr_b16 a[174:175], v59 offset:10240
    v_mfma_f32_32x32x16_bf16 a[48:63], a[236:239], v[212:215], a[48:63]
    ds_read_b64_tr_b16 a[176:177], v56 offset:8448
    ds_read_b64_tr_b16 a[178:179], v56 offset:10496
    v_mfma_f32_32x32x16_bf16 a[64:79], a[240:243], v[212:215], a[64:79]
    ds_read_b64_tr_b16 a[180:181], v57 offset:8448
    ds_read_b64_tr_b16 a[182:183], v57 offset:10496
    v_mfma_f32_32x32x16_bf16 a[80:95], a[244:247], v[212:215], a[80:95]
    ds_read_b64_tr_b16 a[184:185], v58 offset:8448
    ds_read_b64_tr_b16 a[186:187], v58 offset:10496
    v_mfma_f32_32x32x16_bf16 a[96:111], a[248:251], v[212:215], a[96:111]
    ds_read_b64_tr_b16 a[188:189], v59 offset:8448
    ds_read_b64_tr_b16 a[190:191], v59 offset:10496
    v_mfma_f32_32x32x16_bf16 a[112:127], a[252:255], v[212:215], a[112:127]
    s_waitcnt vmcnt(16)
    s_waitcnt vmcnt(12)
    s_waitcnt lgkmcnt(0)
    s_barrier
    ds_read_b64_tr_b16 a[192:193], v56 offset:16384
    ds_read_b64_tr_b16 a[194:195], v56 offset:18432
    v_mfma_f32_32x32x16_bf16 a[0:15], a[128:131], v[216:219], a[0:15]
    ds_read_b64_tr_b16 a[196:197], v57 offset:16384
    ds_read_b64_tr_b16 a[198:199], v57 offset:18432
    v_mfma_f32_32x32x16_bf16 a[16:31], a[132:135], v[216:219], a[16:31]
    s_mov_b32 m0, s46
    s_nop 0
    buffer_load_dwordx4 v28, s[20:23], s37 offen offset:0 lds
    ds_read_b64_tr_b16 a[200:201], v58 offset:16384
    ds_read_b64_tr_b16 a[202:203], v58 offset:18432
    v_mfma_f32_32x32x16_bf16 a[32:47], a[136:139], v[216:219], a[32:47]
    ds_read_b64_tr_b16 a[204:205], v59 offset:16384
    ds_read_b64_tr_b16 a[206:207], v59 offset:18432
    v_mfma_f32_32x32x16_bf16 a[48:63], a[140:143], v[216:219], a[48:63]
    s_mov_b32 m0, s46
    s_nop 0
    buffer_load_dwordx4 v29, s[20:23], s37 offen offset:1024 lds
    ds_read_b64_tr_b16 a[208:209], v56 offset:16640
    ds_read_b64_tr_b16 a[210:211], v56 offset:18688
    v_mfma_f32_32x32x16_bf16 a[64:79], a[144:147], v[216:219], a[64:79]
    ds_read_b64_tr_b16 a[212:213], v57 offset:16640
    ds_read_b64_tr_b16 a[214:215], v57 offset:18688
    v_mfma_f32_32x32x16_bf16 a[80:95], a[148:151], v[216:219], a[80:95]
    ds_read_b64_tr_b16 a[216:217], v58 offset:16640
    ds_read_b64_tr_b16 a[218:219], v58 offset:18688
    v_mfma_f32_32x32x16_bf16 a[96:111], a[152:155], v[216:219], a[96:111]
    ds_read_b64_tr_b16 a[220:221], v59 offset:16640
    ds_read_b64_tr_b16 a[222:223], v59 offset:18688
    v_mfma_f32_32x32x16_bf16 a[112:127], a[156:159], v[216:219], a[112:127]
    ds_read_b64_tr_b16 a[224:225], v56 offset:24576
    ds_read_b64_tr_b16 a[226:227], v56 offset:26624
    v_mfma_f32_32x32x16_bf16 a[0:15], a[160:163], v[220:223], a[0:15]
    ds_read_b64_tr_b16 a[228:229], v57 offset:24576
    ds_read_b64_tr_b16 a[230:231], v57 offset:26624
    v_mfma_f32_32x32x16_bf16 a[16:31], a[164:167], v[220:223], a[16:31]
    ds_read_b64_tr_b16 a[232:233], v58 offset:24576
    ds_read_b64_tr_b16 a[234:235], v58 offset:26624
    v_mfma_f32_32x32x16_bf16 a[32:47], a[168:171], v[220:223], a[32:47]
    ds_read_b64_tr_b16 a[236:237], v59 offset:24576
    ds_read_b64_tr_b16 a[238:239], v59 offset:26624
    v_mfma_f32_32x32x16_bf16 a[48:63], a[172:175], v[220:223], a[48:63]
    ds_read_b64_tr_b16 a[240:241], v56 offset:24832
    ds_read_b64_tr_b16 a[242:243], v56 offset:26880
    v_mfma_f32_32x32x16_bf16 a[64:79], a[176:179], v[220:223], a[64:79]
    ds_read_b64_tr_b16 a[244:245], v57 offset:24832
    ds_read_b64_tr_b16 a[246:247], v57 offset:26880
    v_mfma_f32_32x32x16_bf16 a[80:95], a[180:183], v[220:223], a[80:95]
    ds_read_b64_tr_b16 a[248:249], v58 offset:24832
    ds_read_b64_tr_b16 a[250:251], v58 offset:26880
    v_mfma_f32_32x32x16_bf16 a[96:111], a[184:187], v[220:223], a[96:111]
    ds_read_b64_tr_b16 a[252:253], v59 offset:24832
    ds_read_b64_tr_b16 a[254:255], v59 offset:26880
    v_mfma_f32_32x32x16_bf16 a[112:127], a[188:191], v[220:223], a[112:127]
    s_waitcnt vmcnt(12)
    s_waitcnt vmcnt(8)
    s_waitcnt lgkmcnt(0)
    s_barrier
    ds_read_b64_tr_b16 a[128:129], v56 offset:32768
    ds_read_b64_tr_b16 a[130:131], v56 offset:34816
    v_mfma_f32_32x32x16_bf16 a[0:15], a[192:195], v[224:227], a[0:15]
    ds_read_b64_tr_b16 a[132:133], v57 offset:32768
    ds_read_b64_tr_b16 a[134:135], v57 offset:34816
    v_mfma_f32_32x32x16_bf16 a[16:31], a[196:199], v[224:227], a[16:31]
    s_mov_b32 m0, s46
    s_nop 0
    buffer_load_dwordx4 v28, s[20:23], s37 offen offset:2048 lds
    ds_read_b64_tr_b16 a[136:137], v58 offset:32768
    ds_read_b64_tr_b16 a[138:139], v58 offset:34816
    v_mfma_f32_32x32x16_bf16 a[32:47], a[200:203], v[224:227], a[32:47]
    ds_read_b64_tr_b16 a[140:141], v59 offset:32768
    ds_read_b64_tr_b16 a[142:143], v59 offset:34816
    v_mfma_f32_32x32x16_bf16 a[48:63], a[204:207], v[224:227], a[48:63]
    s_mov_b32 m0, s46
    s_nop 0
    buffer_load_dwordx4 v29, s[20:23], s37 offen offset:3072 lds
    s_add_u32 s37, s37, 16384
    ds_read_b64_tr_b16 a[144:145], v56 offset:33024
    ds_read_b64_tr_b16 a[146:147], v56 offset:35072
    v_mfma_f32_32x32x16_bf16 a[64:79], a[208:211], v[224:227], a[64:79]
    ds_read_b64_tr_b16 a[148:149], v57 offset:33024
    ds_read_b64_tr_b16 a[150:151], v57 offset:35072
    v_mfma_f32_32x32x16_bf16 a[80:95], a[212:215], v[224:227], a[80:95]
    ds_read_b64_tr_b16 a[152:153], v58 offset:33024
    ds_read_b64_tr_b16 a[154:155], v58 offset:35072
    v_mfma_f32_32x32x16_bf16 a[96:111], a[216:219], v[224:227], a[96:111]
    ds_read_b64_tr_b16 a[156:157], v59 offset:33024
    ds_read_b64_tr_b16 a[158:159], v59 offset:35072
    v_mfma_f32_32x32x16_bf16 a[112:127], a[220:223], v[224:227], a[112:127]
    ds_read_b64_tr_b16 a[160:161], v56 offset:40960
    ds_read_b64_tr_b16 a[162:163], v56 offset:43008
    v_mfma_f32_32x32x16_bf16 a[0:15], a[224:227], v[228:231], a[0:15]
    ds_read_b64_tr_b16 a[164:165], v57 offset:40960
    ds_read_b64_tr_b16 a[166:167], v57 offset:43008
    v_mfma_f32_32x32x16_bf16 a[16:31], a[228:231], v[228:231], a[16:31]
    ds_read_b64_tr_b16 a[168:169], v58 offset:40960
    ds_read_b64_tr_b16 a[170:171], v58 offset:43008
    v_mfma_f32_32x32x16_bf16 a[32:47], a[232:235], v[228:231], a[32:47]
    ds_read_b64_tr_b16 a[172:173], v59 offset:40960
    ds_read_b64_tr_b16 a[174:175], v59 offset:43008
    v_mfma_f32_32x32x16_bf16 a[48:63], a[236:239], v[228:231], a[48:63]
    ds_read_b64_tr_b16 a[176:177], v56 offset:41216
    ds_read_b64_tr_b16 a[178:179], v56 offset:43264
    v_mfma_f32_32x32x16_bf16 a[64:79], a[240:243], v[228:231], a[64:79]
    ds_read_b64_tr_b16 a[180:181], v57 offset:41216
    ds_read_b64_tr_b16 a[182:183], v57 offset:43264
    v_mfma_f32_32x32x16_bf16 a[80:95], a[244:247], v[228:231], a[80:95]
    ds_read_b64_tr_b16 a[184:185], v58 offset:41216
    ds_read_b64_tr_b16 a[186:187], v58 offset:43264
    v_mfma_f32_32x32x16_bf16 a[96:111], a[248:251], v[228:231], a[96:111]
    ds_read_b64_tr_b16 a[188:189], v59 offset:41216
    ds_read_b64_tr_b16 a[190:191], v59 offset:43264
    v_mfma_f32_32x32x16_bf16 a[112:127], a[252:255], v[228:231], a[112:127]
    s_waitcnt vmcnt(8)
    s_waitcnt lgkmcnt(0)
    v_mfma_f32_32x32x16_bf16 a[0:15], a[128:131], v[232:235], a[0:15]
    v_mfma_f32_32x32x16_bf16 a[16:31], a[132:135], v[232:235], a[16:31]
    v_mfma_f32_32x32x16_bf16 a[32:47], a[136:139], v[232:235], a[32:47]
    v_mfma_f32_32x32x16_bf16 a[48:63], a[140:143], v[232:235], a[48:63]
    v_mfma_f32_32x32x16_bf16 a[64:79], a[144:147], v[232:235], a[64:79]
    v_mfma_f32_32x32x16_bf16 a[80:95], a[148:151], v[232:235], a[80:95]
    v_mfma_f32_32x32x16_bf16 a[96:111], a[152:155], v[232:235], a[96:111]
    v_mfma_f32_32x32x16_bf16 a[112:127], a[156:159], v[232:235], a[112:127]
    v_mfma_f32_32x32x16_bf16 a[0:15], a[160:163], v[236:239], a[0:15]
    v_mfma_f32_32x32x16_bf16 a[16:31], a[164:167], v[236:239], a[16:31]
    v_mfma_f32_32x32x16_bf16 a[32:47], a[168:171], v[236:239], a[32:47]
    v_mfma_f32_32x32x16_bf16 a[48:63], a[172:175], v[236:239], a[48:63]
    v_mfma_f32_32x32x16_bf16 a[64:79], a[176:179], v[236:239], a[64:79]
    v_mfma_f32_32x32x16_bf16 a[80:95], a[180:183], v[236:239], a[80:95]
    v_mfma_f32_32x32x16_bf16 a[96:111], a[184:187], v[236:239], a[96:111]
    v_mfma_f32_32x32x16_bf16 a[112:127], a[188:191], v[236:239], a[112:127]
    s_waitcnt vmcnt(4)
    s_barrier
    ds_read_b128 a[192:195], v8 offset:0
    ds_read_b128 a[196:199], v9 offset:0
    ds_read_b128 a[200:203], v10 offset:0
    ds_read_b128 a[204:207], v11 offset:0
    ds_read_b128 a[208:211], v12 offset:0
    ds_read_b128 a[212:215], v13 offset:0
    ds_read_b128 a[216:219], v14 offset:0
    ds_read_b128 a[220:223], v15 offset:0
    ds_read_b128 a[224:227], v8 offset:256
    ds_read_b128 a[228:231], v9 offset:256
    ds_read_b128 a[232:235], v10 offset:256
    ds_read_b128 a[236:239], v11 offset:256
    ds_read_b128 a[240:243], v12 offset:256
    ds_read_b128 a[244:247], v13 offset:256
    ds_read_b128 a[248:251], v14 offset:256
    ds_read_b128 a[252:255], v15 offset:256
    s_nop 7
    s_mov_b32 s14, 1035512379
    s_mov_b32 s15, 1035512379
    v_accvgpr_read_b32 v112, a0
    v_accvgpr_read_b32 v113, a1
    v_accvgpr_read_b32 v114, a2
    v_accvgpr_read_b32 v115, a3
    v_accvgpr_read_b32 v116, a4
    v_accvgpr_read_b32 v117, a5
    v_accvgpr_read_b32 v118, a6
    v_accvgpr_read_b32 v119, a7
    v_accvgpr_read_b32 v120, a8
    v_accvgpr_read_b32 v121, a9
    v_accvgpr_read_b32 v122, a10
    v_accvgpr_read_b32 v123, a11
    v_accvgpr_read_b32 v124, a12
    v_accvgpr_read_b32 v125, a13
    v_accvgpr_read_b32 v126, a14
    v_accvgpr_read_b32 v127, a15
    v_pk_mul_f32 v[112:113], v[112:113], s[14:15]
    v_pk_mul_f32 v[114:115], v[114:115], s[14:15]
    v_pk_mul_f32 v[116:117], v[116:117], s[14:15]
    v_pk_mul_f32 v[118:119], v[118:119], s[14:15]
    v_pk_mul_f32 v[120:121], v[120:121], s[14:15]
    v_pk_mul_f32 v[122:123], v[122:123], s[14:15]
    v_pk_mul_f32 v[124:125], v[124:125], s[14:15]
    v_pk_mul_f32 v[126:127], v[126:127], s[14:15]
    v_cvt_pk_bf16_f32 v96, v112, v113
    v_cvt_pk_bf16_f32 v97, v114, v115
    v_cvt_pk_bf16_f32 v98, v116, v117
    v_cvt_pk_bf16_f32 v99, v118, v119
    v_cvt_pk_bf16_f32 v100, v120, v121
    v_cvt_pk_bf16_f32 v101, v122, v123
    v_cvt_pk_bf16_f32 v102, v124, v125
    v_cvt_pk_bf16_f32 v103, v126, v127
    s_nop 1
    v_permlane32_swap_b32 v96, v98
    v_permlane32_swap_b32 v97, v99
    v_permlane32_swap_b32 v100, v102
    v_permlane32_swap_b32 v101, v103
    s_nop 1
    v_accvgpr_write_b32 a128, v96
    v_accvgpr_write_b32 a129, v97
    v_accvgpr_write_b32 a130, v98
    v_accvgpr_write_b32 a131, v99
    v_accvgpr_write_b32 a132, v100
    v_accvgpr_write_b32 a133, v101
    v_accvgpr_write_b32 a134, v102
    v_accvgpr_write_b32 a135, v103
    s_nop 1
    s_waitcnt lgkmcnt(15)
    v_mfma_f32_32x32x16_bf16 v[80:95], a[192:195], a[128:131], 0
    s_waitcnt lgkmcnt(14)
    v_mfma_f32_32x32x16_bf16 v[80:95], a[196:199], a[132:135], v[80:95]
    v_accvgpr_read_b32 v112, a16
    v_accvgpr_read_b32 v113, a17
    v_accvgpr_read_b32 v114, a18
    v_accvgpr_read_b32 v115, a19
    v_accvgpr_read_b32 v116, a20
    v_accvgpr_read_b32 v117, a21
    v_accvgpr_read_b32 v118, a22
    v_accvgpr_read_b32 v119, a23
    v_accvgpr_read_b32 v120, a24
    v_accvgpr_read_b32 v121, a25
    v_accvgpr_read_b32 v122, a26
    v_accvgpr_read_b32 v123, a27
    v_accvgpr_read_b32 v124, a28
    v_accvgpr_read_b32 v125, a29
    v_accvgpr_read_b32 v126, a30
    v_accvgpr_read_b32 v127, a31
    v_pk_mul_f32 v[112:113], v[112:113], s[14:15]
    v_pk_mul_f32 v[114:115], v[114:115], s[14:15]
    v_pk_mul_f32 v[116:117], v[116:117], s[14:15]
    v_pk_mul_f32 v[118:119], v[118:119], s[14:15]
    v_pk_mul_f32 v[120:121], v[120:121], s[14:15]
    v_pk_mul_f32 v[122:123], v[122:123], s[14:15]
    v_pk_mul_f32 v[124:125], v[124:125], s[14:15]
    v_pk_mul_f32 v[126:127], v[126:127], s[14:15]
    v_cvt_pk_bf16_f32 v96, v112, v113
    v_cvt_pk_bf16_f32 v97, v114, v115
    v_cvt_pk_bf16_f32 v98, v116, v117
    v_cvt_pk_bf16_f32 v99, v118, v119
    v_cvt_pk_bf16_f32 v100, v120, v121
    v_cvt_pk_bf16_f32 v101, v122, v123
    v_cvt_pk_bf16_f32 v102, v124, v125
    v_cvt_pk_bf16_f32 v103, v126, v127
    s_nop 1
    v_permlane32_swap_b32 v96, v98
    v_permlane32_swap_b32 v97, v99
    v_permlane32_swap_b32 v100, v102
    v_permlane32_swap_b32 v101, v103
    s_nop 1
    v_accvgpr_write_b32 a136, v96
    v_accvgpr_write_b32 a137, v97
    v_accvgpr_write_b32 a138, v98
    v_accvgpr_write_b32 a139, v99
    v_accvgpr_write_b32 a140, v100
    v_accvgpr_write_b32 a141, v101
    v_accvgpr_write_b32 a142, v102
    v_accvgpr_write_b32 a143, v103
    s_nop 1
    s_waitcnt lgkmcnt(13)
    v_mfma_f32_32x32x16_bf16 v[80:95], a[200:203], a[136:139], v[80:95]
    s_waitcnt lgkmcnt(12)
    v_mfma_f32_32x32x16_bf16 v[80:95], a[204:207], a[140:143], v[80:95]
    v_accvgpr_read_b32 v112, a32
    v_accvgpr_read_b32 v113, a33
    v_accvgpr_read_b32 v114, a34
    v_accvgpr_read_b32 v115, a35
    v_accvgpr_read_b32 v116, a36
    v_accvgpr_read_b32 v117, a37
    v_accvgpr_read_b32 v118, a38
    v_accvgpr_read_b32 v119, a39
    v_accvgpr_read_b32 v120, a40
    v_accvgpr_read_b32 v121, a41
    v_accvgpr_read_b32 v122, a42
    v_accvgpr_read_b32 v123, a43
    v_accvgpr_read_b32 v124, a44
    v_accvgpr_read_b32 v125, a45
    v_accvgpr_read_b32 v126, a46
    v_accvgpr_read_b32 v127, a47
    v_pk_mul_f32 v[112:113], v[112:113], s[14:15]
    v_pk_mul_f32 v[114:115], v[114:115], s[14:15]
    v_pk_mul_f32 v[116:117], v[116:117], s[14:15]
    v_pk_mul_f32 v[118:119], v[118:119], s[14:15]
    v_pk_mul_f32 v[120:121], v[120:121], s[14:15]
    v_pk_mul_f32 v[122:123], v[122:123], s[14:15]
    v_pk_mul_f32 v[124:125], v[124:125], s[14:15]
    v_pk_mul_f32 v[126:127], v[126:127], s[14:15]
    v_cvt_pk_bf16_f32 v96, v112, v113
    v_cvt_pk_bf16_f32 v97, v114, v115
    v_cvt_pk_bf16_f32 v98, v116, v117
    v_cvt_pk_bf16_f32 v99, v118, v119
    v_cvt_pk_bf16_f32 v100, v120, v121
    v_cvt_pk_bf16_f32 v101, v122, v123
    v_cvt_pk_bf16_f32 v102, v124, v125
    v_cvt_pk_bf16_f32 v103, v126, v127
    s_nop 1
    v_permlane32_swap_b32 v96, v98
    v_permlane32_swap_b32 v97, v99
    v_permlane32_swap_b32 v100, v102
    v_permlane32_swap_b32 v101, v103
    s_nop 1
    v_accvgpr_write_b32 a144, v96
    v_accvgpr_write_b32 a145, v97
    v_accvgpr_write_b32 a146, v98
    v_accvgpr_write_b32 a147, v99
    v_accvgpr_write_b32 a148, v100
    v_accvgpr_write_b32 a149, v101
    v_accvgpr_write_b32 a150, v102
    v_accvgpr_write_b32 a151, v103
    s_nop 1
    s_waitcnt lgkmcnt(11)
    v_mfma_f32_32x32x16_bf16 v[80:95], a[208:211], a[144:147], v[80:95]
    s_waitcnt lgkmcnt(10)
    v_mfma_f32_32x32x16_bf16 v[80:95], a[212:215], a[148:151], v[80:95]
    v_accvgpr_read_b32 v112, a48
    v_accvgpr_read_b32 v113, a49
    v_accvgpr_read_b32 v114, a50
    v_accvgpr_read_b32 v115, a51
    v_accvgpr_read_b32 v116, a52
    v_accvgpr_read_b32 v117, a53
    v_accvgpr_read_b32 v118, a54
    v_accvgpr_read_b32 v119, a55
    v_accvgpr_read_b32 v120, a56
    v_accvgpr_read_b32 v121, a57
    v_accvgpr_read_b32 v122, a58
    v_accvgpr_read_b32 v123, a59
    v_accvgpr_read_b32 v124, a60
    v_accvgpr_read_b32 v125, a61
    v_accvgpr_read_b32 v126, a62
    v_accvgpr_read_b32 v127, a63
    v_pk_mul_f32 v[112:113], v[112:113], s[14:15]
    v_pk_mul_f32 v[114:115], v[114:115], s[14:15]
    v_pk_mul_f32 v[116:117], v[116:117], s[14:15]
    v_pk_mul_f32 v[118:119], v[118:119], s[14:15]
    v_pk_mul_f32 v[120:121], v[120:121], s[14:15]
    v_pk_mul_f32 v[122:123], v[122:123], s[14:15]
    v_pk_mul_f32 v[124:125], v[124:125], s[14:15]
    v_pk_mul_f32 v[126:127], v[126:127], s[14:15]
    v_cvt_pk_bf16_f32 v96, v112, v113
    v_cvt_pk_bf16_f32 v97, v114, v115
    v_cvt_pk_bf16_f32 v98, v116, v117
    v_cvt_pk_bf16_f32 v99, v118, v119
    v_cvt_pk_bf16_f32 v100, v120, v121
    v_cvt_pk_bf16_f32 v101, v122, v123
    v_cvt_pk_bf16_f32 v102, v124, v125
    v_cvt_pk_bf16_f32 v103, v126, v127
    s_nop 1
    v_permlane32_swap_b32 v96, v98
    v_permlane32_swap_b32 v97, v99
    v_permlane32_swap_b32 v100, v102
    v_permlane32_swap_b32 v101, v103
    s_nop 1
    v_accvgpr_write_b32 a152, v96
    v_accvgpr_write_b32 a153, v97
    v_accvgpr_write_b32 a154, v98
    v_accvgpr_write_b32 a155, v99
    v_accvgpr_write_b32 a156, v100
    v_accvgpr_write_b32 a157, v101
    v_accvgpr_write_b32 a158, v102
    v_accvgpr_write_b32 a159, v103
    s_nop 1
    s_waitcnt lgkmcnt(9)
    v_mfma_f32_32x32x16_bf16 v[80:95], a[216:219], a[152:155], v[80:95]
    s_waitcnt lgkmcnt(8)
    v_mfma_f32_32x32x16_bf16 v[80:95], a[220:223], a[156:159], v[80:95]
    v_accvgpr_read_b32 v112, a64
    v_accvgpr_read_b32 v113, a65
    v_accvgpr_read_b32 v114, a66
    v_accvgpr_read_b32 v115, a67
    v_accvgpr_read_b32 v116, a68
    v_accvgpr_read_b32 v117, a69
    v_accvgpr_read_b32 v118, a70
    v_accvgpr_read_b32 v119, a71
    v_accvgpr_read_b32 v120, a72
    v_accvgpr_read_b32 v121, a73
    v_accvgpr_read_b32 v122, a74
    v_accvgpr_read_b32 v123, a75
    v_accvgpr_read_b32 v124, a76
    v_accvgpr_read_b32 v125, a77
    v_accvgpr_read_b32 v126, a78
    v_accvgpr_read_b32 v127, a79
    v_pk_mul_f32 v[112:113], v[112:113], s[14:15]
    v_pk_mul_f32 v[114:115], v[114:115], s[14:15]
    v_pk_mul_f32 v[116:117], v[116:117], s[14:15]
    v_pk_mul_f32 v[118:119], v[118:119], s[14:15]
    v_pk_mul_f32 v[120:121], v[120:121], s[14:15]
    v_pk_mul_f32 v[122:123], v[122:123], s[14:15]
    v_pk_mul_f32 v[124:125], v[124:125], s[14:15]
    v_pk_mul_f32 v[126:127], v[126:127], s[14:15]
    v_cvt_pk_bf16_f32 v96, v112, v113
    v_cvt_pk_bf16_f32 v97, v114, v115
    v_cvt_pk_bf16_f32 v98, v116, v117
    v_cvt_pk_bf16_f32 v99, v118, v119
    v_cvt_pk_bf16_f32 v100, v120, v121
    v_cvt_pk_bf16_f32 v101, v122, v123
    v_cvt_pk_bf16_f32 v102, v124, v125
    v_cvt_pk_bf16_f32 v103, v126, v127
    s_nop 1
    v_permlane32_swap_b32 v96, v98
    v_permlane32_swap_b32 v97, v99
    v_permlane32_swap_b32 v100, v102
    v_permlane32_swap_b32 v101, v103
    s_nop 1
    v_accvgpr_write_b32 a160, v96
    v_accvgpr_write_b32 a161, v97
    v_accvgpr_write_b32 a162, v98
    v_accvgpr_write_b32 a163, v99
    v_accvgpr_write_b32 a164, v100
    v_accvgpr_write_b32 a165, v101
    v_accvgpr_write_b32 a166, v102
    v_accvgpr_write_b32 a167, v103
    s_nop 1
    s_waitcnt lgkmcnt(7)
    v_mfma_f32_32x32x16_bf16 v[80:95], a[224:227], a[160:163], v[80:95]
    s_waitcnt lgkmcnt(6)
    v_mfma_f32_32x32x16_bf16 v[80:95], a[228:231], a[164:167], v[80:95]
    v_accvgpr_read_b32 v112, a80
    v_accvgpr_read_b32 v113, a81
    v_accvgpr_read_b32 v114, a82
    v_accvgpr_read_b32 v115, a83
    v_accvgpr_read_b32 v116, a84
    v_accvgpr_read_b32 v117, a85
    v_accvgpr_read_b32 v118, a86
    v_accvgpr_read_b32 v119, a87
    v_accvgpr_read_b32 v120, a88
    v_accvgpr_read_b32 v121, a89
    v_accvgpr_read_b32 v122, a90
    v_accvgpr_read_b32 v123, a91
    v_accvgpr_read_b32 v124, a92
    v_accvgpr_read_b32 v125, a93
    v_accvgpr_read_b32 v126, a94
    v_accvgpr_read_b32 v127, a95
    v_pk_mul_f32 v[112:113], v[112:113], s[14:15]
    v_pk_mul_f32 v[114:115], v[114:115], s[14:15]
    v_pk_mul_f32 v[116:117], v[116:117], s[14:15]
    v_pk_mul_f32 v[118:119], v[118:119], s[14:15]
    v_pk_mul_f32 v[120:121], v[120:121], s[14:15]
    v_pk_mul_f32 v[122:123], v[122:123], s[14:15]
    v_pk_mul_f32 v[124:125], v[124:125], s[14:15]
    v_pk_mul_f32 v[126:127], v[126:127], s[14:15]
    v_cvt_pk_bf16_f32 v96, v112, v113
    v_cvt_pk_bf16_f32 v97, v114, v115
    v_cvt_pk_bf16_f32 v98, v116, v117
    v_cvt_pk_bf16_f32 v99, v118, v119
    v_cvt_pk_bf16_f32 v100, v120, v121
    v_cvt_pk_bf16_f32 v101, v122, v123
    v_cvt_pk_bf16_f32 v102, v124, v125
    v_cvt_pk_bf16_f32 v103, v126, v127
    s_nop 1
    v_permlane32_swap_b32 v96, v98
    v_permlane32_swap_b32 v97, v99
    v_permlane32_swap_b32 v100, v102
    v_permlane32_swap_b32 v101, v103
    s_nop 1
    v_accvgpr_write_b32 a168, v96
    v_accvgpr_write_b32 a169, v97
    v_accvgpr_write_b32 a170, v98
    v_accvgpr_write_b32 a171, v99
    v_accvgpr_write_b32 a172, v100
    v_accvgpr_write_b32 a173, v101
    v_accvgpr_write_b32 a174, v102
    v_accvgpr_write_b32 a175, v103
    s_nop 1
    s_waitcnt lgkmcnt(5)
    v_mfma_f32_32x32x16_bf16 v[80:95], a[232:235], a[168:171], v[80:95]
    s_waitcnt lgkmcnt(4)
    v_mfma_f32_32x32x16_bf16 v[80:95], a[236:239], a[172:175], v[80:95]
    v_accvgpr_read_b32 v112, a96
    v_accvgpr_read_b32 v113, a97
    v_accvgpr_read_b32 v114, a98
    v_accvgpr_read_b32 v115, a99
    v_accvgpr_read_b32 v116, a100
    v_accvgpr_read_b32 v117, a101
    v_accvgpr_read_b32 v118, a102
    v_accvgpr_read_b32 v119, a103
    v_accvgpr_read_b32 v120, a104
    v_accvgpr_read_b32 v121, a105
    v_accvgpr_read_b32 v122, a106
    v_accvgpr_read_b32 v123, a107
    v_accvgpr_read_b32 v124, a108
    v_accvgpr_read_b32 v125, a109
    v_accvgpr_read_b32 v126, a110
    v_accvgpr_read_b32 v127, a111
    v_pk_mul_f32 v[112:113], v[112:113], s[14:15]
    v_pk_mul_f32 v[114:115], v[114:115], s[14:15]
    v_pk_mul_f32 v[116:117], v[116:117], s[14:15]
    v_pk_mul_f32 v[118:119], v[118:119], s[14:15]
    v_pk_mul_f32 v[120:121], v[120:121], s[14:15]
    v_pk_mul_f32 v[122:123], v[122:123], s[14:15]
    v_pk_mul_f32 v[124:125], v[124:125], s[14:15]
    v_pk_mul_f32 v[126:127], v[126:127], s[14:15]
    v_cvt_pk_bf16_f32 v96, v112, v113
    v_cvt_pk_bf16_f32 v97, v114, v115
    v_cvt_pk_bf16_f32 v98, v116, v117
    v_cvt_pk_bf16_f32 v99, v118, v119
    v_cvt_pk_bf16_f32 v100, v120, v121
    v_cvt_pk_bf16_f32 v101, v122, v123
    v_cvt_pk_bf16_f32 v102, v124, v125
    v_cvt_pk_bf16_f32 v103, v126, v127
    s_nop 1
    v_permlane32_swap_b32 v96, v98
    v_permlane32_swap_b32 v97, v99
    v_permlane32_swap_b32 v100, v102
    v_permlane32_swap_b32 v101, v103
    s_nop 1
    v_accvgpr_write_b32 a176, v96
    v_accvgpr_write_b32 a177, v97
    v_accvgpr_write_b32 a178, v98
    v_accvgpr_write_b32 a179, v99
    v_accvgpr_write_b32 a180, v100
    v_accvgpr_write_b32 a181, v101
    v_accvgpr_write_b32 a182, v102
    v_accvgpr_write_b32 a183, v103
    s_nop 1
    s_waitcnt lgkmcnt(3)
    v_mfma_f32_32x32x16_bf16 v[80:95], a[240:243], a[176:179], v[80:95]
    s_waitcnt lgkmcnt(2)
    v_mfma_f32_32x32x16_bf16 v[80:95], a[244:247], a[180:183], v[80:95]
    v_accvgpr_read_b32 v112, a112
    v_accvgpr_read_b32 v113, a113
    v_accvgpr_read_b32 v114, a114
    v_accvgpr_read_b32 v115, a115
    v_accvgpr_read_b32 v116, a116
    v_accvgpr_read_b32 v117, a117
    v_accvgpr_read_b32 v118, a118
    v_accvgpr_read_b32 v119, a119
    v_accvgpr_read_b32 v120, a120
    v_accvgpr_read_b32 v121, a121
    v_accvgpr_read_b32 v122, a122
    v_accvgpr_read_b32 v123, a123
    v_accvgpr_read_b32 v124, a124
    v_accvgpr_read_b32 v125, a125
    v_accvgpr_read_b32 v126, a126
    v_accvgpr_read_b32 v127, a127
    v_pk_mul_f32 v[112:113], v[112:113], s[14:15]
    v_pk_mul_f32 v[114:115], v[114:115], s[14:15]
    v_pk_mul_f32 v[116:117], v[116:117], s[14:15]
    v_pk_mul_f32 v[118:119], v[118:119], s[14:15]
    v_pk_mul_f32 v[120:121], v[120:121], s[14:15]
    v_pk_mul_f32 v[122:123], v[122:123], s[14:15]
    v_pk_mul_f32 v[124:125], v[124:125], s[14:15]
    v_pk_mul_f32 v[126:127], v[126:127], s[14:15]
    v_cvt_pk_bf16_f32 v96, v112, v113
    v_cvt_pk_bf16_f32 v97, v114, v115
    v_cvt_pk_bf16_f32 v98, v116, v117
    v_cvt_pk_bf16_f32 v99, v118, v119
    v_cvt_pk_bf16_f32 v100, v120, v121
    v_cvt_pk_bf16_f32 v101, v122, v123
    v_cvt_pk_bf16_f32 v102, v124, v125
    v_cvt_pk_bf16_f32 v103, v126, v127
    s_nop 1
    v_permlane32_swap_b32 v96, v98
    v_permlane32_swap_b32 v97, v99
    v_permlane32_swap_b32 v100, v102
    v_permlane32_swap_b32 v101, v103
    s_nop 1
    v_accvgpr_write_b32 a184, v96
    v_accvgpr_write_b32 a185, v97
    v_accvgpr_write_b32 a186, v98
    v_accvgpr_write_b32 a187, v99
    v_accvgpr_write_b32 a188, v100
    v_accvgpr_write_b32 a189, v101
    v_accvgpr_write_b32 a190, v102
    v_accvgpr_write_b32 a191, v103
    s_nop 1
    s_waitcnt lgkmcnt(1)
    v_mfma_f32_32x32x16_bf16 v[80:95], a[248:251], a[184:187], v[80:95]
    s_waitcnt lgkmcnt(0)
    v_mfma_f32_32x32x16_bf16 v[80:95], a[252:255], a[188:191], v[80:95]
    s_nop 15
    s_nop 3
    v_max3_f32 v42, v80, v81, v82
    v_max3_f32 v42, v42, v83, v84
    v_max3_f32 v42, v42, v85, v86
    v_max3_f32 v42, v42, v87, v88
    v_max3_f32 v42, v42, v89, v90
    v_max3_f32 v42, v42, v91, v92
    v_max3_f32 v42, v42, v93, v94
    v_max_f32 v42, v42, v95
    v_mov_b32 v43, v42
    s_nop 1
    v_permlane32_swap_b32 v43, v42
    s_nop 1
    v_max_f32 v42, v42, v43
    v_sub_f32 v80, v80, v42
    v_sub_f32 v64, 0, v42
    v_sub_f32 v81, v81, v42
    v_sub_f32 v65, 0, v42
    v_sub_f32 v82, v82, v42
    v_sub_f32 v66, 0, v42
    v_sub_f32 v83, v83, v42
    v_sub_f32 v67, 0, v42
    v_sub_f32 v84, v84, v42
    v_sub_f32 v68, 0, v42
    v_sub_f32 v85, v85, v42
    v_sub_f32 v69, 0, v42
    v_sub_f32 v86, v86, v42
    v_sub_f32 v70, 0, v42
    v_sub_f32 v87, v87, v42
    v_sub_f32 v71, 0, v42
    v_sub_f32 v88, v88, v42
    v_sub_f32 v72, 0, v42
    v_sub_f32 v89, v89, v42
    v_sub_f32 v73, 0, v42
    v_sub_f32 v90, v90, v42
    v_sub_f32 v74, 0, v42
    v_sub_f32 v91, v91, v42
    v_sub_f32 v75, 0, v42
    v_sub_f32 v92, v92, v42
    v_sub_f32 v76, 0, v42
    v_sub_f32 v93, v93, v42
    v_sub_f32 v77, 0, v42
    v_sub_f32 v94, v94, v42
    v_sub_f32 v78, 0, v42
    v_sub_f32 v95, v95, v42
    v_sub_f32 v79, 0, v42
    v_mov_b32 v34, 0
    s_barrier
    s_load_dwordx2 s[72:73], s[0:1], 56
    s_load_dwordx2 s[76:77], s[0:1], 32
    s_load_dwordx2 s[80:81], s[0:1], 48
    s_load_dwordx2 s[84:85], s[0:1], 72
    s_lshl_b32 s14, s2, 2
    s_add_u32 s14, s14, s3
    v_mov_b32 v6, 0x7fffff00
    s_waitcnt lgkmcnt(0)
    s_mov_b32 s74, 8388608
    s_mov_b32 s75, 0x00020000
    s_mul_i32 s15, s14, 8192
    v_lshlrev_b32 v56, 7, v1
    v_add_u32 v56, s15, v56
    s_mov_b32 s78, 3670016
    s_mov_b32 s79, 0x00020000
    s_mul_i32 s15, s14, 3584
    v_lshlrev_b32 v57, 7, v1
    v_add_u32 v57, s15, v57
    v_cmp_gt_u32 vcc, 28, v1
    s_nop 1
    v_cndmask_b32 v57, v6, v57, vcc
    s_mov_b32 s82, 1605632
    s_mov_b32 s83, 0x00020000
    s_mul_i32 s15, s14, 1664
    v_lshlrev_b32 v58, 7, v1
    v_add_u32 v58, s15, v58
    v_cmp_gt_u32 vcc, 13, v1
    s_nop 1
    v_cndmask_b32 v58, v6, v58, vcc
    s_mov_b32 s86, 802816
    s_mov_b32 s87, 0x00020000
    s_mul_i32 s15, s14, 896
    v_lshlrev_b32 v59, 7, v1
    v_add_u32 v59, s15, v59
    v_cmp_gt_u32 vcc, 7, v1
    s_nop 1
    v_cndmask_b32 v59, v6, v59, vcc
    s_mov_b32 s88, 0
    ds_read_b128 a[192:195], v8 offset:16384
    ds_read_b128 a[196:199], v9 offset:16384
    ds_read_b128 a[200:203], v10 offset:16384
    ds_read_b128 a[204:207], v11 offset:16384
    ds_read_b128 a[208:211], v12 offset:16384
    ds_read_b128 a[212:215], v13 offset:16384
    v_exp_f32 v38, v80
    v_exp_f32 v39, v81
    v_exp_f32 v40, v82
    s_waitcnt lgkmcnt(5)
    v_mfma_f32_32x32x16_bf16 v[96:111], a[192:195], a[128:131], v[64:79]
    ds_read_b128 a[216:219], v14 offset:16384
    v_exp_f32 v41, v83
    v_add_f32 v36, v38, v39
    s_waitcnt lgkmcnt(5)
    v_mfma_f32_32x32x16_bf16 v[96:111], a[196:199], a[132:135], v[96:111]
    ds_read_b128 a[220:223], v15 offset:16384
    v_cvt_pk_bf16_f32 v48, v38, v39
    v_exp_f32 v38, v84
    v_exp_f32 v39, v85
    s_waitcnt lgkmcnt(5)
    v_mfma_f32_32x32x16_bf16 v[96:111], a[200:203], a[136:139], v[96:111]
    ds_read_b128 a[224:227], v8 offset:16640
    v_add_f32 v37, v40, v41
    v_cvt_pk_bf16_f32 v49, v40, v41
    s_waitcnt lgkmcnt(5)
    v_mfma_f32_32x32x16_bf16 v[96:111], a[204:207], a[140:143], v[96:111]
    ds_read_b128 a[228:231], v9 offset:16640
    v_exp_f32 v40, v86
    v_exp_f32 v41, v87
    v_add_f32 v36, v36, v38
    s_waitcnt lgkmcnt(5)
    v_mfma_f32_32x32x16_bf16 v[96:111], a[208:211], a[144:147], v[96:111]
    ds_read_b128 a[232:235], v10 offset:16640
    v_add_f32 v37, v37, v39
    v_cvt_pk_bf16_f32 v50, v38, v39
    s_waitcnt lgkmcnt(5)
    v_mfma_f32_32x32x16_bf16 v[96:111], a[212:215], a[148:151], v[96:111]
    ds_read_b128 a[236:239], v11 offset:16640
    v_exp_f32 v38, v88
    v_exp_f32 v39, v89
    v_add_f32 v36, v36, v40
    s_waitcnt lgkmcnt(5)
    v_mfma_f32_32x32x16_bf16 v[96:111], a[216:219], a[152:155], v[96:111]
    ds_read_b128 a[240:243], v12 offset:16640
    v_add_f32 v37, v37, v41
    v_cvt_pk_bf16_f32 v51, v40, v41
    s_waitcnt lgkmcnt(5)
    v_mfma_f32_32x32x16_bf16 v[96:111], a[220:223], a[156:159], v[96:111]
    ds_read_b128 a[244:247], v13 offset:16640
    v_exp_f32 v40, v90
    v_exp_f32 v41, v91
    s_waitcnt lgkmcnt(5)
    v_mfma_f32_32x32x16_bf16 v[96:111], a[224:227], a[160:163], v[96:111]
    ds_read_b128 a[248:251], v14 offset:16640
    v_add_f32 v36, v36, v38
    v_add_f32 v37, v37, v39
    v_cvt_pk_bf16_f32 v52, v38, v39
    s_waitcnt lgkmcnt(5)
    v_mfma_f32_32x32x16_bf16 v[96:111], a[228:231], a[164:167], v[96:111]
    ds_read_b128 a[252:255], v15 offset:16640
    v_exp_f32 v38, v92
    v_exp_f32 v39, v93
    ds_read_b64_tr_b16 v[128:129], v16 offset:0
    ds_read_b64_tr_b16 v[130:131], v16 offset:4096
    s_waitcnt lgkmcnt(7)
    v_mfma_f32_32x32x16_bf16 v[96:111], a[232:235], a[168:171], v[96:111]
    v_add_f32 v36, v36, v40
    v_add_f32 v37, v37, v41
    v_cvt_pk_bf16_f32 v53, v40, v41
    ds_read_b64_tr_b16 v[132:133], v17 offset:0
    ds_read_b64_tr_b16 v[134:135], v17 offset:4096
    s_waitcnt lgkmcnt(8)
    v_mfma_f32_32x32x16_bf16 v[96:111], a[236:239], a[172:175], v[96:111]
    v_exp_f32 v40, v94
    v_exp_f32 v41, v95
    ds_read_b64_tr_b16 v[136:137], v18 offset:0
    ds_read_b64_tr_b16 v[138:139], v18 offset:4096
    s_waitcnt lgkmcnt(9)
    v_mfma_f32_32x32x16_bf16 v[96:111], a[240:243], a[176:179], v[96:111]
    v_add_f32 v36, v36, v38
    v_add_f32 v37, v37, v39
    v_cvt_pk_bf16_f32 v54, v38, v39
    ds_read_b64_tr_b16 v[140:141], v19 offset:0
    ds_read_b64_tr_b16 v[142:143], v19 offset:4096
    s_waitcnt lgkmcnt(10)
    v_mfma_f32_32x32x16_bf16 v[96:111], a[244:247], a[180:183], v[96:111]
    s_nop 0
    v_add_f32 v36, v36, v40
    ds_read_b64_tr_b16 v[144:145], v16 offset:256
    ds_read_b64_tr_b16 v[146:147], v16 offset:4352
    s_waitcnt lgkmcnt(11)
    v_mfma_f32_32x32x16_bf16 v[96:111], a[248:251], a[184:187], v[96:111]
    v_add_f32 v37, v37, v41
    v_cvt_pk_bf16_f32 v55, v40, v41
    ds_read_b64_tr_b16 v[148:149], v17 offset:256
    ds_read_b64_tr_b16 v[150:151], v17 offset:4352
    s_waitcnt lgkmcnt(12)
    v_mfma_f32_32x32x16_bf16 v[96:111], a[252:255], a[188:191], v[96:111]
    ds_read_b64_tr_b16 v[152:153], v18 offset:256
    ds_read_b64_tr_b16 v[154:155], v18 offset:4352
    v_add_f32 v35, v36, v37
    v_cmp_lt_f32 vcc, 1149239296, v35
    s_nop 1
    s_cbranch_vccnz L_front_slow_1
L_front_back_2:
    v_add_f32 v34, v34, v35
    s_waitcnt lgkmcnt(12)
    v_mfma_f32_32x32x16_bf16 a[0:15], v[128:131], v[48:51], 0
    ds_read_b64_tr_b16 v[156:157], v19 offset:256
    ds_read_b64_tr_b16 v[158:159], v19 offset:4352
    s_mov_b32 m0, s42
    s_nop 0
    s_waitcnt lgkmcnt(12)
    v_mfma_f32_32x32x16_bf16 a[16:31], v[132:135], v[48:51], 0
    ds_read_b64_tr_b16 v[160:161], v16 offset:8192
    buffer_load_dwordx4 v24, s[16:19], s36 offen offset:0 lds
    s_waitcnt lgkmcnt(11)
    v_mfma_f32_32x32x16_bf16 a[32:47], v[136:139], v[48:51], 0
    ds_read_b64_tr_b16 v[162:163], v16 offset:12288
    ds_read_b64_tr_b16 v[164:165], v17 offset:8192
    buffer_load_dwordx4 v25, s[16:19], s36 offen offset:1024 lds
    s_waitcnt lgkmcnt(11)
    v_mfma_f32_32x32x16_bf16 a[48:63], v[140:143], v[48:51], 0
    ds_read_b64_tr_b16 v[166:167], v17 offset:12288
    ds_read_b64_tr_b16 v[168:169], v18 offset:8192
    buffer_load_dwordx4 v26, s[16:19], s36 offen offset:2048 lds
    buffer_load_dwordx4 v27, s[16:19], s36 offen offset:3072 lds
    s_waitcnt lgkmcnt(11)
    v_mfma_f32_32x32x16_bf16 a[64:79], v[144:147], v[48:51], 0
    ds_read_b64_tr_b16 v[170:171], v18 offset:12288
    ds_read_b64_tr_b16 v[172:173], v19 offset:8192
    s_add_u32 s36, s36, 16384
    s_waitcnt lgkmcnt(11)
    v_mfma_f32_32x32x16_bf16 a[80:95], v[148:151], v[48:51], 0
    ds_read_b64_tr_b16 v[174:175], v19 offset:12288
    ds_read_b64_tr_b16 v[176:177], v16 offset:8448
    s_mov_b32 m0, s47
    s_waitcnt lgkmcnt(11)
    v_mfma_f32_32x32x16_bf16 a[96:111], v[152:155], v[48:51], 0
    ds_read_b64_tr_b16 v[178:179], v16 offset:12544
    ds_read_b64_tr_b16 v[180:181], v17 offset:8448
    s_nop 0
    s_waitcnt lgkmcnt(11)
    v_mfma_f32_32x32x16_bf16 a[112:127], v[156:159], v[48:51], 0
    ds_read_b64_tr_b16 v[182:183], v17 offset:12544
    ds_read_b64_tr_b16 v[184:185], v18 offset:8448
    buffer_load_dwordx4 v28, s[20:23], s37 offen offset:0 lds
    buffer_load_dwordx4 v29, s[20:23], s37 offen offset:1024 lds
    s_waitcnt lgkmcnt(11)
    v_mfma_f32_32x32x16_bf16 a[0:15], v[160:163], v[52:55], a[0:15]
    ds_read_b64_tr_b16 v[186:187], v18 offset:12544
    ds_read_b64_tr_b16 v[188:189], v19 offset:8448
    buffer_load_dwordx4 v28, s[20:23], s37 offen offset:2048 lds
    s_waitcnt lgkmcnt(11)
    v_mfma_f32_32x32x16_bf16 a[16:31], v[164:167], v[52:55], a[16:31]
    ds_read_b64_tr_b16 v[190:191], v19 offset:12544
    buffer_load_dwordx4 v29, s[20:23], s37 offen offset:3072 lds
    s_waitcnt lgkmcnt(10)
    v_mfma_f32_32x32x16_bf16 a[32:47], v[168:171], v[52:55], a[32:47]
    s_add_u32 s37, s37, 16384
    s_waitcnt lgkmcnt(8)
    v_mfma_f32_32x32x16_bf16 a[48:63], v[172:175], v[52:55], a[48:63]
    s_waitcnt vmcnt(8) lgkmcnt(0)
    s_barrier
    ds_read_b128 a[192:195], v8 offset:32768
    ds_read_b128 a[196:199], v9 offset:32768
    v_mfma_f32_32x32x16_bf16 a[64:79], v[176:179], v[52:55], a[64:79]
    ds_read_b128 a[200:203], v10 offset:32768
    v_exp_f32 v38, v96
    v_exp_f32 v39, v97
    v_exp_f32 v40, v98
    v_mfma_f32_32x32x16_bf16 a[80:95], v[180:183], v[52:55], a[80:95]
    ds_read_b128 a[204:207], v11 offset:32768
    v_exp_f32 v41, v99
    v_add_f32 v36, v38, v39
    v_mfma_f32_32x32x16_bf16 a[96:111], v[184:187], v[52:55], a[96:111]
    ds_read_b128 a[208:211], v12 offset:32768
    v_cvt_pk_bf16_f32 v48, v38, v39
    v_exp_f32 v38, v100
    v_mfma_f32_32x32x16_bf16 a[112:127], v[188:191], v[52:55], a[112:127]
    ds_read_b128 a[212:215], v13 offset:32768
    v_exp_f32 v39, v101
    v_add_f32 v37, v40, v41
    s_waitcnt lgkmcnt(5)
    v_mfma_f32_32x32x16_bf16 v[112:127], a[192:195], a[128:131], v[64:79]
    ds_read_b128 a[216:219], v14 offset:32768
    v_cvt_pk_bf16_f32 v49, v40, v41
    v_exp_f32 v40, v102
    s_waitcnt lgkmcnt(5)
    v_mfma_f32_32x32x16_bf16 v[112:127], a[196:199], a[132:135], v[112:127]
    ds_read_b128 a[220:223], v15 offset:32768
    v_exp_f32 v41, v103
    v_add_f32 v36, v36, v38
    s_waitcnt lgkmcnt(5)
    v_mfma_f32_32x32x16_bf16 v[112:127], a[200:203], a[136:139], v[112:127]
    ds_read_b128 a[224:227], v8 offset:33024
    v_add_f32 v37, v37, v39
    v_cvt_pk_bf16_f32 v50, v38, v39
    s_waitcnt lgkmcnt(5)
    v_mfma_f32_32x32x16_bf16 v[112:127], a[204:207], a[140:143], v[112:127]
    ds_read_b128 a[228:231], v9 offset:33024
    v_exp_f32 v38, v104
    v_exp_f32 v39, v105
    s_waitcnt lgkmcnt(5)
    v_mfma_f32_32x32x16_bf16 v[112:127], a[208:211], a[144:147], v[112:127]
    ds_read_b128 a[232:235], v10 offset:33024
    v_add_f32 v36, v36, v40
    v_add_f32 v37, v37, v41
    s_waitcnt lgkmcnt(5)
    v_mfma_f32_32x32x16_bf16 v[112:127], a[212:215], a[148:151], v[112:127]
    ds_read_b128 a[236:239], v11 offset:33024
    v_cvt_pk_bf16_f32 v51, v40, v41
    v_exp_f32 v40, v106
    s_waitcnt lgkmcnt(5)
    v_mfma_f32_32x32x16_bf16 v[112:127], a[216:219], a[152:155], v[112:127]
    ds_read_b128 a[240:243], v12 offset:33024
    v_exp_f32 v41, v107
    v_add_f32 v36, v36, v38
    s_waitcnt lgkmcnt(5)
    v_mfma_f32_32x32x16_bf16 v[112:127], a[220:223], a[156:159], v[112:127]
    ds_read_b128 a[244:247], v13 offset:33024
    v_add_f32 v37, v37, v39
    v_cvt_pk_bf16_f32 v52, v38, v39
    s_waitcnt lgkmcnt(5)
    v_mfma_f32_32x32x16_bf16 v[112:127], a[224:227], a[160:163], v[112:127]
    ds_read_b128 a[248:251], v14 offset:33024
    v_exp_f32 v38, v108
    v_exp_f32 v39, v109
    s_waitcnt lgkmcnt(5)
    v_mfma_f32_32x32x16_bf16 v[112:127], a[228:231], a[164:167], v[112:127]
    ds_read_b128 a[252:255], v15 offset:33024
    v_add_f32 v36, v36, v40
    v_add_f32 v37, v37, v41
    ds_read_b64_tr_b16 v[128:129], v16 offset:16384
    ds_read_b64_tr_b16 v[130:131], v16 offset:20480
    s_waitcnt lgkmcnt(7)
    v_mfma_f32_32x32x16_bf16 v[112:127], a[232:235], a[168:171], v[112:127]
    v_cvt_pk_bf16_f32 v53, v40, v41
    v_exp_f32 v40, v110
    ds_read_b64_tr_b16 v[132:133], v17 offset:16384
    ds_read_b64_tr_b16 v[134:135], v17 offset:20480
    s_waitcnt lgkmcnt(8)
    v_mfma_f32_32x32x16_bf16 v[112:127], a[236:239], a[172:175], v[112:127]
    v_exp_f32 v41, v111
    v_add_f32 v36, v36, v38
    ds_read_b64_tr_b16 v[136:137], v18 offset:16384
    ds_read_b64_tr_b16 v[138:139], v18 offset:20480
    s_waitcnt lgkmcnt(9)
    v_mfma_f32_32x32x16_bf16 v[112:127], a[240:243], a[176:179], v[112:127]
    v_add_f32 v37, v37, v39
    v_cvt_pk_bf16_f32 v54, v38, v39
    ds_read_b64_tr_b16 v[140:141], v19 offset:16384
    ds_read_b64_tr_b16 v[142:143], v19 offset:20480
    s_waitcnt lgkmcnt(10)
    v_mfma_f32_32x32x16_bf16 v[112:127], a[244:247], a[180:183], v[112:127]
    s_nop 0
    v_add_f32 v36, v36, v40
    ds_read_b64_tr_b16 v[144:145], v16 offset:16640
    ds_read_b64_tr_b16 v[146:147], v16 offset:20736
    s_waitcnt lgkmcnt(11)
    v_mfma_f32_32x32x16_bf16 v[112:127], a[248:251], a[184:187], v[112:127]
    v_add_f32 v37, v37, v41
    v_cvt_pk_bf16_f32 v55, v40, v41
    ds_read_b64_tr_b16 v[148:149], v17 offset:16640
    ds_read_b64_tr_b16 v[150:151], v17 offset:20736
    s_waitcnt lgkmcnt(12)
    v_mfma_f32_32x32x16_bf16 v[112:127], a[252:255], a[188:191], v[112:127]
    ds_read_b64_tr_b16 v[152:153], v18 offset:16640
    ds_read_b64_tr_b16 v[154:155], v18 offset:20736
    v_add_f32 v35, v36, v37
    v_cmp_lt_f32 vcc, 1149239296, v35
    s_nop 1
    s_cbranch_vccnz L_front_slow_3
L_front_back_4:
    v_add_f32 v34, v34, v35
    s_waitcnt lgkmcnt(12)
    v_mfma_f32_32x32x16_bf16 a[0:15], v[128:131], v[48:51], a[0:15]
    ds_read_b64_tr_b16 v[156:157], v19 offset:16640
    ds_read_b64_tr_b16 v[158:159], v19 offset:20736
    s_mov_b32 m0, s43
    s_nop 0
    s_waitcnt lgkmcnt(12)
    v_mfma_f32_32x32x16_bf16 a[16:31], v[132:135], v[48:51], a[16:31]
    ds_read_b64_tr_b16 v[160:161], v16 offset:24576
    buffer_load_dwordx4 v24, s[16:19], s36 offen offset:0 lds
    s_waitcnt lgkmcnt(11)
    v_mfma_f32_32x32x16_bf16 a[32:47], v[136:139], v[48:51], a[32:47]
    ds_read_b64_tr_b16 v[162:163], v16 offset:28672
    ds_read_b64_tr_b16 v[164:165], v17 offset:24576
    buffer_load_dwordx4 v25, s[16:19], s36 offen offset:1024 lds
    s_waitcnt lgkmcnt(11)
    v_mfma_f32_32x32x16_bf16 a[48:63], v[140:143], v[48:51], a[48:63]
    ds_read_b64_tr_b16 v[166:167], v17 offset:28672
    ds_read_b64_tr_b16 v[168:169], v18 offset:24576
    buffer_load_dwordx4 v26, s[16:19], s36 offen offset:2048 lds
    buffer_load_dwordx4 v27, s[16:19], s36 offen offset:3072 lds
    s_waitcnt lgkmcnt(11)
    v_mfma_f32_32x32x16_bf16 a[64:79], v[144:147], v[48:51], a[64:79]
    ds_read_b64_tr_b16 v[170:171], v18 offset:28672
    ds_read_b64_tr_b16 v[172:173], v19 offset:24576
    s_add_u32 s36, s36, 16384
    s_waitcnt lgkmcnt(11)
    v_mfma_f32_32x32x16_bf16 a[80:95], v[148:151], v[48:51], a[80:95]
    ds_read_b64_tr_b16 v[174:175], v19 offset:28672
    ds_read_b64_tr_b16 v[176:177], v16 offset:24832
    s_mov_b32 m0, s45
    s_waitcnt lgkmcnt(11)
    v_mfma_f32_32x32x16_bf16 a[96:111], v[152:155], v[48:51], a[96:111]
    ds_read_b64_tr_b16 v[178:179], v16 offset:28928
    ds_read_b64_tr_b16 v[180:181], v17 offset:24832
    s_nop 0
    s_waitcnt lgkmcnt(11)
    v_mfma_f32_32x32x16_bf16 a[112:127], v[156:159], v[48:51], a[112:127]
    ds_read_b64_tr_b16 v[182:183], v17 offset:28928
    ds_read_b64_tr_b16 v[184:185], v18 offset:24832
    buffer_load_dwordx4 v28, s[20:23], s37 offen offset:0 lds
    buffer_load_dwordx4 v29, s[20:23], s37 offen offset:1024 lds
    s_waitcnt lgkmcnt(11)
    v_mfma_f32_32x32x16_bf16 a[0:15], v[160:163], v[52:55], a[0:15]
    ds_read_b64_tr_b16 v[186:187], v18 offset:28928
    ds_read_b64_tr_b16 v[188:189], v19 offset:24832
    buffer_load_dwordx4 v28, s[20:23], s37 offen offset:2048 lds
    s_waitcnt lgkmcnt(11)
    v_mfma_f32_32x32x16_bf16 a[16:31], v[164:167], v[52:55], a[16:31]
    ds_read_b64_tr_b16 v[190:191], v19 offset:28928
    buffer_load_dwordx4 v29, s[20:23], s37 offen offset:3072 lds
    s_waitcnt lgkmcnt(10)
    v_mfma_f32_32x32x16_bf16 a[32:47], v[168:171], v[52:55], a[32:47]
    s_add_u32 s37, s37, 16384
    s_waitcnt lgkmcnt(8)
    v_mfma_f32_32x32x16_bf16 a[48:63], v[172:175], v[52:55], a[48:63]
    buffer_load_dword v7, v56, s[72:75], s88 offen
    buffer_load_dword v7, v57, s[76:79], s88 offen
    buffer_load_dword v7, v58, s[80:83], s88 offen
    buffer_load_dword v7, v59, s[84:87], s88 offen
    s_waitcnt vmcnt(12) lgkmcnt(0)
    s_barrier
    ds_read_b128 a[192:195], v8 offset:0
    ds_read_b128 a[196:199], v9 offset:0
    v_mfma_f32_32x32x16_bf16 a[64:79], v[176:179], v[52:55], a[64:79]
    ds_read_b128 a[200:203], v10 offset:0
    v_exp_f32 v38, v112
    v_exp_f32 v39, v113
    v_exp_f32 v40, v114
    v_mfma_f32_32x32x16_bf16 a[80:95], v[180:183], v[52:55], a[80:95]
    ds_read_b128 a[204:207], v11 offset:0
    v_exp_f32 v41, v115
    v_add_f32 v36, v38, v39
    v_mfma_f32_32x32x16_bf16 a[96:111], v[184:187], v[52:55], a[96:111]
    ds_read_b128 a[208:211], v12 offset:0
    v_cvt_pk_bf16_f32 v48, v38, v39
    v_exp_f32 v38, v116
    v_mfma_f32_32x32x16_bf16 a[112:127], v[188:191], v[52:55], a[112:127]
    ds_read_b128 a[212:215], v13 offset:0
    v_exp_f32 v39, v117
    v_add_f32 v37, v40, v41
    s_waitcnt lgkmcnt(5)
    v_mfma_f32_32x32x16_bf16 v[80:95], a[192:195], a[128:131], v[64:79]
    ds_read_b128 a[216:219], v14 offset:0
    v_cvt_pk_bf16_f32 v49, v40, v41
    v_exp_f32 v40, v118
    s_waitcnt lgkmcnt(5)
    v_mfma_f32_32x32x16_bf16 v[80:95], a[196:199], a[132:135], v[80:95]
    ds_read_b128 a[220:223], v15 offset:0
    v_exp_f32 v41, v119
    v_add_f32 v36, v36, v38
    s_waitcnt lgkmcnt(5)
    v_mfma_f32_32x32x16_bf16 v[80:95], a[200:203], a[136:139], v[80:95]
    ds_read_b128 a[224:227], v8 offset:256
    v_add_f32 v37, v37, v39
    v_cvt_pk_bf16_f32 v50, v38, v39
    s_waitcnt lgkmcnt(5)
    v_mfma_f32_32x32x16_bf16 v[80:95], a[204:207], a[140:143], v[80:95]
    ds_read_b128 a[228:231], v9 offset:256
    v_exp_f32 v38, v120
    v_exp_f32 v39, v121
    s_waitcnt lgkmcnt(5)
    v_mfma_f32_32x32x16_bf16 v[80:95], a[208:211], a[144:147], v[80:95]
    ds_read_b128 a[232:235], v10 offset:256
    v_add_f32 v36, v36, v40
    v_add_f32 v37, v37, v41
    s_waitcnt lgkmcnt(5)
    v_mfma_f32_32x32x16_bf16 v[80:95], a[212:215], a[148:151], v[80:95]
    ds_read_b128 a[236:239], v11 offset:256
    v_cvt_pk_bf16_f32 v51, v40, v41
    v_exp_f32 v40, v122
    s_waitcnt lgkmcnt(5)
    v_mfma_f32_32x32x16_bf16 v[80:95], a[216:219], a[152:155], v[80:95]
    ds_read_b128 a[240:243], v12 offset:256
    v_exp_f32 v41, v123
    v_add_f32 v36, v36, v38
    s_waitcnt lgkmcnt(5)
    v_mfma_f32_32x32x16_bf16 v[80:95], a[220:223], a[156:159], v[80:95]
    ds_read_b128 a[244:247], v13 offset:256
    v_add_f32 v37, v37, v39
    v_cvt_pk_bf16_f32 v52, v38, v39
    s_waitcnt lgkmcnt(5)
    v_mfma_f32_32x32x16_bf16 v[80:95], a[224:227], a[160:163], v[80:95]
    ds_read_b128 a[248:251], v14 offset:256
    v_exp_f32 v38, v124
    v_exp_f32 v39, v125
    s_waitcnt lgkmcnt(5)
    v_mfma_f32_32x32x16_bf16 v[80:95], a[228:231], a[164:167], v[80:95]
    ds_read_b128 a[252:255], v15 offset:256
    v_add_f32 v36, v36, v40
    v_add_f32 v37, v37, v41
    ds_read_b64_tr_b16 v[128:129], v16 offset:32768
    ds_read_b64_tr_b16 v[130:131], v16 offset:36864
    s_waitcnt lgkmcnt(7)
    v_mfma_f32_32x32x16_bf16 v[80:95], a[232:235], a[168:171], v[80:95]
    v_cvt_pk_bf16_f32 v53, v40, v41
    v_exp_f32 v40, v126
    ds_read_b64_tr_b16 v[132:133], v17 offset:32768
    ds_read_b64_tr_b16 v[134:135], v17 offset:36864
    s_waitcnt lgkmcnt(8)
    v_mfma_f32_32x32x16_bf16 v[80:95], a[236:239], a[172:175], v[80:95]
    v_exp_f32 v41, v127
    v_add_f32 v36, v36, v38
    ds_read_b64_tr_b16 v[136:137], v18 offset:32768
    ds_read_b64_tr_b16 v[138:139], v18 offset:36864
    s_waitcnt lgkmcnt(9)
    v_mfma_f32_32x32x16_bf16 v[80:95], a[240:243], a[176:179], v[80:95]
    v_add_f32 v37, v37, v39
    v_cvt_pk_bf16_f32 v54, v38, v39
    ds_read_b64_tr_b16 v[140:141], v19 offset:32768
    ds_read_b64_tr_b16 v[142:143], v19 offset:36864
    s_waitcnt lgkmcnt(10)
    v_mfma_f32_32x32x16_bf16 v[80:95], a[244:247], a[180:183], v[80:95]
    s_nop 0
    v_add_f32 v36, v36, v40
    ds_read_b64_tr_b16 v[144:145], v16 offset:33024
    ds_read_b64_tr_b16 v[146:147], v16 offset:37120
    s_waitcnt lgkmcnt(11)
    v_mfma_f32_32x32x16_bf16 v[80:95], a[248:251], a[184:187], v[80:95]
    v_add_f32 v37, v37, v41
    v_cvt_pk_bf16_f32 v55, v40, v41
    ds_read_b64_tr_b16 v[148:149], v17 offset:33024
    ds_read_b64_tr_b16 v[150:151], v17 offset:37120
    s_waitcnt lgkmcnt(12)
    v_mfma_f32_32x32x16_bf16 v[80:95], a[252:255], a[188:191], v[80:95]
    ds_read_b64_tr_b16 v[152:153], v18 offset:33024
    ds_read_b64_tr_b16 v[154:155], v18 offset:37120
    v_add_f32 v35, v36, v37
    v_cmp_lt_f32 vcc, 1149239296, v35
    s_nop 1
    s_cbranch_vccnz L_front_slow_5
L_front_back_6:
    v_add_f32 v34, v34, v35
    s_waitcnt lgkmcnt(12)
    v_mfma_f32_32x32x16_bf16 a[0:15], v[128:131], v[48:51], a[0:15]
    ds_read_b64_tr_b16 v[156:157], v19 offset:33024
    ds_read_b64_tr_b16 v[158:159], v19 offset:37120
    s_mov_b32 m0, s44
    s_nop 0
    s_waitcnt lgkmcnt(12)
    v_mfma_f32_32x32x16_bf16 a[16:31], v[132:135], v[48:51], a[16:31]
    ds_read_b64_tr_b16 v[160:161], v16 offset:40960
    buffer_load_dwordx4 v24, s[16:19], s36 offen offset:0 lds
    s_waitcnt lgkmcnt(11)
    v_mfma_f32_32x32x16_bf16 a[32:47], v[136:139], v[48:51], a[32:47]
    ds_read_b64_tr_b16 v[162:163], v16 offset:45056
    ds_read_b64_tr_b16 v[164:165], v17 offset:40960
    buffer_load_dwordx4 v25, s[16:19], s36 offen offset:1024 lds
    s_waitcnt lgkmcnt(11)
    v_mfma_f32_32x32x16_bf16 a[48:63], v[140:143], v[48:51], a[48:63]
    ds_read_b64_tr_b16 v[166:167], v17 offset:45056
    ds_read_b64_tr_b16 v[168:169], v18 offset:40960
    buffer_load_dwordx4 v26, s[16:19], s36 offen offset:2048 lds
    buffer_load_dwordx4 v27, s[16:19], s36 offen offset:3072 lds
    s_waitcnt lgkmcnt(11)
    v_mfma_f32_32x32x16_bf16 a[64:79], v[144:147], v[48:51], a[64:79]
    ds_read_b64_tr_b16 v[170:171], v18 offset:45056
    ds_read_b64_tr_b16 v[172:173], v19 offset:40960
    s_add_u32 s36, s36, 16384
    s_waitcnt lgkmcnt(11)
    v_mfma_f32_32x32x16_bf16 a[80:95], v[148:151], v[48:51], a[80:95]
    ds_read_b64_tr_b16 v[174:175], v19 offset:45056
    ds_read_b64_tr_b16 v[176:177], v16 offset:41216
    s_mov_b32 m0, s46
    s_waitcnt lgkmcnt(11)
    v_mfma_f32_32x32x16_bf16 a[96:111], v[152:155], v[48:51], a[96:111]
    ds_read_b64_tr_b16 v[178:179], v16 offset:45312
    ds_read_b64_tr_b16 v[180:181], v17 offset:41216
    s_nop 0
    s_waitcnt lgkmcnt(11)
    v_mfma_f32_32x32x16_bf16 a[112:127], v[156:159], v[48:51], a[112:127]
    ds_read_b64_tr_b16 v[182:183], v17 offset:45312
    ds_read_b64_tr_b16 v[184:185], v18 offset:41216
    buffer_load_dwordx4 v28, s[20:23], s37 offen offset:0 lds
    buffer_load_dwordx4 v29, s[20:23], s37 offen offset:1024 lds
    s_waitcnt lgkmcnt(11)
    v_mfma_f32_32x32x16_bf16 a[0:15], v[160:163], v[52:55], a[0:15]
    ds_read_b64_tr_b16 v[186:187], v18 offset:45312
    ds_read_b64_tr_b16 v[188:189], v19 offset:41216
    buffer_load_dwordx4 v28, s[20:23], s37 offen offset:2048 lds
    s_waitcnt lgkmcnt(11)
    v_mfma_f32_32x32x16_bf16 a[16:31], v[164:167], v[52:55], a[16:31]
    ds_read_b64_tr_b16 v[190:191], v19 offset:45312
    buffer_load_dwordx4 v29, s[20:23], s37 offen offset:3072 lds
    s_waitcnt lgkmcnt(10)
    v_mfma_f32_32x32x16_bf16 a[32:47], v[168:171], v[52:55], a[32:47]
    s_add_u32 s37, s37, 16384
    s_waitcnt lgkmcnt(8)
    v_mfma_f32_32x32x16_bf16 a[48:63], v[172:175], v[52:55], a[48:63]
    s_waitcnt vmcnt(12) lgkmcnt(0)
    s_barrier
    ds_read_b128 a[192:195], v8 offset:16384
    ds_read_b128 a[196:199], v9 offset:16384
    v_mfma_f32_32x32x16_bf16 a[64:79], v[176:179], v[52:55], a[64:79]
    ds_read_b128 a[200:203], v10 offset:16384
    v_exp_f32 v38, v80
    v_exp_f32 v39, v81
    v_exp_f32 v40, v82
    v_mfma_f32_32x32x16_bf16 a[80:95], v[180:183], v[52:55], a[80:95]
    ds_read_b128 a[204:207], v11 offset:16384
    v_exp_f32 v41, v83
    v_add_f32 v36, v38, v39
    v_mfma_f32_32x32x16_bf16 a[96:111], v[184:187], v[52:55], a[96:111]
    ds_read_b128 a[208:211], v12 offset:16384
    v_cvt_pk_bf16_f32 v48, v38, v39
    v_exp_f32 v38, v84
    v_mfma_f32_32x32x16_bf16 a[112:127], v[188:191], v[52:55], a[112:127]
    ds_read_b128 a[212:215], v13 offset:16384
    v_exp_f32 v39, v85
    v_add_f32 v37, v40, v41
    s_waitcnt lgkmcnt(5)
    v_mfma_f32_32x32x16_bf16 v[96:111], a[192:195], a[128:131], v[64:79]
    ds_read_b128 a[216:219], v14 offset:16384
    v_cvt_pk_bf16_f32 v49, v40, v41
    v_exp_f32 v40, v86
    s_waitcnt lgkmcnt(5)
    v_mfma_f32_32x32x16_bf16 v[96:111], a[196:199], a[132:135], v[96:111]
    ds_read_b128 a[220:223], v15 offset:16384
    v_exp_f32 v41, v87
    v_add_f32 v36, v36, v38
    s_waitcnt lgkmcnt(5)
    v_mfma_f32_32x32x16_bf16 v[96:111], a[200:203], a[136:139], v[96:111]
    ds_read_b128 a[224:227], v8 offset:16640
    v_add_f32 v37, v37, v39
    v_cvt_pk_bf16_f32 v50, v38, v39
    s_waitcnt lgkmcnt(5)
    v_mfma_f32_32x32x16_bf16 v[96:111], a[204:207], a[140:143], v[96:111]
    ds_read_b128 a[228:231], v9 offset:16640
    v_exp_f32 v38, v88
    v_exp_f32 v39, v89
    s_waitcnt lgkmcnt(5)
    v_mfma_f32_32x32x16_bf16 v[96:111], a[208:211], a[144:147], v[96:111]
    ds_read_b128 a[232:235], v10 offset:16640
    v_add_f32 v36, v36, v40
    v_add_f32 v37, v37, v41
    s_waitcnt lgkmcnt(5)
    v_mfma_f32_32x32x16_bf16 v[96:111], a[212:215], a[148:151], v[96:111]
    ds_read_b128 a[236:239], v11 offset:16640
    v_cvt_pk_bf16_f32 v51, v40, v41
    v_exp_f32 v40, v90
    s_waitcnt lgkmcnt(5)
    v_mfma_f32_32x32x16_bf16 v[96:111], a[216:219], a[152:155], v[96:111]
    ds_read_b128 a[240:243], v12 offset:16640
    v_exp_f32 v41, v91
    v_add_f32 v36, v36, v38
    s_waitcnt lgkmcnt(5)
    v_mfma_f32_32x32x16_bf16 v[96:111], a[220:223], a[156:159], v[96:111]
    ds_read_b128 a[244:247], v13 offset:16640
    v_add_f32 v37, v37, v39
    v_cvt_pk_bf16_f32 v52, v38, v39
    s_waitcnt lgkmcnt(5)
    v_mfma_f32_32x32x16_bf16 v[96:111], a[224:227], a[160:163], v[96:111]
    ds_read_b128 a[248:251], v14 offset:16640
    v_exp_f32 v38, v92
    v_exp_f32 v39, v93
    s_waitcnt lgkmcnt(5)
    v_mfma_f32_32x32x16_bf16 v[96:111], a[228:231], a[164:167], v[96:111]
    ds_read_b128 a[252:255], v15 offset:16640
    v_add_f32 v36, v36, v40
    v_add_f32 v37, v37, v41
    ds_read_b64_tr_b16 v[128:129], v16 offset:0
    ds_read_b64_tr_b16 v[130:131], v16 offset:4096
    s_waitcnt lgkmcnt(7)
    v_mfma_f32_32x32x16_bf16 v[96:111], a[232:235], a[168:171], v[96:111]
    v_cvt_pk_bf16_f32 v53, v40, v41
    v_exp_f32 v40, v94
    ds_read_b64_tr_b16 v[132:133], v17 offset:0
    ds_read_b64_tr_b16 v[134:135], v17 offset:4096
    s_waitcnt lgkmcnt(8)
    v_mfma_f32_32x32x16_bf16 v[96:111], a[236:239], a[172:175], v[96:111]
    v_exp_f32 v41, v95
    v_add_f32 v36, v36, v38
    ds_read_b64_tr_b16 v[136:137], v18 offset:0
    ds_read_b64_tr_b16 v[138:139], v18 offset:4096
    s_waitcnt lgkmcnt(9)
    v_mfma_f32_32x32x16_bf16 v[96:111], a[240:243], a[176:179], v[96:111]
    v_add_f32 v37, v37, v39
    v_cvt_pk_bf16_f32 v54, v38, v39
    ds_read_b64_tr_b16 v[140:141], v19 offset:0
    ds_read_b64_tr_b16 v[142:143], v19 offset:4096
    s_waitcnt lgkmcnt(10)
    v_mfma_f32_32x32x16_bf16 v[96:111], a[244:247], a[180:183], v[96:111]
    s_nop 0
    v_add_f32 v36, v36, v40
    ds_read_b64_tr_b16 v[144:145], v16 offset:256
    ds_read_b64_tr_b16 v[146:147], v16 offset:4352
    s_waitcnt lgkmcnt(11)
    v_mfma_f32_32x32x16_bf16 v[96:111], a[248:251], a[184:187], v[96:111]
    v_add_f32 v37, v37, v41
    v_cvt_pk_bf16_f32 v55, v40, v41
    ds_read_b64_tr_b16 v[148:149], v17 offset:256
    ds_read_b64_tr_b16 v[150:151], v17 offset:4352
    s_waitcnt lgkmcnt(12)
    v_mfma_f32_32x32x16_bf16 v[96:111], a[252:255], a[188:191], v[96:111]
    ds_read_b64_tr_b16 v[152:153], v18 offset:256
    ds_read_b64_tr_b16 v[154:155], v18 offset:4352
    v_add_f32 v35, v36, v37
    v_cmp_lt_f32 vcc, 1149239296, v35
    s_nop 1
    s_cbranch_vccnz L_front_slow_7
L_front_back_8:
    v_add_f32 v34, v34, v35
    s_waitcnt lgkmcnt(12)
    v_mfma_f32_32x32x16_bf16 a[0:15], v[128:131], v[48:51], a[0:15]
    ds_read_b64_tr_b16 v[156:157], v19 offset:256
    ds_read_b64_tr_b16 v[158:159], v19 offset:4352
    s_mov_b32 m0, s42
    s_nop 0
    s_waitcnt lgkmcnt(12)
    v_mfma_f32_32x32x16_bf16 a[16:31], v[132:135], v[48:51], a[16:31]
    ds_read_b64_tr_b16 v[160:161], v16 offset:8192
    buffer_load_dwordx4 v24, s[16:19], s36 offen offset:0 lds
    s_waitcnt lgkmcnt(11)
    v_mfma_f32_32x32x16_bf16 a[32:47], v[136:139], v[48:51], a[32:47]
    ds_read_b64_tr_b16 v[162:163], v16 offset:12288
    ds_read_b64_tr_b16 v[164:165], v17 offset:8192
    buffer_load_dwordx4 v25, s[16:19], s36 offen offset:1024 lds
    s_waitcnt lgkmcnt(11)
    v_mfma_f32_32x32x16_bf16 a[48:63], v[140:143], v[48:51], a[48:63]
    ds_read_b64_tr_b16 v[166:167], v17 offset:12288
    ds_read_b64_tr_b16 v[168:169], v18 offset:8192
    buffer_load_dwordx4 v26, s[16:19], s36 offen offset:2048 lds
    buffer_load_dwordx4 v27, s[16:19], s36 offen offset:3072 lds
    s_waitcnt lgkmcnt(11)
    v_mfma_f32_32x32x16_bf16 a[64:79], v[144:147], v[48:51], a[64:79]
    ds_read_b64_tr_b16 v[170:171], v18 offset:12288
    ds_read_b64_tr_b16 v[172:173], v19 offset:8192
    s_add_u32 s36, s36, 16384
    s_waitcnt lgkmcnt(11)
    v_mfma_f32_32x32x16_bf16 a[80:95], v[148:151], v[48:51], a[80:95]
    ds_read_b64_tr_b16 v[174:175], v19 offset:12288
    ds_read_b64_tr_b16 v[176:177], v16 offset:8448
    s_mov_b32 m0, s47
    s_waitcnt lgkmcnt(11)
    v_mfma_f32_32x32x16_bf16 a[96:111], v[152:155], v[48:51], a[96:111]
    ds_read_b64_tr_b16 v[178:179], v16 offset:12544
    ds_read_b64_tr_b16 v[180:181], v17 offset:8448
    s_nop 0
    s_waitcnt lgkmcnt(11)
    v_mfma_f32_32x32x16_bf16 a[112:127], v[156:159], v[48:51], a[112:127]
    ds_read_b64_tr_b16 v[182:183], v17 offset:12544
    ds_read_b64_tr_b16 v[184:185], v18 offset:8448
    buffer_load_dwordx4 v28, s[20:23], s37 offen offset:0 lds
    buffer_load_dwordx4 v29, s[20:23], s37 offen offset:1024 lds
    s_waitcnt lgkmcnt(11)
    v_mfma_f32_32x32x16_bf16 a[0:15], v[160:163], v[52:55], a[0:15]
    ds_read_b64_tr_b16 v[186:187], v18 offset:12544
    ds_read_b64_tr_b16 v[188:189], v19 offset:8448
    buffer_load_dwordx4 v28, s[20:23], s37 offen offset:2048 lds
    s_waitcnt lgkmcnt(11)
    v_mfma_f32_32x32x16_bf16 a[16:31], v[164:167], v[52:55], a[16:31]
    ds_read_b64_tr_b16 v[190:191], v19 offset:12544
    buffer_load_dwordx4 v29, s[20:23], s37 offen offset:3072 lds
    s_waitcnt lgkmcnt(10)
    v_mfma_f32_32x32x16_bf16 a[32:47], v[168:171], v[52:55], a[32:47]
    s_add_u32 s37, s37, 16384
    s_waitcnt lgkmcnt(8)
    v_mfma_f32_32x32x16_bf16 a[48:63], v[172:175], v[52:55], a[48:63]
    s_waitcnt vmcnt(8) lgkmcnt(0)
    s_barrier
    s_mov_b32 s38, 19
L_attn_loop:
    ds_read_b128 a[192:195], v8 offset:32768
    ds_read_b128 a[196:199], v9 offset:32768
    v_mfma_f32_32x32x16_bf16 a[64:79], v[176:179], v[52:55], a[64:79]
    ds_read_b128 a[200:203], v10 offset:32768
    v_exp_f32 v38, v96
    v_exp_f32 v39, v97
    v_exp_f32 v40, v98
    v_mfma_f32_32x32x16_bf16 a[80:95], v[180:183], v[52:55], a[80:95]
    ds_read_b128 a[204:207], v11 offset:32768
    v_exp_f32 v41, v99
    v_add_f32 v36, v38, v39
    v_mfma_f32_32x32x16_bf16 a[96:111], v[184:187], v[52:55], a[96:111]
    ds_read_b128 a[208:211], v12 offset:32768
    v_cvt_pk_bf16_f32 v48, v38, v39
    v_exp_f32 v38, v100
    v_mfma_f32_32x32x16_bf16 a[112:127], v[188:191], v[52:55], a[112:127]
    ds_read_b128 a[212:215], v13 offset:32768
    v_exp_f32 v39, v101
    v_add_f32 v37, v40, v41
    s_waitcnt lgkmcnt(5)
    v_mfma_f32_32x32x16_bf16 v[112:127], a[192:195], a[128:131], v[64:79]
    ds_read_b128 a[216:219], v14 offset:32768
    v_cvt_pk_bf16_f32 v49, v40, v41
    v_exp_f32 v40, v102
    s_waitcnt lgkmcnt(5)
    v_mfma_f32_32x32x16_bf16 v[112:127], a[196:199], a[132:135], v[112:127]
    ds_read_b128 a[220:223], v15 offset:32768
    v_exp_f32 v41, v103
    v_add_f32 v36, v36, v38
    s_waitcnt lgkmcnt(5)
    v_mfma_f32_32x32x16_bf16 v[112:127], a[200:203], a[136:139], v[112:127]
    ds_read_b128 a[224:227], v8 offset:33024
    v_add_f32 v37, v37, v39
    v_cvt_pk_bf16_f32 v50, v38, v39
    s_waitcnt lgkmcnt(5)
    v_mfma_f32_32x32x16_bf16 v[112:127], a[204:207], a[140:143], v[112:127]
    ds_read_b128 a[228:231], v9 offset:33024
    v_exp_f32 v38, v104
    v_exp_f32 v39, v105
    s_waitcnt lgkmcnt(5)
    v_mfma_f32_32x32x16_bf16 v[112:127], a[208:211], a[144:147], v[112:127]
    ds_read_b128 a[232:235], v10 offset:33024
    v_add_f32 v36, v36, v40
    v_add_f32 v37, v37, v41
    s_waitcnt lgkmcnt(5)
    v_mfma_f32_32x32x16_bf16 v[112:127], a[212:215], a[148:151], v[112:127]
    ds_read_b128 a[236:239], v11 offset:33024
    v_cvt_pk_bf16_f32 v51, v40, v41
    v_exp_f32 v40, v106
    s_waitcnt lgkmcnt(5)
    v_mfma_f32_32x32x16_bf16 v[112:127], a[216:219], a[152:155], v[112:127]
    ds_read_b128 a[240:243], v12 offset:33024
    v_exp_f32 v41, v107
    v_add_f32 v36, v36, v38
    s_waitcnt lgkmcnt(5)
    v_mfma_f32_32x32x16_bf16 v[112:127], a[220:223], a[156:159], v[112:127]
    ds_read_b128 a[244:247], v13 offset:33024
    v_add_f32 v37, v37, v39
    v_cvt_pk_bf16_f32 v52, v38, v39
    s_waitcnt lgkmcnt(5)
    v_mfma_f32_32x32x16_bf16 v[112:127], a[224:227], a[160:163], v[112:127]
    ds_read_b128 a[248:251], v14 offset:33024
    v_exp_f32 v38, v108
    v_exp_f32 v39, v109
    s_waitcnt lgkmcnt(5)
    v_mfma_f32_32x32x16_bf16 v[112:127], a[228:231], a[164:167], v[112:127]
    ds_read_b128 a[252:255], v15 offset:33024
    v_add_f32 v36, v36, v40
    v_add_f32 v37, v37, v41
    ds_read_b64_tr_b16 v[128:129], v16 offset:16384
    ds_read_b64_tr_b16 v[130:131], v16 offset:20480
    s_waitcnt lgkmcnt(7)
    v_mfma_f32_32x32x16_bf16 v[112:127], a[232:235], a[168:171], v[112:127]
    v_cvt_pk_bf16_f32 v53, v40, v41
    v_exp_f32 v40, v110
    ds_read_b64_tr_b16 v[132:133], v17 offset:16384
    ds_read_b64_tr_b16 v[134:135], v17 offset:20480
    s_waitcnt lgkmcnt(8)
    v_mfma_f32_32x32x16_bf16 v[112:127], a[236:239], a[172:175], v[112:127]
    v_exp_f32 v41, v111
    v_add_f32 v36, v36, v38
    ds_read_b64_tr_b16 v[136:137], v18 offset:16384
    ds_read_b64_tr_b16 v[138:139], v18 offset:20480
    s_waitcnt lgkmcnt(9)
    v_mfma_f32_32x32x16_bf16 v[112:127], a[240:243], a[176:179], v[112:127]
    v_add_f32 v37, v37, v39
    v_cvt_pk_bf16_f32 v54, v38, v39
    ds_read_b64_tr_b16 v[140:141], v19 offset:16384
    ds_read_b64_tr_b16 v[142:143], v19 offset:20480
    s_waitcnt lgkmcnt(10)
    v_mfma_f32_32x32x16_bf16 v[112:127], a[244:247], a[180:183], v[112:127]
    s_nop 0
    v_add_f32 v36, v36, v40
    ds_read_b64_tr_b16 v[144:145], v16 offset:16640
    ds_read_b64_tr_b16 v[146:147], v16 offset:20736
    s_waitcnt lgkmcnt(11)
    v_mfma_f32_32x32x16_bf16 v[112:127], a[248:251], a[184:187], v[112:127]
    v_add_f32 v37, v37, v41
    v_cvt_pk_bf16_f32 v55, v40, v41
    ds_read_b64_tr_b16 v[148:149], v17 offset:16640
    ds_read_b64_tr_b16 v[150:151], v17 offset:20736
    s_waitcnt lgkmcnt(12)
    v_mfma_f32_32x32x16_bf16 v[112:127], a[252:255], a[188:191], v[112:127]
    ds_read_b64_tr_b16 v[152:153], v18 offset:16640
    ds_read_b64_tr_b16 v[154:155], v18 offset:20736
    v_add_f32 v35, v36, v37
    v_cmp_lt_f32 vcc, 1149239296, v35
    s_nop 1
    s_cbranch_vccnz L_front_slow_9
L_front_back_10:
    v_add_f32 v34, v34, v35
    s_waitcnt lgkmcnt(12)
    v_mfma_f32_32x32x16_bf16 a[0:15], v[128:131], v[48:51], a[0:15]
    ds_read_b64_tr_b16 v[156:157], v19 offset:16640
    ds_read_b64_tr_b16 v[158:159], v19 offset:20736
    s_mov_b32 m0, s43
    s_nop 0
    s_waitcnt lgkmcnt(12)
    v_mfma_f32_32x32x16_bf16 a[16:31], v[132:135], v[48:51], a[16:31]
    ds_read_b64_tr_b16 v[160:161], v16 offset:24576
    buffer_load_dwordx4 v24, s[16:19], s36 offen offset:0 lds
    s_waitcnt lgkmcnt(11)
    v_mfma_f32_32x32x16_bf16 a[32:47], v[136:139], v[48:51], a[32:47]
    ds_read_b64_tr_b16 v[162:163], v16 offset:28672
    ds_read_b64_tr_b16 v[164:165], v17 offset:24576
    buffer_load_dwordx4 v25, s[16:19], s36 offen offset:1024 lds
    s_waitcnt lgkmcnt(11)
    v_mfma_f32_32x32x16_bf16 a[48:63], v[140:143], v[48:51], a[48:63]
    ds_read_b64_tr_b16 v[166:167], v17 offset:28672
    ds_read_b64_tr_b16 v[168:169], v18 offset:24576
    buffer_load_dwordx4 v26, s[16:19], s36 offen offset:2048 lds
    buffer_load_dwordx4 v27, s[16:19], s36 offen offset:3072 lds
    s_waitcnt lgkmcnt(11)
    v_mfma_f32_32x32x16_bf16 a[64:79], v[144:147], v[48:51], a[64:79]
    ds_read_b64_tr_b16 v[170:171], v18 offset:28672
    ds_read_b64_tr_b16 v[172:173], v19 offset:24576
    s_add_u32 s36, s36, 16384
    s_waitcnt lgkmcnt(11)
    v_mfma_f32_32x32x16_bf16 a[80:95], v[148:151], v[48:51], a[80:95]
    ds_read_b64_tr_b16 v[174:175], v19 offset:28672
    ds_read_b64_tr_b16 v[176:177], v16 offset:24832
    s_mov_b32 m0, s45
    s_waitcnt lgkmcnt(11)
    v_mfma_f32_32x32x16_bf16 a[96:111], v[152:155], v[48:51], a[96:111]
    ds_read_b64_tr_b16 v[178:179], v16 offset:28928
    ds_read_b64_tr_b16 v[180:181], v17 offset:24832
    s_nop 0
    s_waitcnt lgkmcnt(11)
    v_mfma_f32_32x32x16_bf16 a[112:127], v[156:159], v[48:51], a[112:127]
    ds_read_b64_tr_b16 v[182:183], v17 offset:28928
    ds_read_b64_tr_b16 v[184:185], v18 offset:24832
    buffer_load_dwordx4 v28, s[20:23], s37 offen offset:0 lds
    buffer_load_dwordx4 v29, s[20:23], s37 offen offset:1024 lds
    s_waitcnt lgkmcnt(11)
    v_mfma_f32_32x32x16_bf16 a[0:15], v[160:163], v[52:55], a[0:15]
    ds_read_b64_tr_b16 v[186:187], v18 offset:28928
    ds_read_b64_tr_b16 v[188:189], v19 offset:24832
    buffer_load_dwordx4 v28, s[20:23], s37 offen offset:2048 lds
    s_waitcnt lgkmcnt(11)
    v_mfma_f32_32x32x16_bf16 a[16:31], v[164:167], v[52:55], a[16:31]
    ds_read_b64_tr_b16 v[190:191], v19 offset:28928
    buffer_load_dwordx4 v29, s[20:23], s37 offen offset:3072 lds
    s_waitcnt lgkmcnt(10)
    v_mfma_f32_32x32x16_bf16 a[32:47], v[168:171], v[52:55], a[32:47]
    s_add_u32 s37, s37, 16384
    s_waitcnt lgkmcnt(8)
    v_mfma_f32_32x32x16_bf16 a[48:63], v[172:175], v[52:55], a[48:63]
    s_waitcnt vmcnt(8) lgkmcnt(0)
    s_barrier
    ds_read_b128 a[192:195], v8 offset:0
    ds_read_b128 a[196:199], v9 offset:0
    v_mfma_f32_32x32x16_bf16 a[64:79], v[176:179], v[52:55], a[64:79]
    ds_read_b128 a[200:203], v10 offset:0
    v_exp_f32 v38, v112
    v_exp_f32 v39, v113
    v_exp_f32 v40, v114
    v_mfma_f32_32x32x16_bf16 a[80:95], v[180:183], v[52:55], a[80:95]
    ds_read_b128 a[204:207], v11 offset:0
    v_exp_f32 v41, v115
    v_add_f32 v36, v38, v39
    v_mfma_f32_32x32x16_bf16 a[96:111], v[184:187], v[52:55], a[96:111]
    ds_read_b128 a[208:211], v12 offset:0
    v_cvt_pk_bf16_f32 v48, v38, v39
    v_exp_f32 v38, v116
    v_mfma_f32_32x32x16_bf16 a[112:127], v[188:191], v[52:55], a[112:127]
    ds_read_b128 a[212:215], v13 offset:0
    v_exp_f32 v39, v117
    v_add_f32 v37, v40, v41
    s_waitcnt lgkmcnt(5)
    v_mfma_f32_32x32x16_bf16 v[80:95], a[192:195], a[128:131], v[64:79]
    ds_read_b128 a[216:219], v14 offset:0
    v_cvt_pk_bf16_f32 v49, v40, v41
    v_exp_f32 v40, v118
    s_waitcnt lgkmcnt(5)
    v_mfma_f32_32x32x16_bf16 v[80:95], a[196:199], a[132:135], v[80:95]
    ds_read_b128 a[220:223], v15 offset:0
    v_exp_f32 v41, v119
    v_add_f32 v36, v36, v38
    s_waitcnt lgkmcnt(5)
    v_mfma_f32_32x32x16_bf16 v[80:95], a[200:203], a[136:139], v[80:95]
    ds_read_b128 a[224:227], v8 offset:256
    v_add_f32 v37, v37, v39
    v_cvt_pk_bf16_f32 v50, v38, v39
    s_waitcnt lgkmcnt(5)
    v_mfma_f32_32x32x16_bf16 v[80:95], a[204:207], a[140:143], v[80:95]
    ds_read_b128 a[228:231], v9 offset:256
    v_exp_f32 v38, v120
    v_exp_f32 v39, v121
    s_waitcnt lgkmcnt(5)
    v_mfma_f32_32x32x16_bf16 v[80:95], a[208:211], a[144:147], v[80:95]
    ds_read_b128 a[232:235], v10 offset:256
    v_add_f32 v36, v36, v40
    v_add_f32 v37, v37, v41
    s_waitcnt lgkmcnt(5)
    v_mfma_f32_32x32x16_bf16 v[80:95], a[212:215], a[148:151], v[80:95]
    ds_read_b128 a[236:239], v11 offset:256
    v_cvt_pk_bf16_f32 v51, v40, v41
    v_exp_f32 v40, v122
    s_waitcnt lgkmcnt(5)
    v_mfma_f32_32x32x16_bf16 v[80:95], a[216:219], a[152:155], v[80:95]
    ds_read_b128 a[240:243], v12 offset:256
    v_exp_f32 v41, v123
    v_add_f32 v36, v36, v38
    s_waitcnt lgkmcnt(5)
    v_mfma_f32_32x32x16_bf16 v[80:95], a[220:223], a[156:159], v[80:95]
    ds_read_b128 a[244:247], v13 offset:256
    v_add_f32 v37, v37, v39
    v_cvt_pk_bf16_f32 v52, v38, v39
    s_waitcnt lgkmcnt(5)
    v_mfma_f32_32x32x16_bf16 v[80:95], a[224:227], a[160:163], v[80:95]
    ds_read_b128 a[248:251], v14 offset:256
    v_exp_f32 v38, v124
    v_exp_f32 v39, v125
    s_waitcnt lgkmcnt(5)
    v_mfma_f32_32x32x16_bf16 v[80:95], a[228:231], a[164:167], v[80:95]
    ds_read_b128 a[252:255], v15 offset:256
    v_add_f32 v36, v36, v40
    v_add_f32 v37, v37, v41
    ds_read_b64_tr_b16 v[128:129], v16 offset:32768
    ds_read_b64_tr_b16 v[130:131], v16 offset:36864
    s_waitcnt lgkmcnt(7)
    v_mfma_f32_32x32x16_bf16 v[80:95], a[232:235], a[168:171], v[80:95]
    v_cvt_pk_bf16_f32 v53, v40, v41
    v_exp_f32 v40, v126
    ds_read_b64_tr_b16 v[132:133], v17 offset:32768
    ds_read_b64_tr_b16 v[134:135], v17 offset:36864
    s_waitcnt lgkmcnt(8)
    v_mfma_f32_32x32x16_bf16 v[80:95], a[236:239], a[172:175], v[80:95]
    v_exp_f32 v41, v127
    v_add_f32 v36, v36, v38
    ds_read_b64_tr_b16 v[136:137], v18 offset:32768
    ds_read_b64_tr_b16 v[138:139], v18 offset:36864
    s_waitcnt lgkmcnt(9)
    v_mfma_f32_32x32x16_bf16 v[80:95], a[240:243], a[176:179], v[80:95]
    v_add_f32 v37, v37, v39
    v_cvt_pk_bf16_f32 v54, v38, v39
    ds_read_b64_tr_b16 v[140:141], v19 offset:32768
    ds_read_b64_tr_b16 v[142:143], v19 offset:36864
    s_waitcnt lgkmcnt(10)
    v_mfma_f32_32x32x16_bf16 v[80:95], a[244:247], a[180:183], v[80:95]
    s_nop 0
    v_add_f32 v36, v36, v40
    ds_read_b64_tr_b16 v[144:145], v16 offset:33024
    ds_read_b64_tr_b16 v[146:147], v16 offset:37120
    s_waitcnt lgkmcnt(11)
    v_mfma_f32_32x32x16_bf16 v[80:95], a[248:251], a[184:187], v[80:95]
    v_add_f32 v37, v37, v41
    v_cvt_pk_bf16_f32 v55, v40, v41
    ds_read_b64_tr_b16 v[148:149], v17 offset:33024
    ds_read_b64_tr_b16 v[150:151], v17 offset:37120
    s_waitcnt lgkmcnt(12)
    v_mfma_f32_32x32x16_bf16 v[80:95], a[252:255], a[188:191], v[80:95]
    ds_read_b64_tr_b16 v[152:153], v18 offset:33024
    ds_read_b64_tr_b16 v[154:155], v18 offset:37120
    v_add_f32 v35, v36, v37
    v_cmp_lt_f32 vcc, 1149239296, v35
    s_nop 1
    s_cbranch_vccnz L_front_slow_11
L_front_back_12:
    v_add_f32 v34, v34, v35
    s_waitcnt lgkmcnt(12)
    v_mfma_f32_32x32x16_bf16 a[0:15], v[128:131], v[48:51], a[0:15]
    ds_read_b64_tr_b16 v[156:157], v19 offset:33024
    ds_read_b64_tr_b16 v[158:159], v19 offset:37120
    s_mov_b32 m0, s44
    s_nop 0
    s_waitcnt lgkmcnt(12)
    v_mfma_f32_32x32x16_bf16 a[16:31], v[132:135], v[48:51], a[16:31]
    ds_read_b64_tr_b16 v[160:161], v16 offset:40960
    buffer_load_dwordx4 v24, s[16:19], s36 offen offset:0 lds
    s_waitcnt lgkmcnt(11)
    v_mfma_f32_32x32x16_bf16 a[32:47], v[136:139], v[48:51], a[32:47]
    ds_read_b64_tr_b16 v[162:163], v16 offset:45056
    ds_read_b64_tr_b16 v[164:165], v17 offset:40960
    buffer_load_dwordx4 v25, s[16:19], s36 offen offset:1024 lds
    s_waitcnt lgkmcnt(11)
    v_mfma_f32_32x32x16_bf16 a[48:63], v[140:143], v[48:51], a[48:63]
    ds_read_b64_tr_b16 v[166:167], v17 offset:45056
    ds_read_b64_tr_b16 v[168:169], v18 offset:40960
    buffer_load_dwordx4 v26, s[16:19], s36 offen offset:2048 lds
    buffer_load_dwordx4 v27, s[16:19], s36 offen offset:3072 lds
    s_waitcnt lgkmcnt(11)
    v_mfma_f32_32x32x16_bf16 a[64:79], v[144:147], v[48:51], a[64:79]
    ds_read_b64_tr_b16 v[170:171], v18 offset:45056
    ds_read_b64_tr_b16 v[172:173], v19 offset:40960
    s_add_u32 s36, s36, 16384
    s_waitcnt lgkmcnt(11)
    v_mfma_f32_32x32x16_bf16 a[80:95], v[148:151], v[48:51], a[80:95]
    ds_read_b64_tr_b16 v[174:175], v19 offset:45056
    ds_read_b64_tr_b16 v[176:177], v16 offset:41216
    s_mov_b32 m0, s46
    s_waitcnt lgkmcnt(11)
    v_mfma_f32_32x32x16_bf16 a[96:111], v[152:155], v[48:51], a[96:111]
    ds_read_b64_tr_b16 v[178:179], v16 offset:45312
    ds_read_b64_tr_b16 v[180:181], v17 offset:41216
    s_nop 0
    s_waitcnt lgkmcnt(11)
    v_mfma_f32_32x32x16_bf16 a[112:127], v[156:159], v[48:51], a[112:127]
    ds_read_b64_tr_b16 v[182:183], v17 offset:45312
    ds_read_b64_tr_b16 v[184:185], v18 offset:41216
    buffer_load_dwordx4 v28, s[20:23], s37 offen offset:0 lds
    buffer_load_dwordx4 v29, s[20:23], s37 offen offset:1024 lds
    s_waitcnt lgkmcnt(11)
    v_mfma_f32_32x32x16_bf16 a[0:15], v[160:163], v[52:55], a[0:15]
    ds_read_b64_tr_b16 v[186:187], v18 offset:45312
    ds_read_b64_tr_b16 v[188:189], v19 offset:41216
    buffer_load_dwordx4 v28, s[20:23], s37 offen offset:2048 lds
    s_waitcnt lgkmcnt(11)
    v_mfma_f32_32x32x16_bf16 a[16:31], v[164:167], v[52:55], a[16:31]
    ds_read_b64_tr_b16 v[190:191], v19 offset:45312
    buffer_load_dwordx4 v29, s[20:23], s37 offen offset:3072 lds
    s_waitcnt lgkmcnt(10)
    v_mfma_f32_32x32x16_bf16 a[32:47], v[168:171], v[52:55], a[32:47]
    s_add_u32 s37, s37, 16384
    s_waitcnt lgkmcnt(8)
    v_mfma_f32_32x32x16_bf16 a[48:63], v[172:175], v[52:55], a[48:63]
    s_waitcnt vmcnt(8) lgkmcnt(0)
    s_barrier
    ds_read_b128 a[192:195], v8 offset:16384
    ds_read_b128 a[196:199], v9 offset:16384
    v_mfma_f32_32x32x16_bf16 a[64:79], v[176:179], v[52:55], a[64:79]
    ds_read_b128 a[200:203], v10 offset:16384
    v_exp_f32 v38, v80
    v_exp_f32 v39, v81
    v_exp_f32 v40, v82
    v_mfma_f32_32x32x16_bf16 a[80:95], v[180:183], v[52:55], a[80:95]
    ds_read_b128 a[204:207], v11 offset:16384
    v_exp_f32 v41, v83
    v_add_f32 v36, v38, v39
    v_mfma_f32_32x32x16_bf16 a[96:111], v[184:187], v[52:55], a[96:111]
    ds_read_b128 a[208:211], v12 offset:16384
    v_cvt_pk_bf16_f32 v48, v38, v39
    v_exp_f32 v38, v84
    v_mfma_f32_32x32x16_bf16 a[112:127], v[188:191], v[52:55], a[112:127]
    ds_read_b128 a[212:215], v13 offset:16384
    v_exp_f32 v39, v85
    v_add_f32 v37, v40, v41
    s_waitcnt lgkmcnt(5)
    v_mfma_f32_32x32x16_bf16 v[96:111], a[192:195], a[128:131], v[64:79]
    ds_read_b128 a[216:219], v14 offset:16384
    v_cvt_pk_bf16_f32 v49, v40, v41
    v_exp_f32 v40, v86
    s_waitcnt lgkmcnt(5)
    v_mfma_f32_32x32x16_bf16 v[96:111], a[196:199], a[132:135], v[96:111]
    ds_read_b128 a[220:223], v15 offset:16384
    v_exp_f32 v41, v87
    v_add_f32 v36, v36, v38
    s_waitcnt lgkmcnt(5)
    v_mfma_f32_32x32x16_bf16 v[96:111], a[200:203], a[136:139], v[96:111]
    ds_read_b128 a[224:227], v8 offset:16640
    v_add_f32 v37, v37, v39
    v_cvt_pk_bf16_f32 v50, v38, v39
    s_waitcnt lgkmcnt(5)
    v_mfma_f32_32x32x16_bf16 v[96:111], a[204:207], a[140:143], v[96:111]
    ds_read_b128 a[228:231], v9 offset:16640
    v_exp_f32 v38, v88
    v_exp_f32 v39, v89
    s_waitcnt lgkmcnt(5)
    v_mfma_f32_32x32x16_bf16 v[96:111], a[208:211], a[144:147], v[96:111]
    ds_read_b128 a[232:235], v10 offset:16640
    v_add_f32 v36, v36, v40
    v_add_f32 v37, v37, v41
    s_waitcnt lgkmcnt(5)
    v_mfma_f32_32x32x16_bf16 v[96:111], a[212:215], a[148:151], v[96:111]
    ds_read_b128 a[236:239], v11 offset:16640
    v_cvt_pk_bf16_f32 v51, v40, v41
    v_exp_f32 v40, v90
    s_waitcnt lgkmcnt(5)
    v_mfma_f32_32x32x16_bf16 v[96:111], a[216:219], a[152:155], v[96:111]
    ds_read_b128 a[240:243], v12 offset:16640
    v_exp_f32 v41, v91
    v_add_f32 v36, v36, v38
    s_waitcnt lgkmcnt(5)
    v_mfma_f32_32x32x16_bf16 v[96:111], a[220:223], a[156:159], v[96:111]
    ds_read_b128 a[244:247], v13 offset:16640
    v_add_f32 v37, v37, v39
    v_cvt_pk_bf16_f32 v52, v38, v39
    s_waitcnt lgkmcnt(5)
    v_mfma_f32_32x32x16_bf16 v[96:111], a[224:227], a[160:163], v[96:111]
    ds_read_b128 a[248:251], v14 offset:16640
    v_exp_f32 v38, v92
    v_exp_f32 v39, v93
    s_waitcnt lgkmcnt(5)
    v_mfma_f32_32x32x16_bf16 v[96:111], a[228:231], a[164:167], v[96:111]
    ds_read_b128 a[252:255], v15 offset:16640
    v_add_f32 v36, v36, v40
    v_add_f32 v37, v37, v41
    ds_read_b64_tr_b16 v[128:129], v16 offset:0
    ds_read_b64_tr_b16 v[130:131], v16 offset:4096
    s_waitcnt lgkmcnt(7)
    v_mfma_f32_32x32x16_bf16 v[96:111], a[232:235], a[168:171], v[96:111]
    v_cvt_pk_bf16_f32 v53, v40, v41
    v_exp_f32 v40, v94
    ds_read_b64_tr_b16 v[132:133], v17 offset:0
    ds_read_b64_tr_b16 v[134:135], v17 offset:4096
    s_waitcnt lgkmcnt(8)
    v_mfma_f32_32x32x16_bf16 v[96:111], a[236:239], a[172:175], v[96:111]
    v_exp_f32 v41, v95
    v_add_f32 v36, v36, v38
    ds_read_b64_tr_b16 v[136:137], v18 offset:0
    ds_read_b64_tr_b16 v[138:139], v18 offset:4096
    s_waitcnt lgkmcnt(9)
    v_mfma_f32_32x32x16_bf16 v[96:111], a[240:243], a[176:179], v[96:111]
    v_add_f32 v37, v37, v39
    v_cvt_pk_bf16_f32 v54, v38, v39
    ds_read_b64_tr_b16 v[140:141], v19 offset:0
    ds_read_b64_tr_b16 v[142:143], v19 offset:4096
    s_waitcnt lgkmcnt(10)
    v_mfma_f32_32x32x16_bf16 v[96:111], a[244:247], a[180:183], v[96:111]
    s_nop 0
    v_add_f32 v36, v36, v40
    ds_read_b64_tr_b16 v[144:145], v16 offset:256
    ds_read_b64_tr_b16 v[146:147], v16 offset:4352
    s_waitcnt lgkmcnt(11)
    v_mfma_f32_32x32x16_bf16 v[96:111], a[248:251], a[184:187], v[96:111]
    v_add_f32 v37, v37, v41
    v_cvt_pk_bf16_f32 v55, v40, v41
    ds_read_b64_tr_b16 v[148:149], v17 offset:256
    ds_read_b64_tr_b16 v[150:151], v17 offset:4352
    s_waitcnt lgkmcnt(12)
    v_mfma_f32_32x32x16_bf16 v[96:111], a[252:255], a[188:191], v[96:111]
    ds_read_b64_tr_b16 v[152:153], v18 offset:256
    ds_read_b64_tr_b16 v[154:155], v18 offset:4352
    v_add_f32 v35, v36, v37
    v_cmp_lt_f32 vcc, 1149239296, v35
    s_nop 1
    s_cbranch_vccnz L_front_slow_13
L_front_back_14:
    v_add_f32 v34, v34, v35
    s_waitcnt lgkmcnt(12)
    v_mfma_f32_32x32x16_bf16 a[0:15], v[128:131], v[48:51], a[0:15]
    ds_read_b64_tr_b16 v[156:157], v19 offset:256
    ds_read_b64_tr_b16 v[158:159], v19 offset:4352
    s_mov_b32 m0, s42
    s_nop 0
    s_waitcnt lgkmcnt(12)
    v_mfma_f32_32x32x16_bf16 a[16:31], v[132:135], v[48:51], a[16:31]
    ds_read_b64_tr_b16 v[160:161], v16 offset:8192
    buffer_load_dwordx4 v24, s[16:19], s36 offen offset:0 lds
    s_waitcnt lgkmcnt(11)
    v_mfma_f32_32x32x16_bf16 a[32:47], v[136:139], v[48:51], a[32:47]
    ds_read_b64_tr_b16 v[162:163], v16 offset:12288
    ds_read_b64_tr_b16 v[164:165], v17 offset:8192
    buffer_load_dwordx4 v25, s[16:19], s36 offen offset:1024 lds
    s_waitcnt lgkmcnt(11)
    v_mfma_f32_32x32x16_bf16 a[48:63], v[140:143], v[48:51], a[48:63]
    ds_read_b64_tr_b16 v[166:167], v17 offset:12288
    ds_read_b64_tr_b16 v[168:169], v18 offset:8192
    buffer_load_dwordx4 v26, s[16:19], s36 offen offset:2048 lds
    buffer_load_dwordx4 v27, s[16:19], s36 offen offset:3072 lds
    s_waitcnt lgkmcnt(11)
    v_mfma_f32_32x32x16_bf16 a[64:79], v[144:147], v[48:51], a[64:79]
    ds_read_b64_tr_b16 v[170:171], v18 offset:12288
    ds_read_b64_tr_b16 v[172:173], v19 offset:8192
    s_add_u32 s36, s36, 16384
    s_waitcnt lgkmcnt(11)
    v_mfma_f32_32x32x16_bf16 a[80:95], v[148:151], v[48:51], a[80:95]
    ds_read_b64_tr_b16 v[174:175], v19 offset:12288
    ds_read_b64_tr_b16 v[176:177], v16 offset:8448
    s_mov_b32 m0, s47
    s_waitcnt lgkmcnt(11)
    v_mfma_f32_32x32x16_bf16 a[96:111], v[152:155], v[48:51], a[96:111]
    ds_read_b64_tr_b16 v[178:179], v16 offset:12544
    ds_read_b64_tr_b16 v[180:181], v17 offset:8448
    s_nop 0
    s_waitcnt lgkmcnt(11)
    v_mfma_f32_32x32x16_bf16 a[112:127], v[156:159], v[48:51], a[112:127]
    ds_read_b64_tr_b16 v[182:183], v17 offset:12544
    ds_read_b64_tr_b16 v[184:185], v18 offset:8448
    buffer_load_dwordx4 v28, s[20:23], s37 offen offset:0 lds
    buffer_load_dwordx4 v29, s[20:23], s37 offen offset:1024 lds
    s_waitcnt lgkmcnt(11)
    v_mfma_f32_32x32x16_bf16 a[0:15], v[160:163], v[52:55], a[0:15]
    ds_read_b64_tr_b16 v[186:187], v18 offset:12544
    ds_read_b64_tr_b16 v[188:189], v19 offset:8448
    buffer_load_dwordx4 v28, s[20:23], s37 offen offset:2048 lds
    s_waitcnt lgkmcnt(11)
    v_mfma_f32_32x32x16_bf16 a[16:31], v[164:167], v[52:55], a[16:31]
    ds_read_b64_tr_b16 v[190:191], v19 offset:12544
    buffer_load_dwordx4 v29, s[20:23], s37 offen offset:3072 lds
    s_waitcnt lgkmcnt(10)
    v_mfma_f32_32x32x16_bf16 a[32:47], v[168:171], v[52:55], a[32:47]
    s_add_u32 s37, s37, 16384
    s_waitcnt lgkmcnt(8)
    v_mfma_f32_32x32x16_bf16 a[48:63], v[172:175], v[52:55], a[48:63]
    s_waitcnt vmcnt(8) lgkmcnt(0)
    s_barrier
    s_sub_u32 s38, s38, 1
    s_cmp_lg_u32 s38, 0
    s_cbranch_scc1 L_attn_loop
    ds_read_b128 a[192:195], v8 offset:32768
    ds_read_b128 a[196:199], v9 offset:32768
    v_mfma_f32_32x32x16_bf16 a[64:79], v[176:179], v[52:55], a[64:79]
    ds_read_b128 a[200:203], v10 offset:32768
    v_exp_f32 v38, v96
    v_exp_f32 v39, v97
    v_exp_f32 v40, v98
    v_mfma_f32_32x32x16_bf16 a[80:95], v[180:183], v[52:55], a[80:95]
    ds_read_b128 a[204:207], v11 offset:32768
    v_exp_f32 v41, v99
    v_add_f32 v36, v38, v39
    v_mfma_f32_32x32x16_bf16 a[96:111], v[184:187], v[52:55], a[96:111]
    ds_read_b128 a[208:211], v12 offset:32768
    v_cvt_pk_bf16_f32 v48, v38, v39
    v_exp_f32 v38, v100
    v_mfma_f32_32x32x16_bf16 a[112:127], v[188:191], v[52:55], a[112:127]
    ds_read_b128 a[212:215], v13 offset:32768
    v_exp_f32 v39, v101
    v_add_f32 v37, v40, v41
    s_waitcnt lgkmcnt(5)
    v_mfma_f32_32x32x16_bf16 v[112:127], a[192:195], a[128:131], v[64:79]
    ds_read_b128 a[216:219], v14 offset:32768
    v_cvt_pk_bf16_f32 v49, v40, v41
    v_exp_f32 v40, v102
    s_waitcnt lgkmcnt(5)
    v_mfma_f32_32x32x16_bf16 v[112:127], a[196:199], a[132:135], v[112:127]
    ds_read_b128 a[220:223], v15 offset:32768
    v_exp_f32 v41, v103
    v_add_f32 v36, v36, v38
    s_waitcnt lgkmcnt(5)
    v_mfma_f32_32x32x16_bf16 v[112:127], a[200:203], a[136:139], v[112:127]
    ds_read_b128 a[224:227], v8 offset:33024
    v_add_f32 v37, v37, v39
    v_cvt_pk_bf16_f32 v50, v38, v39
    s_waitcnt lgkmcnt(5)
    v_mfma_f32_32x32x16_bf16 v[112:127], a[204:207], a[140:143], v[112:127]
    ds_read_b128 a[228:231], v9 offset:33024
    v_exp_f32 v38, v104
    v_exp_f32 v39, v105
    s_waitcnt lgkmcnt(5)
    v_mfma_f32_32x32x16_bf16 v[112:127], a[208:211], a[144:147], v[112:127]
    ds_read_b128 a[232:235], v10 offset:33024
    v_add_f32 v36, v36, v40
    v_add_f32 v37, v37, v41
    s_waitcnt lgkmcnt(5)
    v_mfma_f32_32x32x16_bf16 v[112:127], a[212:215], a[148:151], v[112:127]
    ds_read_b128 a[236:239], v11 offset:33024
    v_cvt_pk_bf16_f32 v51, v40, v41
    v_exp_f32 v40, v106
    s_waitcnt lgkmcnt(5)
    v_mfma_f32_32x32x16_bf16 v[112:127], a[216:219], a[152:155], v[112:127]
    ds_read_b128 a[240:243], v12 offset:33024
    v_exp_f32 v41, v107
    v_add_f32 v36, v36, v38
    s_waitcnt lgkmcnt(5)
    v_mfma_f32_32x32x16_bf16 v[112:127], a[220:223], a[156:159], v[112:127]
    ds_read_b128 a[244:247], v13 offset:33024
    v_add_f32 v37, v37, v39
    v_cvt_pk_bf16_f32 v52, v38, v39
    s_waitcnt lgkmcnt(5)
    v_mfma_f32_32x32x16_bf16 v[112:127], a[224:227], a[160:163], v[112:127]
    ds_read_b128 a[248:251], v14 offset:33024
    v_exp_f32 v38, v108
    v_exp_f32 v39, v109
    s_waitcnt lgkmcnt(5)
    v_mfma_f32_32x32x16_bf16 v[112:127], a[228:231], a[164:167], v[112:127]
    ds_read_b128 a[252:255], v15 offset:33024
    v_add_f32 v36, v36, v40
    v_add_f32 v37, v37, v41
    ds_read_b64_tr_b16 v[128:129], v16 offset:16384
    ds_read_b64_tr_b16 v[130:131], v16 offset:20480
    s_waitcnt lgkmcnt(7)
    v_mfma_f32_32x32x16_bf16 v[112:127], a[232:235], a[168:171], v[112:127]
    v_cvt_pk_bf16_f32 v53, v40, v41
    v_exp_f32 v40, v110
    ds_read_b64_tr_b16 v[132:133], v17 offset:16384
    ds_read_b64_tr_b16 v[134:135], v17 offset:20480
    s_waitcnt lgkmcnt(8)
    v_mfma_f32_32x32x16_bf16 v[112:127], a[236:239], a[172:175], v[112:127]
    v_exp_f32 v41, v111
    v_add_f32 v36, v36, v38
    ds_read_b64_tr_b16 v[136:137], v18 offset:16384
    ds_read_b64_tr_b16 v[138:139], v18 offset:20480
    s_waitcnt lgkmcnt(9)
    v_mfma_f32_32x32x16_bf16 v[112:127], a[240:243], a[176:179], v[112:127]
    v_add_f32 v37, v37, v39
    v_cvt_pk_bf16_f32 v54, v38, v39
    ds_read_b64_tr_b16 v[140:141], v19 offset:16384
    ds_read_b64_tr_b16 v[142:143], v19 offset:20480
    s_waitcnt lgkmcnt(10)
    v_mfma_f32_32x32x16_bf16 v[112:127], a[244:247], a[180:183], v[112:127]
    s_nop 0
    v_add_f32 v36, v36, v40
    ds_read_b64_tr_b16 v[144:145], v16 offset:16640
    ds_read_b64_tr_b16 v[146:147], v16 offset:20736
    s_waitcnt lgkmcnt(11)
    v_mfma_f32_32x32x16_bf16 v[112:127], a[248:251], a[184:187], v[112:127]
    v_add_f32 v37, v37, v41
    v_cvt_pk_bf16_f32 v55, v40, v41
    ds_read_b64_tr_b16 v[148:149], v17 offset:16640
    ds_read_b64_tr_b16 v[150:151], v17 offset:20736
    s_waitcnt lgkmcnt(12)
    v_mfma_f32_32x32x16_bf16 v[112:127], a[252:255], a[188:191], v[112:127]
    ds_read_b64_tr_b16 v[152:153], v18 offset:16640
    ds_read_b64_tr_b16 v[154:155], v18 offset:20736
    v_add_f32 v35, v36, v37
    v_cmp_lt_f32 vcc, 1149239296, v35
    s_nop 1
    s_cbranch_vccnz L_front_slow_15
L_front_back_16:
    v_add_f32 v34, v34, v35
    s_waitcnt lgkmcnt(12)
    v_mfma_f32_32x32x16_bf16 a[0:15], v[128:131], v[48:51], a[0:15]
    ds_read_b64_tr_b16 v[156:157], v19 offset:16640
    ds_read_b64_tr_b16 v[158:159], v19 offset:20736
    s_mov_b32 m0, s45
    s_waitcnt lgkmcnt(12)
    v_mfma_f32_32x32x16_bf16 a[16:31], v[132:135], v[48:51], a[16:31]
    ds_read_b64_tr_b16 v[160:161], v16 offset:24576
    s_nop 0
    s_waitcnt lgkmcnt(11)
    v_mfma_f32_32x32x16_bf16 a[32:47], v[136:139], v[48:51], a[32:47]
    ds_read_b64_tr_b16 v[162:163], v16 offset:28672
    ds_read_b64_tr_b16 v[164:165], v17 offset:24576
    s_waitcnt lgkmcnt(11)
    v_mfma_f32_32x32x16_bf16 a[48:63], v[140:143], v[48:51], a[48:63]
    ds_read_b64_tr_b16 v[166:167], v17 offset:28672
    ds_read_b64_tr_b16 v[168:169], v18 offset:24576
    buffer_load_dwordx4 v28, s[20:23], s37 offen offset:0 lds
    s_waitcnt lgkmcnt(11)
    v_mfma_f32_32x32x16_bf16 a[64:79], v[144:147], v[48:51], a[64:79]
    ds_read_b64_tr_b16 v[170:171], v18 offset:28672
    ds_read_b64_tr_b16 v[172:173], v19 offset:24576
    buffer_load_dwordx4 v29, s[20:23], s37 offen offset:1024 lds
    s_waitcnt lgkmcnt(11)
    v_mfma_f32_32x32x16_bf16 a[80:95], v[148:151], v[48:51], a[80:95]
    ds_read_b64_tr_b16 v[174:175], v19 offset:28672
    ds_read_b64_tr_b16 v[176:177], v16 offset:24832
    s_waitcnt lgkmcnt(11)
    v_mfma_f32_32x32x16_bf16 a[96:111], v[152:155], v[48:51], a[96:111]
    ds_read_b64_tr_b16 v[178:179], v16 offset:28928
    ds_read_b64_tr_b16 v[180:181], v17 offset:24832
    buffer_load_dwordx4 v28, s[20:23], s37 offen offset:2048 lds
    s_waitcnt lgkmcnt(11)
    v_mfma_f32_32x32x16_bf16 a[112:127], v[156:159], v[48:51], a[112:127]
    ds_read_b64_tr_b16 v[182:183], v17 offset:28928
    ds_read_b64_tr_b16 v[184:185], v18 offset:24832
    buffer_load_dwordx4 v29, s[20:23], s37 offen offset:3072 lds
    s_waitcnt lgkmcnt(11)
    v_mfma_f32_32x32x16_bf16 a[0:15], v[160:163], v[52:55], a[0:15]
    ds_read_b64_tr_b16 v[186:187], v18 offset:28928
    ds_read_b64_tr_b16 v[188:189], v19 offset:24832
    s_waitcnt lgkmcnt(11)
    v_mfma_f32_32x32x16_bf16 a[16:31], v[164:167], v[52:55], a[16:31]
    ds_read_b64_tr_b16 v[190:191], v19 offset:28928
    s_add_u32 s37, s37, 16384
    s_waitcnt lgkmcnt(10)
    v_mfma_f32_32x32x16_bf16 a[32:47], v[168:171], v[52:55], a[32:47]
    s_waitcnt lgkmcnt(8)
    v_mfma_f32_32x32x16_bf16 a[48:63], v[172:175], v[52:55], a[48:63]
    s_waitcnt vmcnt(4) lgkmcnt(0)
    s_barrier
    ds_read_b128 a[192:195], v8 offset:0
    ds_read_b128 a[196:199], v9 offset:0
    v_mfma_f32_32x32x16_bf16 a[64:79], v[176:179], v[52:55], a[64:79]
    ds_read_b128 a[200:203], v10 offset:0
    v_exp_f32 v38, v112
    v_exp_f32 v39, v113
    v_exp_f32 v40, v114
    v_mfma_f32_32x32x16_bf16 a[80:95], v[180:183], v[52:55], a[80:95]
    ds_read_b128 a[204:207], v11 offset:0
    v_exp_f32 v41, v115
    v_add_f32 v36, v38, v39
    v_mfma_f32_32x32x16_bf16 a[96:111], v[184:187], v[52:55], a[96:111]
    ds_read_b128 a[208:211], v12 offset:0
    v_cvt_pk_bf16_f32 v48, v38, v39
    v_exp_f32 v38, v116
    v_mfma_f32_32x32x16_bf16 a[112:127], v[188:191], v[52:55], a[112:127]
    ds_read_b128 a[212:215], v13 offset:0
    v_exp_f32 v39, v117
    v_add_f32 v37, v40, v41
    s_waitcnt lgkmcnt(5)
    v_mfma_f32_32x32x16_bf16 v[80:95], a[192:195], a[128:131], v[64:79]
    ds_read_b128 a[216:219], v14 offset:0
    v_cvt_pk_bf16_f32 v49, v40, v41
    v_exp_f32 v40, v118
    s_waitcnt lgkmcnt(5)
    v_mfma_f32_32x32x16_bf16 v[80:95], a[196:199], a[132:135], v[80:95]
    ds_read_b128 a[220:223], v15 offset:0
    v_exp_f32 v41, v119
    v_add_f32 v36, v36, v38
    s_waitcnt lgkmcnt(5)
    v_mfma_f32_32x32x16_bf16 v[80:95], a[200:203], a[136:139], v[80:95]
    ds_read_b128 a[224:227], v8 offset:256
    v_add_f32 v37, v37, v39
    v_cvt_pk_bf16_f32 v50, v38, v39
    s_waitcnt lgkmcnt(5)
    v_mfma_f32_32x32x16_bf16 v[80:95], a[204:207], a[140:143], v[80:95]
    ds_read_b128 a[228:231], v9 offset:256
    v_exp_f32 v38, v120
    v_exp_f32 v39, v121
    s_waitcnt lgkmcnt(5)
    v_mfma_f32_32x32x16_bf16 v[80:95], a[208:211], a[144:147], v[80:95]
    ds_read_b128 a[232:235], v10 offset:256
    v_add_f32 v36, v36, v40
    v_add_f32 v37, v37, v41
    s_waitcnt lgkmcnt(5)
    v_mfma_f32_32x32x16_bf16 v[80:95], a[212:215], a[148:151], v[80:95]
    ds_read_b128 a[236:239], v11 offset:256
    v_cvt_pk_bf16_f32 v51, v40, v41
    v_exp_f32 v40, v122
    s_waitcnt lgkmcnt(5)
    v_mfma_f32_32x32x16_bf16 v[80:95], a[216:219], a[152:155], v[80:95]
    ds_read_b128 a[240:243], v12 offset:256
    v_exp_f32 v41, v123
    v_add_f32 v36, v36, v38
    s_waitcnt lgkmcnt(5)
    v_mfma_f32_32x32x16_bf16 v[80:95], a[220:223], a[156:159], v[80:95]
    ds_read_b128 a[244:247], v13 offset:256
    v_add_f32 v37, v37, v39
    v_cvt_pk_bf16_f32 v52, v38, v39
    s_waitcnt lgkmcnt(5)
    v_mfma_f32_32x32x16_bf16 v[80:95], a[224:227], a[160:163], v[80:95]
    ds_read_b128 a[248:251], v14 offset:256
    v_exp_f32 v38, v124
    v_exp_f32 v39, v125
    s_waitcnt lgkmcnt(5)
    v_mfma_f32_32x32x16_bf16 v[80:95], a[228:231], a[164:167], v[80:95]
    ds_read_b128 a[252:255], v15 offset:256
    v_add_f32 v36, v36, v40
    v_add_f32 v37, v37, v41
    ds_read_b64_tr_b16 v[128:129], v16 offset:32768
    ds_read_b64_tr_b16 v[130:131], v16 offset:36864
    s_waitcnt lgkmcnt(7)
    v_mfma_f32_32x32x16_bf16 v[80:95], a[232:235], a[168:171], v[80:95]
    v_cvt_pk_bf16_f32 v53, v40, v41
    v_exp_f32 v40, v126
    ds_read_b64_tr_b16 v[132:133], v17 offset:32768
    ds_read_b64_tr_b16 v[134:135], v17 offset:36864
    s_waitcnt lgkmcnt(8)
    v_mfma_f32_32x32x16_bf16 v[80:95], a[236:239], a[172:175], v[80:95]
    v_exp_f32 v41, v127
    v_add_f32 v36, v36, v38
    ds_read_b64_tr_b16 v[136:137], v18 offset:32768
    ds_read_b64_tr_b16 v[138:139], v18 offset:36864
    s_waitcnt lgkmcnt(9)
    v_mfma_f32_32x32x16_bf16 v[80:95], a[240:243], a[176:179], v[80:95]
    v_add_f32 v37, v37, v39
    v_cvt_pk_bf16_f32 v54, v38, v39
    ds_read_b64_tr_b16 v[140:141], v19 offset:32768
    ds_read_b64_tr_b16 v[142:143], v19 offset:36864
    s_waitcnt lgkmcnt(10)
    v_mfma_f32_32x32x16_bf16 v[80:95], a[244:247], a[180:183], v[80:95]
    s_nop 0
    v_add_f32 v36, v36, v40
    ds_read_b64_tr_b16 v[144:145], v16 offset:33024
    ds_read_b64_tr_b16 v[146:147], v16 offset:37120
    s_waitcnt lgkmcnt(11)
    v_mfma_f32_32x32x16_bf16 v[80:95], a[248:251], a[184:187], v[80:95]
    v_add_f32 v37, v37, v41
    v_cvt_pk_bf16_f32 v55, v40, v41
    ds_read_b64_tr_b16 v[148:149], v17 offset:33024
    ds_read_b64_tr_b16 v[150:151], v17 offset:37120
    s_waitcnt lgkmcnt(12)
    v_mfma_f32_32x32x16_bf16 v[80:95], a[252:255], a[188:191], v[80:95]
    ds_read_b64_tr_b16 v[152:153], v18 offset:33024
    ds_read_b64_tr_b16 v[154:155], v18 offset:37120
    v_add_f32 v35, v36, v37
    v_cmp_lt_f32 vcc, 1149239296, v35
    s_nop 1
    s_cbranch_vccnz L_front_slow_17
L_front_back_18:
    v_add_f32 v34, v34, v35
    s_waitcnt lgkmcnt(12)
    v_mfma_f32_32x32x16_bf16 a[0:15], v[128:131], v[48:51], a[0:15]
    ds_read_b64_tr_b16 v[156:157], v19 offset:33024
    ds_read_b64_tr_b16 v[158:159], v19 offset:37120
    s_waitcnt lgkmcnt(12)
    v_mfma_f32_32x32x16_bf16 a[16:31], v[132:135], v[48:51], a[16:31]
    ds_read_b64_tr_b16 v[160:161], v16 offset:40960
    s_waitcnt lgkmcnt(11)
    v_mfma_f32_32x32x16_bf16 a[32:47], v[136:139], v[48:51], a[32:47]
    ds_read_b64_tr_b16 v[162:163], v16 offset:45056
    ds_read_b64_tr_b16 v[164:165], v17 offset:40960
    s_waitcnt lgkmcnt(11)
    v_mfma_f32_32x32x16_bf16 a[48:63], v[140:143], v[48:51], a[48:63]
    ds_read_b64_tr_b16 v[166:167], v17 offset:45056
    ds_read_b64_tr_b16 v[168:169], v18 offset:40960
    s_waitcnt lgkmcnt(11)
    v_mfma_f32_32x32x16_bf16 a[64:79], v[144:147], v[48:51], a[64:79]
    ds_read_b64_tr_b16 v[170:171], v18 offset:45056
    ds_read_b64_tr_b16 v[172:173], v19 offset:40960
    s_waitcnt lgkmcnt(11)
    v_mfma_f32_32x32x16_bf16 a[80:95], v[148:151], v[48:51], a[80:95]
    ds_read_b64_tr_b16 v[174:175], v19 offset:45056
    ds_read_b64_tr_b16 v[176:177], v16 offset:41216
    s_waitcnt lgkmcnt(11)
    v_mfma_f32_32x32x16_bf16 a[96:111], v[152:155], v[48:51], a[96:111]
    ds_read_b64_tr_b16 v[178:179], v16 offset:45312
    ds_read_b64_tr_b16 v[180:181], v17 offset:41216
    s_waitcnt lgkmcnt(11)
    v_mfma_f32_32x32x16_bf16 a[112:127], v[156:159], v[48:51], a[112:127]
    ds_read_b64_tr_b16 v[182:183], v17 offset:45312
    ds_read_b64_tr_b16 v[184:185], v18 offset:41216
    s_waitcnt lgkmcnt(11)
    v_mfma_f32_32x32x16_bf16 a[0:15], v[160:163], v[52:55], a[0:15]
    ds_read_b64_tr_b16 v[186:187], v18 offset:45312
    ds_read_b64_tr_b16 v[188:189], v19 offset:41216
    s_waitcnt lgkmcnt(11)
    v_mfma_f32_32x32x16_bf16 a[16:31], v[164:167], v[52:55], a[16:31]
    ds_read_b64_tr_b16 v[190:191], v19 offset:45312
    s_waitcnt lgkmcnt(10)
    v_mfma_f32_32x32x16_bf16 a[32:47], v[168:171], v[52:55], a[32:47]
    s_waitcnt lgkmcnt(8)
    v_mfma_f32_32x32x16_bf16 a[48:63], v[172:175], v[52:55], a[48:63]
    s_waitcnt vmcnt(0) lgkmcnt(0)
    s_barrier
    v_exp_f32 v38, v80
    v_exp_f32 v39, v81
    v_exp_f32 v40, v82
    v_exp_f32 v41, v83
    v_add_f32 v36, v38, v39
    v_cvt_pk_bf16_f32 v48, v38, v39
    ds_read_b64_tr_b16 v[128:129], v16 offset:0
    ds_read_b64_tr_b16 v[130:131], v16 offset:4096
    ds_read_b64_tr_b16 v[132:133], v17 offset:0
    v_mfma_f32_32x32x16_bf16 a[64:79], v[176:179], v[52:55], a[64:79]
    v_exp_f32 v38, v84
    v_exp_f32 v39, v85
    v_add_f32 v37, v40, v41
    v_cvt_pk_bf16_f32 v49, v40, v41
    v_exp_f32 v40, v86
    v_exp_f32 v41, v87
    ds_read_b64_tr_b16 v[134:135], v17 offset:4096
    ds_read_b64_tr_b16 v[136:137], v18 offset:0
    v_mfma_f32_32x32x16_bf16 a[80:95], v[180:183], v[52:55], a[80:95]
    v_add_f32 v36, v36, v38
    v_add_f32 v37, v37, v39
    v_cvt_pk_bf16_f32 v50, v38, v39
    v_exp_f32 v38, v88
    v_exp_f32 v39, v89
    v_add_f32 v36, v36, v40
    ds_read_b64_tr_b16 v[138:139], v18 offset:4096
    ds_read_b64_tr_b16 v[140:141], v19 offset:0
    v_mfma_f32_32x32x16_bf16 a[96:111], v[184:187], v[52:55], a[96:111]
    v_add_f32 v37, v37, v41
    v_cvt_pk_bf16_f32 v51, v40, v41
    v_exp_f32 v40, v90
    v_exp_f32 v41, v91
    v_add_f32 v36, v36, v38
    v_add_f32 v37, v37, v39
    ds_read_b64_tr_b16 v[142:143], v19 offset:4096
    ds_read_b64_tr_b16 v[144:145], v16 offset:256
    v_mfma_f32_32x32x16_bf16 a[112:127], v[188:191], v[52:55], a[112:127]
    v_cvt_pk_bf16_f32 v52, v38, v39
    v_exp_f32 v38, v92
    v_exp_f32 v39, v93
    v_add_f32 v36, v36, v40
    v_add_f32 v37, v37, v41
    v_cvt_pk_bf16_f32 v53, v40, v41
    v_exp_f32 v40, v94
    v_exp_f32 v41, v95
    v_add_f32 v36, v36, v38
    v_add_f32 v37, v37, v39
    v_cvt_pk_bf16_f32 v54, v38, v39
    s_nop 0
    v_add_f32 v36, v36, v40
    v_add_f32 v37, v37, v41
    v_cvt_pk_bf16_f32 v55, v40, v41
    ds_read_b64_tr_b16 v[146:147], v16 offset:4352
    ds_read_b64_tr_b16 v[148:149], v17 offset:256
    v_add_f32 v35, v36, v37
    v_cmp_lt_f32 vcc, 1149239296, v35
    s_nop 1
    s_cbranch_vccnz L_front_slow_19
L_front_back_20:
    v_add_f32 v34, v34, v35
    s_waitcnt lgkmcnt(9)
    v_mfma_f32_32x32x16_bf16 a[0:15], v[128:131], v[48:51], a[0:15]
    ds_read_b64_tr_b16 v[150:151], v17 offset:4352
    ds_read_b64_tr_b16 v[152:153], v18 offset:256
    s_waitcnt lgkmcnt(9)
    v_mfma_f32_32x32x16_bf16 a[16:31], v[132:135], v[48:51], a[16:31]
    ds_read_b64_tr_b16 v[154:155], v18 offset:4352
    ds_read_b64_tr_b16 v[156:157], v19 offset:256
    s_waitcnt lgkmcnt(9)
    v_mfma_f32_32x32x16_bf16 a[32:47], v[136:139], v[48:51], a[32:47]
    ds_read_b64_tr_b16 v[158:159], v19 offset:4352
    ds_read_b64_tr_b16 v[160:161], v16 offset:8192
    ds_read_b64_tr_b16 v[162:163], v16 offset:12288
    s_waitcnt lgkmcnt(10)
    v_mfma_f32_32x32x16_bf16 a[48:63], v[140:143], v[48:51], a[48:63]
    ds_read_b64_tr_b16 v[164:165], v17 offset:8192
    ds_read_b64_tr_b16 v[166:167], v17 offset:12288
    s_waitcnt lgkmcnt(10)
    v_mfma_f32_32x32x16_bf16 a[64:79], v[144:147], v[48:51], a[64:79]
    ds_read_b64_tr_b16 v[168:169], v18 offset:8192
    ds_read_b64_tr_b16 v[170:171], v18 offset:12288
    s_waitcnt lgkmcnt(10)
    v_mfma_f32_32x32x16_bf16 a[80:95], v[148:151], v[48:51], a[80:95]
    ds_read_b64_tr_b16 v[172:173], v19 offset:8192
    ds_read_b64_tr_b16 v[174:175], v19 offset:12288
    s_waitcnt lgkmcnt(10)
    v_mfma_f32_32x32x16_bf16 a[96:111], v[152:155], v[48:51], a[96:111]
    ds_read_b64_tr_b16 v[176:177], v16 offset:8448
    ds_read_b64_tr_b16 v[178:179], v16 offset:12544
    s_waitcnt lgkmcnt(10)
    v_mfma_f32_32x32x16_bf16 a[112:127], v[156:159], v[48:51], a[112:127]
    ds_read_b64_tr_b16 v[180:181], v17 offset:8448
    ds_read_b64_tr_b16 v[182:183], v17 offset:12544
    s_waitcnt lgkmcnt(10)
    v_mfma_f32_32x32x16_bf16 a[0:15], v[160:163], v[52:55], a[0:15]
    ds_read_b64_tr_b16 v[184:185], v18 offset:8448
    ds_read_b64_tr_b16 v[186:187], v18 offset:12544
    s_waitcnt lgkmcnt(10)
    v_mfma_f32_32x32x16_bf16 a[16:31], v[164:167], v[52:55], a[16:31]
    ds_read_b64_tr_b16 v[188:189], v19 offset:8448
    ds_read_b64_tr_b16 v[190:191], v19 offset:12544
    s_waitcnt lgkmcnt(10)
    v_mfma_f32_32x32x16_bf16 a[32:47], v[168:171], v[52:55], a[32:47]
    s_waitcnt lgkmcnt(8)
    v_mfma_f32_32x32x16_bf16 a[48:63], v[172:175], v[52:55], a[48:63]
    s_waitcnt vmcnt(0) lgkmcnt(0)
    s_barrier
    v_mfma_f32_32x32x16_bf16 a[64:79], v[176:179], v[52:55], a[64:79]
    v_mfma_f32_32x32x16_bf16 a[80:95], v[180:183], v[52:55], a[80:95]
    v_mfma_f32_32x32x16_bf16 a[96:111], v[184:187], v[52:55], a[96:111]
    v_mfma_f32_32x32x16_bf16 a[112:127], v[188:191], v[52:55], a[112:127]
    v_mov_b32 v43, v34
    s_nop 1
    v_permlane32_swap_b32 v43, v34
    s_nop 1
    v_add_f32 v34, v34, v43
    v_rcp_f32 v44, v34
    s_nop 15
    s_nop 3
    v_accvgpr_read_b32 v80, a0
    v_accvgpr_read_b32 v81, a1
    v_accvgpr_read_b32 v82, a2
    v_accvgpr_read_b32 v83, a3
    v_accvgpr_read_b32 v84, a4
    v_accvgpr_read_b32 v85, a5
    v_accvgpr_read_b32 v86, a6
    v_accvgpr_read_b32 v87, a7
    v_accvgpr_read_b32 v88, a8
    v_accvgpr_read_b32 v89, a9
    v_accvgpr_read_b32 v90, a10
    v_accvgpr_read_b32 v91, a11
    v_accvgpr_read_b32 v92, a12
    v_accvgpr_read_b32 v93, a13
    v_accvgpr_read_b32 v94, a14
    v_accvgpr_read_b32 v95, a15
    v_mul_f32 v80, v44, v80
    v_mul_f32 v81, v44, v81
    v_mul_f32 v82, v44, v82
    v_mul_f32 v83, v44, v83
    v_mul_f32 v84, v44, v84
    v_mul_f32 v85, v44, v85
    v_mul_f32 v86, v44, v86
    v_mul_f32 v87, v44, v87
    v_mul_f32 v88, v44, v88
    v_mul_f32 v89, v44, v89
    v_mul_f32 v90, v44, v90
    v_mul_f32 v91, v44, v91
    v_mul_f32 v92, v44, v92
    v_mul_f32 v93, v44, v93
    v_mul_f32 v94, v44, v94
    v_mul_f32 v95, v44, v95
    v_cvt_pk_bf16_f32 v128, v80, v81
    v_cvt_pk_bf16_f32 v129, v82, v83
    v_cvt_pk_bf16_f32 v130, v84, v85
    v_cvt_pk_bf16_f32 v131, v86, v87
    v_cvt_pk_bf16_f32 v132, v88, v89
    v_cvt_pk_bf16_f32 v133, v90, v91
    v_cvt_pk_bf16_f32 v134, v92, v93
    v_cvt_pk_bf16_f32 v135, v94, v95
    s_nop 1
    v_permlane32_swap_b32 v128, v130
    v_permlane32_swap_b32 v129, v131
    v_permlane32_swap_b32 v132, v134
    v_permlane32_swap_b32 v133, v135
    s_nop 1
    buffer_store_dwordx4 v[128:131], v4, s[32:35], s48 offen offset:0
    buffer_store_dwordx4 v[132:135], v4, s[32:35], s48 offen offset:1024
    v_accvgpr_read_b32 v96, a16
    v_accvgpr_read_b32 v97, a17
    v_accvgpr_read_b32 v98, a18
    v_accvgpr_read_b32 v99, a19
    v_accvgpr_read_b32 v100, a20
    v_accvgpr_read_b32 v101, a21
    v_accvgpr_read_b32 v102, a22
    v_accvgpr_read_b32 v103, a23
    v_accvgpr_read_b32 v104, a24
    v_accvgpr_read_b32 v105, a25
    v_accvgpr_read_b32 v106, a26
    v_accvgpr_read_b32 v107, a27
    v_accvgpr_read_b32 v108, a28
    v_accvgpr_read_b32 v109, a29
    v_accvgpr_read_b32 v110, a30
    v_accvgpr_read_b32 v111, a31
    v_mul_f32 v96, v44, v96
    v_mul_f32 v97, v44, v97
    v_mul_f32 v98, v44, v98
    v_mul_f32 v99, v44, v99
    v_mul_f32 v100, v44, v100
    v_mul_f32 v101, v44, v101
    v_mul_f32 v102, v44, v102
    v_mul_f32 v103, v44, v103
    v_mul_f32 v104, v44, v104
    v_mul_f32 v105, v44, v105
    v_mul_f32 v106, v44, v106
    v_mul_f32 v107, v44, v107
    v_mul_f32 v108, v44, v108
    v_mul_f32 v109, v44, v109
    v_mul_f32 v110, v44, v110
    v_mul_f32 v111, v44, v111
    v_cvt_pk_bf16_f32 v136, v96, v97
    v_cvt_pk_bf16_f32 v137, v98, v99
    v_cvt_pk_bf16_f32 v138, v100, v101
    v_cvt_pk_bf16_f32 v139, v102, v103
    v_cvt_pk_bf16_f32 v140, v104, v105
    v_cvt_pk_bf16_f32 v141, v106, v107
    v_cvt_pk_bf16_f32 v142, v108, v109
    v_cvt_pk_bf16_f32 v143, v110, v111
    s_nop 1
    v_permlane32_swap_b32 v136, v138
    v_permlane32_swap_b32 v137, v139
    v_permlane32_swap_b32 v140, v142
    v_permlane32_swap_b32 v141, v143
    s_nop 1
    buffer_store_dwordx4 v[136:139], v4, s[32:35], s48 offen offset:2048
    buffer_store_dwordx4 v[140:143], v4, s[32:35], s48 offen offset:3072
    s_add_u32 s48, s48, 4096
    v_accvgpr_read_b32 v80, a32
    v_accvgpr_read_b32 v81, a33
    v_accvgpr_read_b32 v82, a34
    v_accvgpr_read_b32 v83, a35
    v_accvgpr_read_b32 v84, a36
    v_accvgpr_read_b32 v85, a37
    v_accvgpr_read_b32 v86, a38
    v_accvgpr_read_b32 v87, a39
    v_accvgpr_read_b32 v88, a40
    v_accvgpr_read_b32 v89, a41
    v_accvgpr_read_b32 v90, a42
    v_accvgpr_read_b32 v91, a43
    v_accvgpr_read_b32 v92, a44
    v_accvgpr_read_b32 v93, a45
    v_accvgpr_read_b32 v94, a46
    v_accvgpr_read_b32 v95, a47
    v_mul_f32 v80, v44, v80
    v_mul_f32 v81, v44, v81
    v_mul_f32 v82, v44, v82
    v_mul_f32 v83, v44, v83
    v_mul_f32 v84, v44, v84
    v_mul_f32 v85, v44, v85
    v_mul_f32 v86, v44, v86
    v_mul_f32 v87, v44, v87
    v_mul_f32 v88, v44, v88
    v_mul_f32 v89, v44, v89
    v_mul_f32 v90, v44, v90
    v_mul_f32 v91, v44, v91
    v_mul_f32 v92, v44, v92
    v_mul_f32 v93, v44, v93
    v_mul_f32 v94, v44, v94
    v_mul_f32 v95, v44, v95
    v_cvt_pk_bf16_f32 v144, v80, v81
    v_cvt_pk_bf16_f32 v145, v82, v83
    v_cvt_pk_bf16_f32 v146, v84, v85
    v_cvt_pk_bf16_f32 v147, v86, v87
    v_cvt_pk_bf16_f32 v148, v88, v89
    v_cvt_pk_bf16_f32 v149, v90, v91
    v_cvt_pk_bf16_f32 v150, v92, v93
    v_cvt_pk_bf16_f32 v151, v94, v95
    s_nop 1
    v_permlane32_swap_b32 v144, v146
    v_permlane32_swap_b32 v145, v147
    v_permlane32_swap_b32 v148, v150
    v_permlane32_swap_b32 v149, v151
    s_nop 1
    buffer_store_dwordx4 v[144:147], v4, s[32:35], s48 offen offset:0
    buffer_store_dwordx4 v[148:151], v4, s[32:35], s48 offen offset:1024
    v_accvgpr_read_b32 v96, a48
    v_accvgpr_read_b32 v97, a49
    v_accvgpr_read_b32 v98, a50
    v_accvgpr_read_b32 v99, a51
    v_accvgpr_read_b32 v100, a52
    v_accvgpr_read_b32 v101, a53
    v_accvgpr_read_b32 v102, a54
    v_accvgpr_read_b32 v103, a55
    v_accvgpr_read_b32 v104, a56
    v_accvgpr_read_b32 v105, a57
    v_accvgpr_read_b32 v106, a58
    v_accvgpr_read_b32 v107, a59
    v_accvgpr_read_b32 v108, a60
    v_accvgpr_read_b32 v109, a61
    v_accvgpr_read_b32 v110, a62
    v_accvgpr_read_b32 v111, a63
    v_mul_f32 v96, v44, v96
    v_mul_f32 v97, v44, v97
    v_mul_f32 v98, v44, v98
    v_mul_f32 v99, v44, v99
    v_mul_f32 v100, v44, v100
    v_mul_f32 v101, v44, v101
    v_mul_f32 v102, v44, v102
    v_mul_f32 v103, v44, v103
    v_mul_f32 v104, v44, v104
    v_mul_f32 v105, v44, v105
    v_mul_f32 v106, v44, v106
    v_mul_f32 v107, v44, v107
    v_mul_f32 v108, v44, v108
    v_mul_f32 v109, v44, v109
    v_mul_f32 v110, v44, v110
    v_mul_f32 v111, v44, v111
    v_cvt_pk_bf16_f32 v152, v96, v97
    v_cvt_pk_bf16_f32 v153, v98, v99
    v_cvt_pk_bf16_f32 v154, v100, v101
    v_cvt_pk_bf16_f32 v155, v102, v103
    v_cvt_pk_bf16_f32 v156, v104, v105
    v_cvt_pk_bf16_f32 v157, v106, v107
    v_cvt_pk_bf16_f32 v158, v108, v109
    v_cvt_pk_bf16_f32 v159, v110, v111
    s_nop 1
    v_permlane32_swap_b32 v152, v154
    v_permlane32_swap_b32 v153, v155
    v_permlane32_swap_b32 v156, v158
    v_permlane32_swap_b32 v157, v159
    s_nop 1
    buffer_store_dwordx4 v[152:155], v4, s[32:35], s48 offen offset:2048
    buffer_store_dwordx4 v[156:159], v4, s[32:35], s48 offen offset:3072
    s_add_u32 s48, s48, 4096
    v_accvgpr_read_b32 v80, a64
    v_accvgpr_read_b32 v81, a65
    v_accvgpr_read_b32 v82, a66
    v_accvgpr_read_b32 v83, a67
    v_accvgpr_read_b32 v84, a68
    v_accvgpr_read_b32 v85, a69
    v_accvgpr_read_b32 v86, a70
    v_accvgpr_read_b32 v87, a71
    v_accvgpr_read_b32 v88, a72
    v_accvgpr_read_b32 v89, a73
    v_accvgpr_read_b32 v90, a74
    v_accvgpr_read_b32 v91, a75
    v_accvgpr_read_b32 v92, a76
    v_accvgpr_read_b32 v93, a77
    v_accvgpr_read_b32 v94, a78
    v_accvgpr_read_b32 v95, a79
    v_mul_f32 v80, v44, v80
    v_mul_f32 v81, v44, v81
    v_mul_f32 v82, v44, v82
    v_mul_f32 v83, v44, v83
    v_mul_f32 v84, v44, v84
    v_mul_f32 v85, v44, v85
    v_mul_f32 v86, v44, v86
    v_mul_f32 v87, v44, v87
    v_mul_f32 v88, v44, v88
    v_mul_f32 v89, v44, v89
    v_mul_f32 v90, v44, v90
    v_mul_f32 v91, v44, v91
    v_mul_f32 v92, v44, v92
    v_mul_f32 v93, v44, v93
    v_mul_f32 v94, v44, v94
    v_mul_f32 v95, v44, v95
    v_cvt_pk_bf16_f32 v160, v80, v81
    v_cvt_pk_bf16_f32 v161, v82, v83
    v_cvt_pk_bf16_f32 v162, v84, v85
    v_cvt_pk_bf16_f32 v163, v86, v87
    v_cvt_pk_bf16_f32 v164, v88, v89
    v_cvt_pk_bf16_f32 v165, v90, v91
    v_cvt_pk_bf16_f32 v166, v92, v93
    v_cvt_pk_bf16_f32 v167, v94, v95
    s_nop 1
    v_permlane32_swap_b32 v160, v162
    v_permlane32_swap_b32 v161, v163
    v_permlane32_swap_b32 v164, v166
    v_permlane32_swap_b32 v165, v167
    s_nop 1
    buffer_store_dwordx4 v[160:163], v4, s[32:35], s48 offen offset:0
    buffer_store_dwordx4 v[164:167], v4, s[32:35], s48 offen offset:1024
    v_accvgpr_read_b32 v96, a80
    v_accvgpr_read_b32 v97, a81
    v_accvgpr_read_b32 v98, a82
    v_accvgpr_read_b32 v99, a83
    v_accvgpr_read_b32 v100, a84
    v_accvgpr_read_b32 v101, a85
    v_accvgpr_read_b32 v102, a86
    v_accvgpr_read_b32 v103, a87
    v_accvgpr_read_b32 v104, a88
    v_accvgpr_read_b32 v105, a89
    v_accvgpr_read_b32 v106, a90
    v_accvgpr_read_b32 v107, a91
    v_accvgpr_read_b32 v108, a92
    v_accvgpr_read_b32 v109, a93
    v_accvgpr_read_b32 v110, a94
    v_accvgpr_read_b32 v111, a95
    v_mul_f32 v96, v44, v96
    v_mul_f32 v97, v44, v97
    v_mul_f32 v98, v44, v98
    v_mul_f32 v99, v44, v99
    v_mul_f32 v100, v44, v100
    v_mul_f32 v101, v44, v101
    v_mul_f32 v102, v44, v102
    v_mul_f32 v103, v44, v103
    v_mul_f32 v104, v44, v104
    v_mul_f32 v105, v44, v105
    v_mul_f32 v106, v44, v106
    v_mul_f32 v107, v44, v107
    v_mul_f32 v108, v44, v108
    v_mul_f32 v109, v44, v109
    v_mul_f32 v110, v44, v110
    v_mul_f32 v111, v44, v111
    v_cvt_pk_bf16_f32 v168, v96, v97
    v_cvt_pk_bf16_f32 v169, v98, v99
    v_cvt_pk_bf16_f32 v170, v100, v101
    v_cvt_pk_bf16_f32 v171, v102, v103
    v_cvt_pk_bf16_f32 v172, v104, v105
    v_cvt_pk_bf16_f32 v173, v106, v107
    v_cvt_pk_bf16_f32 v174, v108, v109
    v_cvt_pk_bf16_f32 v175, v110, v111
    s_nop 1
    v_permlane32_swap_b32 v168, v170
    v_permlane32_swap_b32 v169, v171
    v_permlane32_swap_b32 v172, v174
    v_permlane32_swap_b32 v173, v175
    s_nop 1
    buffer_store_dwordx4 v[168:171], v4, s[32:35], s48 offen offset:2048
    buffer_store_dwordx4 v[172:175], v4, s[32:35], s48 offen offset:3072
    s_add_u32 s48, s48, 4096
    v_accvgpr_read_b32 v80, a96
    v_accvgpr_read_b32 v81, a97
    v_accvgpr_read_b32 v82, a98
    v_accvgpr_read_b32 v83, a99
    v_accvgpr_read_b32 v84, a100
    v_accvgpr_read_b32 v85, a101
    v_accvgpr_read_b32 v86, a102
    v_accvgpr_read_b32 v87, a103
    v_accvgpr_read_b32 v88, a104
    v_accvgpr_read_b32 v89, a105
    v_accvgpr_read_b32 v90, a106
    v_accvgpr_read_b32 v91, a107
    v_accvgpr_read_b32 v92, a108
    v_accvgpr_read_b32 v93, a109
    v_accvgpr_read_b32 v94, a110
    v_accvgpr_read_b32 v95, a111
    v_mul_f32 v80, v44, v80
    v_mul_f32 v81, v44, v81
    v_mul_f32 v82, v44, v82
    v_mul_f32 v83, v44, v83
    v_mul_f32 v84, v44, v84
    v_mul_f32 v85, v44, v85
    v_mul_f32 v86, v44, v86
    v_mul_f32 v87, v44, v87
    v_mul_f32 v88, v44, v88
    v_mul_f32 v89, v44, v89
    v_mul_f32 v90, v44, v90
    v_mul_f32 v91, v44, v91
    v_mul_f32 v92, v44, v92
    v_mul_f32 v93, v44, v93
    v_mul_f32 v94, v44, v94
    v_mul_f32 v95, v44, v95
    v_cvt_pk_bf16_f32 v176, v80, v81
    v_cvt_pk_bf16_f32 v177, v82, v83
    v_cvt_pk_bf16_f32 v178, v84, v85
    v_cvt_pk_bf16_f32 v179, v86, v87
    v_cvt_pk_bf16_f32 v180, v88, v89
    v_cvt_pk_bf16_f32 v181, v90, v91
    v_cvt_pk_bf16_f32 v182, v92, v93
    v_cvt_pk_bf16_f32 v183, v94, v95
    s_nop 1
    v_permlane32_swap_b32 v176, v178
    v_permlane32_swap_b32 v177, v179
    v_permlane32_swap_b32 v180, v182
    v_permlane32_swap_b32 v181, v183
    s_nop 1
    buffer_store_dwordx4 v[176:179], v4, s[32:35], s48 offen offset:0
    buffer_store_dwordx4 v[180:183], v4, s[32:35], s48 offen offset:1024
    v_accvgpr_read_b32 v96, a112
    v_accvgpr_read_b32 v97, a113
    v_accvgpr_read_b32 v98, a114
    v_accvgpr_read_b32 v99, a115
    v_accvgpr_read_b32 v100, a116
    v_accvgpr_read_b32 v101, a117
    v_accvgpr_read_b32 v102, a118
    v_accvgpr_read_b32 v103, a119
    v_accvgpr_read_b32 v104, a120
    v_accvgpr_read_b32 v105, a121
    v_accvgpr_read_b32 v106, a122
    v_accvgpr_read_b32 v107, a123
    v_accvgpr_read_b32 v108, a124
    v_accvgpr_read_b32 v109, a125
    v_accvgpr_read_b32 v110, a126
    v_accvgpr_read_b32 v111, a127
    v_mul_f32 v96, v44, v96
    v_mul_f32 v97, v44, v97
    v_mul_f32 v98, v44, v98
    v_mul_f32 v99, v44, v99
    v_mul_f32 v100, v44, v100
    v_mul_f32 v101, v44, v101
    v_mul_f32 v102, v44, v102
    v_mul_f32 v103, v44, v103
    v_mul_f32 v104, v44, v104
    v_mul_f32 v105, v44, v105
    v_mul_f32 v106, v44, v106
    v_mul_f32 v107, v44, v107
    v_mul_f32 v108, v44, v108
    v_mul_f32 v109, v44, v109
    v_mul_f32 v110, v44, v110
    v_mul_f32 v111, v44, v111
    v_cvt_pk_bf16_f32 v184, v96, v97
    v_cvt_pk_bf16_f32 v185, v98, v99
    v_cvt_pk_bf16_f32 v186, v100, v101
    v_cvt_pk_bf16_f32 v187, v102, v103
    v_cvt_pk_bf16_f32 v188, v104, v105
    v_cvt_pk_bf16_f32 v189, v106, v107
    v_cvt_pk_bf16_f32 v190, v108, v109
    v_cvt_pk_bf16_f32 v191, v110, v111
    s_nop 1
    v_permlane32_swap_b32 v184, v186
    v_permlane32_swap_b32 v185, v187
    v_permlane32_swap_b32 v188, v190
    v_permlane32_swap_b32 v189, v191
    s_nop 1
    buffer_store_dwordx4 v[184:187], v4, s[32:35], s48 offen offset:2048
    buffer_store_dwordx4 v[188:191], v4, s[32:35], s48 offen offset:3072
    s_add_u32 s48, s48, 4096
    s_endpgm
L_front_slow_1:
    s_nop 15
    s_nop 7
    v_max3_f32 v42, v80, v81, v82
    v_max3_f32 v42, v42, v83, v84
    v_max3_f32 v42, v42, v85, v86
    v_max3_f32 v42, v42, v87, v88
    v_max3_f32 v42, v42, v89, v90
    v_max3_f32 v42, v42, v91, v92
    v_max3_f32 v42, v42, v93, v94
    v_max_f32 v42, v42, v95
    v_mov_b32 v43, v42
    s_nop 1
    v_permlane32_swap_b32 v43, v42
    s_nop 1
    v_max_f32 v42, v42, v43
    v_max_f32 v42, 0, v42
    v_sub_f32 v44, 0, v42
    v_exp_f32 v44, v44
    v_sub_f32 v80, v80, v42
    v_sub_f32 v96, v96, v42
    v_sub_f32 v64, v64, v42
    v_sub_f32 v81, v81, v42
    v_sub_f32 v97, v97, v42
    v_sub_f32 v65, v65, v42
    v_sub_f32 v82, v82, v42
    v_sub_f32 v98, v98, v42
    v_sub_f32 v66, v66, v42
    v_sub_f32 v83, v83, v42
    v_sub_f32 v99, v99, v42
    v_sub_f32 v67, v67, v42
    v_sub_f32 v84, v84, v42
    v_sub_f32 v100, v100, v42
    v_sub_f32 v68, v68, v42
    v_sub_f32 v85, v85, v42
    v_sub_f32 v101, v101, v42
    v_sub_f32 v69, v69, v42
    v_sub_f32 v86, v86, v42
    v_sub_f32 v102, v102, v42
    v_sub_f32 v70, v70, v42
    v_sub_f32 v87, v87, v42
    v_sub_f32 v103, v103, v42
    v_sub_f32 v71, v71, v42
    v_sub_f32 v88, v88, v42
    v_sub_f32 v104, v104, v42
    v_sub_f32 v72, v72, v42
    v_sub_f32 v89, v89, v42
    v_sub_f32 v105, v105, v42
    v_sub_f32 v73, v73, v42
    v_sub_f32 v90, v90, v42
    v_sub_f32 v106, v106, v42
    v_sub_f32 v74, v74, v42
    v_sub_f32 v91, v91, v42
    v_sub_f32 v107, v107, v42
    v_sub_f32 v75, v75, v42
    v_sub_f32 v92, v92, v42
    v_sub_f32 v108, v108, v42
    v_sub_f32 v76, v76, v42
    v_sub_f32 v93, v93, v42
    v_sub_f32 v109, v109, v42
    v_sub_f32 v77, v77, v42
    v_sub_f32 v94, v94, v42
    v_sub_f32 v110, v110, v42
    v_sub_f32 v78, v78, v42
    v_sub_f32 v95, v95, v42
    v_sub_f32 v111, v111, v42
    v_sub_f32 v79, v79, v42
    v_mul_f32 v34, v34, v44
    v_accvgpr_read_b32 v38, a0
    v_mul_f32 v38, v38, v44
    v_accvgpr_write_b32 a0, v38
    v_accvgpr_read_b32 v39, a1
    v_mul_f32 v39, v39, v44
    v_accvgpr_write_b32 a1, v39
    v_accvgpr_read_b32 v40, a2
    v_mul_f32 v40, v40, v44
    v_accvgpr_write_b32 a2, v40
    v_accvgpr_read_b32 v41, a3
    v_mul_f32 v41, v41, v44
    v_accvgpr_write_b32 a3, v41
    v_accvgpr_read_b32 v38, a4
    v_mul_f32 v38, v38, v44
    v_accvgpr_write_b32 a4, v38
    v_accvgpr_read_b32 v39, a5
    v_mul_f32 v39, v39, v44
    v_accvgpr_write_b32 a5, v39
    v_accvgpr_read_b32 v40, a6
    v_mul_f32 v40, v40, v44
    v_accvgpr_write_b32 a6, v40
    v_accvgpr_read_b32 v41, a7
    v_mul_f32 v41, v41, v44
    v_accvgpr_write_b32 a7, v41
    v_accvgpr_read_b32 v38, a8
    v_mul_f32 v38, v38, v44
    v_accvgpr_write_b32 a8, v38
    v_accvgpr_read_b32 v39, a9
    v_mul_f32 v39, v39, v44
    v_accvgpr_write_b32 a9, v39
    v_accvgpr_read_b32 v40, a10
    v_mul_f32 v40, v40, v44
    v_accvgpr_write_b32 a10, v40
    v_accvgpr_read_b32 v41, a11
    v_mul_f32 v41, v41, v44
    v_accvgpr_write_b32 a11, v41
    v_accvgpr_read_b32 v38, a12
    v_mul_f32 v38, v38, v44
    v_accvgpr_write_b32 a12, v38
    v_accvgpr_read_b32 v39, a13
    v_mul_f32 v39, v39, v44
    v_accvgpr_write_b32 a13, v39
    v_accvgpr_read_b32 v40, a14
    v_mul_f32 v40, v40, v44
    v_accvgpr_write_b32 a14, v40
    v_accvgpr_read_b32 v41, a15
    v_mul_f32 v41, v41, v44
    v_accvgpr_write_b32 a15, v41
    v_accvgpr_read_b32 v38, a16
    v_mul_f32 v38, v38, v44
    v_accvgpr_write_b32 a16, v38
    v_accvgpr_read_b32 v39, a17
    v_mul_f32 v39, v39, v44
    v_accvgpr_write_b32 a17, v39
    v_accvgpr_read_b32 v40, a18
    v_mul_f32 v40, v40, v44
    v_accvgpr_write_b32 a18, v40
    v_accvgpr_read_b32 v41, a19
    v_mul_f32 v41, v41, v44
    v_accvgpr_write_b32 a19, v41
    v_accvgpr_read_b32 v38, a20
    v_mul_f32 v38, v38, v44
    v_accvgpr_write_b32 a20, v38
    v_accvgpr_read_b32 v39, a21
    v_mul_f32 v39, v39, v44
    v_accvgpr_write_b32 a21, v39
    v_accvgpr_read_b32 v40, a22
    v_mul_f32 v40, v40, v44
    v_accvgpr_write_b32 a22, v40
    v_accvgpr_read_b32 v41, a23
    v_mul_f32 v41, v41, v44
    v_accvgpr_write_b32 a23, v41
    v_accvgpr_read_b32 v38, a24
    v_mul_f32 v38, v38, v44
    v_accvgpr_write_b32 a24, v38
    v_accvgpr_read_b32 v39, a25
    v_mul_f32 v39, v39, v44
    v_accvgpr_write_b32 a25, v39
    v_accvgpr_read_b32 v40, a26
    v_mul_f32 v40, v40, v44
    v_accvgpr_write_b32 a26, v40
    v_accvgpr_read_b32 v41, a27
    v_mul_f32 v41, v41, v44
    v_accvgpr_write_b32 a27, v41
    v_accvgpr_read_b32 v38, a28
    v_mul_f32 v38, v38, v44
    v_accvgpr_write_b32 a28, v38
    v_accvgpr_read_b32 v39, a29
    v_mul_f32 v39, v39, v44
    v_accvgpr_write_b32 a29, v39
    v_accvgpr_read_b32 v40, a30
    v_mul_f32 v40, v40, v44
    v_accvgpr_write_b32 a30, v40
    v_accvgpr_read_b32 v41, a31
    v_mul_f32 v41, v41, v44
    v_accvgpr_write_b32 a31, v41
    v_accvgpr_read_b32 v38, a32
    v_mul_f32 v38, v38, v44
    v_accvgpr_write_b32 a32, v38
    v_accvgpr_read_b32 v39, a33
    v_mul_f32 v39, v39, v44
    v_accvgpr_write_b32 a33, v39
    v_accvgpr_read_b32 v40, a34
    v_mul_f32 v40, v40, v44
    v_accvgpr_write_b32 a34, v40
    v_accvgpr_read_b32 v41, a35
    v_mul_f32 v41, v41, v44
    v_accvgpr_write_b32 a35, v41
    v_accvgpr_read_b32 v38, a36
    v_mul_f32 v38, v38, v44
    v_accvgpr_write_b32 a36, v38
    v_accvgpr_read_b32 v39, a37
    v_mul_f32 v39, v39, v44
    v_accvgpr_write_b32 a37, v39
    v_accvgpr_read_b32 v40, a38
    v_mul_f32 v40, v40, v44
    v_accvgpr_write_b32 a38, v40
    v_accvgpr_read_b32 v41, a39
    v_mul_f32 v41, v41, v44
    v_accvgpr_write_b32 a39, v41
    v_accvgpr_read_b32 v38, a40
    v_mul_f32 v38, v38, v44
    v_accvgpr_write_b32 a40, v38
    v_accvgpr_read_b32 v39, a41
    v_mul_f32 v39, v39, v44
    v_accvgpr_write_b32 a41, v39
    v_accvgpr_read_b32 v40, a42
    v_mul_f32 v40, v40, v44
    v_accvgpr_write_b32 a42, v40
    v_accvgpr_read_b32 v41, a43
    v_mul_f32 v41, v41, v44
    v_accvgpr_write_b32 a43, v41
    v_accvgpr_read_b32 v38, a44
    v_mul_f32 v38, v38, v44
    v_accvgpr_write_b32 a44, v38
    v_accvgpr_read_b32 v39, a45
    v_mul_f32 v39, v39, v44
    v_accvgpr_write_b32 a45, v39
    v_accvgpr_read_b32 v40, a46
    v_mul_f32 v40, v40, v44
    v_accvgpr_write_b32 a46, v40
    v_accvgpr_read_b32 v41, a47
    v_mul_f32 v41, v41, v44
    v_accvgpr_write_b32 a47, v41
    v_accvgpr_read_b32 v38, a48
    v_mul_f32 v38, v38, v44
    v_accvgpr_write_b32 a48, v38
    v_accvgpr_read_b32 v39, a49
    v_mul_f32 v39, v39, v44
    v_accvgpr_write_b32 a49, v39
    v_accvgpr_read_b32 v40, a50
    v_mul_f32 v40, v40, v44
    v_accvgpr_write_b32 a50, v40
    v_accvgpr_read_b32 v41, a51
    v_mul_f32 v41, v41, v44
    v_accvgpr_write_b32 a51, v41
    v_accvgpr_read_b32 v38, a52
    v_mul_f32 v38, v38, v44
    v_accvgpr_write_b32 a52, v38
    v_accvgpr_read_b32 v39, a53
    v_mul_f32 v39, v39, v44
    v_accvgpr_write_b32 a53, v39
    v_accvgpr_read_b32 v40, a54
    v_mul_f32 v40, v40, v44
    v_accvgpr_write_b32 a54, v40
    v_accvgpr_read_b32 v41, a55
    v_mul_f32 v41, v41, v44
    v_accvgpr_write_b32 a55, v41
    v_accvgpr_read_b32 v38, a56
    v_mul_f32 v38, v38, v44
    v_accvgpr_write_b32 a56, v38
    v_accvgpr_read_b32 v39, a57
    v_mul_f32 v39, v39, v44
    v_accvgpr_write_b32 a57, v39
    v_accvgpr_read_b32 v40, a58
    v_mul_f32 v40, v40, v44
    v_accvgpr_write_b32 a58, v40
    v_accvgpr_read_b32 v41, a59
    v_mul_f32 v41, v41, v44
    v_accvgpr_write_b32 a59, v41
    v_accvgpr_read_b32 v38, a60
    v_mul_f32 v38, v38, v44
    v_accvgpr_write_b32 a60, v38
    v_accvgpr_read_b32 v39, a61
    v_mul_f32 v39, v39, v44
    v_accvgpr_write_b32 a61, v39
    v_accvgpr_read_b32 v40, a62
    v_mul_f32 v40, v40, v44
    v_accvgpr_write_b32 a62, v40
    v_accvgpr_read_b32 v41, a63
    v_mul_f32 v41, v41, v44
    v_accvgpr_write_b32 a63, v41
    v_accvgpr_read_b32 v38, a64
    v_mul_f32 v38, v38, v44
    v_accvgpr_write_b32 a64, v38
    v_accvgpr_read_b32 v39, a65
    v_mul_f32 v39, v39, v44
    v_accvgpr_write_b32 a65, v39
    v_accvgpr_read_b32 v40, a66
    v_mul_f32 v40, v40, v44
    v_accvgpr_write_b32 a66, v40
    v_accvgpr_read_b32 v41, a67
    v_mul_f32 v41, v41, v44
    v_accvgpr_write_b32 a67, v41
    v_accvgpr_read_b32 v38, a68
    v_mul_f32 v38, v38, v44
    v_accvgpr_write_b32 a68, v38
    v_accvgpr_read_b32 v39, a69
    v_mul_f32 v39, v39, v44
    v_accvgpr_write_b32 a69, v39
    v_accvgpr_read_b32 v40, a70
    v_mul_f32 v40, v40, v44
    v_accvgpr_write_b32 a70, v40
    v_accvgpr_read_b32 v41, a71
    v_mul_f32 v41, v41, v44
    v_accvgpr_write_b32 a71, v41
    v_accvgpr_read_b32 v38, a72
    v_mul_f32 v38, v38, v44
    v_accvgpr_write_b32 a72, v38
    v_accvgpr_read_b32 v39, a73
    v_mul_f32 v39, v39, v44
    v_accvgpr_write_b32 a73, v39
    v_accvgpr_read_b32 v40, a74
    v_mul_f32 v40, v40, v44
    v_accvgpr_write_b32 a74, v40
    v_accvgpr_read_b32 v41, a75
    v_mul_f32 v41, v41, v44
    v_accvgpr_write_b32 a75, v41
    v_accvgpr_read_b32 v38, a76
    v_mul_f32 v38, v38, v44
    v_accvgpr_write_b32 a76, v38
    v_accvgpr_read_b32 v39, a77
    v_mul_f32 v39, v39, v44
    v_accvgpr_write_b32 a77, v39
    v_accvgpr_read_b32 v40, a78
    v_mul_f32 v40, v40, v44
    v_accvgpr_write_b32 a78, v40
    v_accvgpr_read_b32 v41, a79
    v_mul_f32 v41, v41, v44
    v_accvgpr_write_b32 a79, v41
    v_accvgpr_read_b32 v38, a80
    v_mul_f32 v38, v38, v44
    v_accvgpr_write_b32 a80, v38
    v_accvgpr_read_b32 v39, a81
    v_mul_f32 v39, v39, v44
    v_accvgpr_write_b32 a81, v39
    v_accvgpr_read_b32 v40, a82
    v_mul_f32 v40, v40, v44
    v_accvgpr_write_b32 a82, v40
    v_accvgpr_read_b32 v41, a83
    v_mul_f32 v41, v41, v44
    v_accvgpr_write_b32 a83, v41
    v_accvgpr_read_b32 v38, a84
    v_mul_f32 v38, v38, v44
    v_accvgpr_write_b32 a84, v38
    v_accvgpr_read_b32 v39, a85
    v_mul_f32 v39, v39, v44
    v_accvgpr_write_b32 a85, v39
    v_accvgpr_read_b32 v40, a86
    v_mul_f32 v40, v40, v44
    v_accvgpr_write_b32 a86, v40
    v_accvgpr_read_b32 v41, a87
    v_mul_f32 v41, v41, v44
    v_accvgpr_write_b32 a87, v41
    v_accvgpr_read_b32 v38, a88
    v_mul_f32 v38, v38, v44
    v_accvgpr_write_b32 a88, v38
    v_accvgpr_read_b32 v39, a89
    v_mul_f32 v39, v39, v44
    v_accvgpr_write_b32 a89, v39
    v_accvgpr_read_b32 v40, a90
    v_mul_f32 v40, v40, v44
    v_accvgpr_write_b32 a90, v40
    v_accvgpr_read_b32 v41, a91
    v_mul_f32 v41, v41, v44
    v_accvgpr_write_b32 a91, v41
    v_accvgpr_read_b32 v38, a92
    v_mul_f32 v38, v38, v44
    v_accvgpr_write_b32 a92, v38
    v_accvgpr_read_b32 v39, a93
    v_mul_f32 v39, v39, v44
    v_accvgpr_write_b32 a93, v39
    v_accvgpr_read_b32 v40, a94
    v_mul_f32 v40, v40, v44
    v_accvgpr_write_b32 a94, v40
    v_accvgpr_read_b32 v41, a95
    v_mul_f32 v41, v41, v44
    v_accvgpr_write_b32 a95, v41
    v_accvgpr_read_b32 v38, a96
    v_mul_f32 v38, v38, v44
    v_accvgpr_write_b32 a96, v38
    v_accvgpr_read_b32 v39, a97
    v_mul_f32 v39, v39, v44
    v_accvgpr_write_b32 a97, v39
    v_accvgpr_read_b32 v40, a98
    v_mul_f32 v40, v40, v44
    v_accvgpr_write_b32 a98, v40
    v_accvgpr_read_b32 v41, a99
    v_mul_f32 v41, v41, v44
    v_accvgpr_write_b32 a99, v41
    v_accvgpr_read_b32 v38, a100
    v_mul_f32 v38, v38, v44
    v_accvgpr_write_b32 a100, v38
    v_accvgpr_read_b32 v39, a101
    v_mul_f32 v39, v39, v44
    v_accvgpr_write_b32 a101, v39
    v_accvgpr_read_b32 v40, a102
    v_mul_f32 v40, v40, v44
    v_accvgpr_write_b32 a102, v40
    v_accvgpr_read_b32 v41, a103
    v_mul_f32 v41, v41, v44
    v_accvgpr_write_b32 a103, v41
    v_accvgpr_read_b32 v38, a104
    v_mul_f32 v38, v38, v44
    v_accvgpr_write_b32 a104, v38
    v_accvgpr_read_b32 v39, a105
    v_mul_f32 v39, v39, v44
    v_accvgpr_write_b32 a105, v39
    v_accvgpr_read_b32 v40, a106
    v_mul_f32 v40, v40, v44
    v_accvgpr_write_b32 a106, v40
    v_accvgpr_read_b32 v41, a107
    v_mul_f32 v41, v41, v44
    v_accvgpr_write_b32 a107, v41
    v_accvgpr_read_b32 v38, a108
    v_mul_f32 v38, v38, v44
    v_accvgpr_write_b32 a108, v38
    v_accvgpr_read_b32 v39, a109
    v_mul_f32 v39, v39, v44
    v_accvgpr_write_b32 a109, v39
    v_accvgpr_read_b32 v40, a110
    v_mul_f32 v40, v40, v44
    v_accvgpr_write_b32 a110, v40
    v_accvgpr_read_b32 v41, a111
    v_mul_f32 v41, v41, v44
    v_accvgpr_write_b32 a111, v41
    v_accvgpr_read_b32 v38, a112
    v_mul_f32 v38, v38, v44
    v_accvgpr_write_b32 a112, v38
    v_accvgpr_read_b32 v39, a113
    v_mul_f32 v39, v39, v44
    v_accvgpr_write_b32 a113, v39
    v_accvgpr_read_b32 v40, a114
    v_mul_f32 v40, v40, v44
    v_accvgpr_write_b32 a114, v40
    v_accvgpr_read_b32 v41, a115
    v_mul_f32 v41, v41, v44
    v_accvgpr_write_b32 a115, v41
    v_accvgpr_read_b32 v38, a116
    v_mul_f32 v38, v38, v44
    v_accvgpr_write_b32 a116, v38
    v_accvgpr_read_b32 v39, a117
    v_mul_f32 v39, v39, v44
    v_accvgpr_write_b32 a117, v39
    v_accvgpr_read_b32 v40, a118
    v_mul_f32 v40, v40, v44
    v_accvgpr_write_b32 a118, v40
    v_accvgpr_read_b32 v41, a119
    v_mul_f32 v41, v41, v44
    v_accvgpr_write_b32 a119, v41
    v_accvgpr_read_b32 v38, a120
    v_mul_f32 v38, v38, v44
    v_accvgpr_write_b32 a120, v38
    v_accvgpr_read_b32 v39, a121
    v_mul_f32 v39, v39, v44
    v_accvgpr_write_b32 a121, v39
    v_accvgpr_read_b32 v40, a122
    v_mul_f32 v40, v40, v44
    v_accvgpr_write_b32 a122, v40
    v_accvgpr_read_b32 v41, a123
    v_mul_f32 v41, v41, v44
    v_accvgpr_write_b32 a123, v41
    v_accvgpr_read_b32 v38, a124
    v_mul_f32 v38, v38, v44
    v_accvgpr_write_b32 a124, v38
    v_accvgpr_read_b32 v39, a125
    v_mul_f32 v39, v39, v44
    v_accvgpr_write_b32 a125, v39
    v_accvgpr_read_b32 v40, a126
    v_mul_f32 v40, v40, v44
    v_accvgpr_write_b32 a126, v40
    v_accvgpr_read_b32 v41, a127
    v_mul_f32 v41, v41, v44
    v_accvgpr_write_b32 a127, v41
    v_exp_f32 v38, v80
    v_exp_f32 v39, v81
    v_exp_f32 v40, v82
    v_exp_f32 v41, v83
    v_add_f32 v36, v38, v39
    v_cvt_pk_bf16_f32 v48, v38, v39
    v_exp_f32 v38, v84
    v_exp_f32 v39, v85
    v_add_f32 v37, v40, v41
    v_cvt_pk_bf16_f32 v49, v40, v41
    v_exp_f32 v40, v86
    v_exp_f32 v41, v87
    v_add_f32 v36, v36, v38
    v_add_f32 v37, v37, v39
    v_cvt_pk_bf16_f32 v50, v38, v39
    v_exp_f32 v38, v88
    v_exp_f32 v39, v89
    v_add_f32 v36, v36, v40
    v_add_f32 v37, v37, v41
    v_cvt_pk_bf16_f32 v51, v40, v41
    v_exp_f32 v40, v90
    v_exp_f32 v41, v91
    v_add_f32 v36, v36, v38
    v_add_f32 v37, v37, v39
    v_cvt_pk_bf16_f32 v52, v38, v39
    v_exp_f32 v38, v92
    v_exp_f32 v39, v93
    v_add_f32 v36, v36, v40
    v_add_f32 v37, v37, v41
    v_cvt_pk_bf16_f32 v53, v40, v41
    v_exp_f32 v40, v94
    v_exp_f32 v41, v95
    v_add_f32 v36, v36, v38
    v_add_f32 v37, v37, v39
    v_cvt_pk_bf16_f32 v54, v38, v39
    s_nop 0
    v_add_f32 v36, v36, v40
    v_add_f32 v37, v37, v41
    v_cvt_pk_bf16_f32 v55, v40, v41
    v_add_f32 v35, v36, v37
    s_nop 3
    s_branch L_front_back_2
L_front_slow_3:
    s_nop 15
    s_nop 7
    v_max3_f32 v42, v96, v97, v98
    v_max3_f32 v42, v42, v99, v100
    v_max3_f32 v42, v42, v101, v102
    v_max3_f32 v42, v42, v103, v104
    v_max3_f32 v42, v42, v105, v106
    v_max3_f32 v42, v42, v107, v108
    v_max3_f32 v42, v42, v109, v110
    v_max_f32 v42, v42, v111
    v_mov_b32 v43, v42
    s_nop 1
    v_permlane32_swap_b32 v43, v42
    s_nop 1
    v_max_f32 v42, v42, v43
    v_max_f32 v42, 0, v42
    v_sub_f32 v44, 0, v42
    v_exp_f32 v44, v44
    v_sub_f32 v96, v96, v42
    v_sub_f32 v112, v112, v42
    v_sub_f32 v64, v64, v42
    v_sub_f32 v97, v97, v42
    v_sub_f32 v113, v113, v42
    v_sub_f32 v65, v65, v42
    v_sub_f32 v98, v98, v42
    v_sub_f32 v114, v114, v42
    v_sub_f32 v66, v66, v42
    v_sub_f32 v99, v99, v42
    v_sub_f32 v115, v115, v42
    v_sub_f32 v67, v67, v42
    v_sub_f32 v100, v100, v42
    v_sub_f32 v116, v116, v42
    v_sub_f32 v68, v68, v42
    v_sub_f32 v101, v101, v42
    v_sub_f32 v117, v117, v42
    v_sub_f32 v69, v69, v42
    v_sub_f32 v102, v102, v42
    v_sub_f32 v118, v118, v42
    v_sub_f32 v70, v70, v42
    v_sub_f32 v103, v103, v42
    v_sub_f32 v119, v119, v42
    v_sub_f32 v71, v71, v42
    v_sub_f32 v104, v104, v42
    v_sub_f32 v120, v120, v42
    v_sub_f32 v72, v72, v42
    v_sub_f32 v105, v105, v42
    v_sub_f32 v121, v121, v42
    v_sub_f32 v73, v73, v42
    v_sub_f32 v106, v106, v42
    v_sub_f32 v122, v122, v42
    v_sub_f32 v74, v74, v42
    v_sub_f32 v107, v107, v42
    v_sub_f32 v123, v123, v42
    v_sub_f32 v75, v75, v42
    v_sub_f32 v108, v108, v42
    v_sub_f32 v124, v124, v42
    v_sub_f32 v76, v76, v42
    v_sub_f32 v109, v109, v42
    v_sub_f32 v125, v125, v42
    v_sub_f32 v77, v77, v42
    v_sub_f32 v110, v110, v42
    v_sub_f32 v126, v126, v42
    v_sub_f32 v78, v78, v42
    v_sub_f32 v111, v111, v42
    v_sub_f32 v127, v127, v42
    v_sub_f32 v79, v79, v42
    v_mul_f32 v34, v34, v44
    v_accvgpr_read_b32 v38, a0
    v_mul_f32 v38, v38, v44
    v_accvgpr_write_b32 a0, v38
    v_accvgpr_read_b32 v39, a1
    v_mul_f32 v39, v39, v44
    v_accvgpr_write_b32 a1, v39
    v_accvgpr_read_b32 v40, a2
    v_mul_f32 v40, v40, v44
    v_accvgpr_write_b32 a2, v40
    v_accvgpr_read_b32 v41, a3
    v_mul_f32 v41, v41, v44
    v_accvgpr_write_b32 a3, v41
    v_accvgpr_read_b32 v38, a4
    v_mul_f32 v38, v38, v44
    v_accvgpr_write_b32 a4, v38
    v_accvgpr_read_b32 v39, a5
    v_mul_f32 v39, v39, v44
    v_accvgpr_write_b32 a5, v39
    v_accvgpr_read_b32 v40, a6
    v_mul_f32 v40, v40, v44
    v_accvgpr_write_b32 a6, v40
    v_accvgpr_read_b32 v41, a7
    v_mul_f32 v41, v41, v44
    v_accvgpr_write_b32 a7, v41
    v_accvgpr_read_b32 v38, a8
    v_mul_f32 v38, v38, v44
    v_accvgpr_write_b32 a8, v38
    v_accvgpr_read_b32 v39, a9
    v_mul_f32 v39, v39, v44
    v_accvgpr_write_b32 a9, v39
    v_accvgpr_read_b32 v40, a10
    v_mul_f32 v40, v40, v44
    v_accvgpr_write_b32 a10, v40
    v_accvgpr_read_b32 v41, a11
    v_mul_f32 v41, v41, v44
    v_accvgpr_write_b32 a11, v41
    v_accvgpr_read_b32 v38, a12
    v_mul_f32 v38, v38, v44
    v_accvgpr_write_b32 a12, v38
    v_accvgpr_read_b32 v39, a13
    v_mul_f32 v39, v39, v44
    v_accvgpr_write_b32 a13, v39
    v_accvgpr_read_b32 v40, a14
    v_mul_f32 v40, v40, v44
    v_accvgpr_write_b32 a14, v40
    v_accvgpr_read_b32 v41, a15
    v_mul_f32 v41, v41, v44
    v_accvgpr_write_b32 a15, v41
    v_accvgpr_read_b32 v38, a16
    v_mul_f32 v38, v38, v44
    v_accvgpr_write_b32 a16, v38
    v_accvgpr_read_b32 v39, a17
    v_mul_f32 v39, v39, v44
    v_accvgpr_write_b32 a17, v39
    v_accvgpr_read_b32 v40, a18
    v_mul_f32 v40, v40, v44
    v_accvgpr_write_b32 a18, v40
    v_accvgpr_read_b32 v41, a19
    v_mul_f32 v41, v41, v44
    v_accvgpr_write_b32 a19, v41
    v_accvgpr_read_b32 v38, a20
    v_mul_f32 v38, v38, v44
    v_accvgpr_write_b32 a20, v38
    v_accvgpr_read_b32 v39, a21
    v_mul_f32 v39, v39, v44
    v_accvgpr_write_b32 a21, v39
    v_accvgpr_read_b32 v40, a22
    v_mul_f32 v40, v40, v44
    v_accvgpr_write_b32 a22, v40
    v_accvgpr_read_b32 v41, a23
    v_mul_f32 v41, v41, v44
    v_accvgpr_write_b32 a23, v41
    v_accvgpr_read_b32 v38, a24
    v_mul_f32 v38, v38, v44
    v_accvgpr_write_b32 a24, v38
    v_accvgpr_read_b32 v39, a25
    v_mul_f32 v39, v39, v44
    v_accvgpr_write_b32 a25, v39
    v_accvgpr_read_b32 v40, a26
    v_mul_f32 v40, v40, v44
    v_accvgpr_write_b32 a26, v40
    v_accvgpr_read_b32 v41, a27
    v_mul_f32 v41, v41, v44
    v_accvgpr_write_b32 a27, v41
    v_accvgpr_read_b32 v38, a28
    v_mul_f32 v38, v38, v44
    v_accvgpr_write_b32 a28, v38
    v_accvgpr_read_b32 v39, a29
    v_mul_f32 v39, v39, v44
    v_accvgpr_write_b32 a29, v39
    v_accvgpr_read_b32 v40, a30
    v_mul_f32 v40, v40, v44
    v_accvgpr_write_b32 a30, v40
    v_accvgpr_read_b32 v41, a31
    v_mul_f32 v41, v41, v44
    v_accvgpr_write_b32 a31, v41
    v_accvgpr_read_b32 v38, a32
    v_mul_f32 v38, v38, v44
    v_accvgpr_write_b32 a32, v38
    v_accvgpr_read_b32 v39, a33
    v_mul_f32 v39, v39, v44
    v_accvgpr_write_b32 a33, v39
    v_accvgpr_read_b32 v40, a34
    v_mul_f32 v40, v40, v44
    v_accvgpr_write_b32 a34, v40
    v_accvgpr_read_b32 v41, a35
    v_mul_f32 v41, v41, v44
    v_accvgpr_write_b32 a35, v41
    v_accvgpr_read_b32 v38, a36
    v_mul_f32 v38, v38, v44
    v_accvgpr_write_b32 a36, v38
    v_accvgpr_read_b32 v39, a37
    v_mul_f32 v39, v39, v44
    v_accvgpr_write_b32 a37, v39
    v_accvgpr_read_b32 v40, a38
    v_mul_f32 v40, v40, v44
    v_accvgpr_write_b32 a38, v40
    v_accvgpr_read_b32 v41, a39
    v_mul_f32 v41, v41, v44
    v_accvgpr_write_b32 a39, v41
    v_accvgpr_read_b32 v38, a40
    v_mul_f32 v38, v38, v44
    v_accvgpr_write_b32 a40, v38
    v_accvgpr_read_b32 v39, a41
    v_mul_f32 v39, v39, v44
    v_accvgpr_write_b32 a41, v39
    v_accvgpr_read_b32 v40, a42
    v_mul_f32 v40, v40, v44
    v_accvgpr_write_b32 a42, v40
    v_accvgpr_read_b32 v41, a43
    v_mul_f32 v41, v41, v44
    v_accvgpr_write_b32 a43, v41
    v_accvgpr_read_b32 v38, a44
    v_mul_f32 v38, v38, v44
    v_accvgpr_write_b32 a44, v38
    v_accvgpr_read_b32 v39, a45
    v_mul_f32 v39, v39, v44
    v_accvgpr_write_b32 a45, v39
    v_accvgpr_read_b32 v40, a46
    v_mul_f32 v40, v40, v44
    v_accvgpr_write_b32 a46, v40
    v_accvgpr_read_b32 v41, a47
    v_mul_f32 v41, v41, v44
    v_accvgpr_write_b32 a47, v41
    v_accvgpr_read_b32 v38, a48
    v_mul_f32 v38, v38, v44
    v_accvgpr_write_b32 a48, v38
    v_accvgpr_read_b32 v39, a49
    v_mul_f32 v39, v39, v44
    v_accvgpr_write_b32 a49, v39
    v_accvgpr_read_b32 v40, a50
    v_mul_f32 v40, v40, v44
    v_accvgpr_write_b32 a50, v40
    v_accvgpr_read_b32 v41, a51
    v_mul_f32 v41, v41, v44
    v_accvgpr_write_b32 a51, v41
    v_accvgpr_read_b32 v38, a52
    v_mul_f32 v38, v38, v44
    v_accvgpr_write_b32 a52, v38
    v_accvgpr_read_b32 v39, a53
    v_mul_f32 v39, v39, v44
    v_accvgpr_write_b32 a53, v39
    v_accvgpr_read_b32 v40, a54
    v_mul_f32 v40, v40, v44
    v_accvgpr_write_b32 a54, v40
    v_accvgpr_read_b32 v41, a55
    v_mul_f32 v41, v41, v44
    v_accvgpr_write_b32 a55, v41
    v_accvgpr_read_b32 v38, a56
    v_mul_f32 v38, v38, v44
    v_accvgpr_write_b32 a56, v38
    v_accvgpr_read_b32 v39, a57
    v_mul_f32 v39, v39, v44
    v_accvgpr_write_b32 a57, v39
    v_accvgpr_read_b32 v40, a58
    v_mul_f32 v40, v40, v44
    v_accvgpr_write_b32 a58, v40
    v_accvgpr_read_b32 v41, a59
    v_mul_f32 v41, v41, v44
    v_accvgpr_write_b32 a59, v41
    v_accvgpr_read_b32 v38, a60
    v_mul_f32 v38, v38, v44
    v_accvgpr_write_b32 a60, v38
    v_accvgpr_read_b32 v39, a61
    v_mul_f32 v39, v39, v44
    v_accvgpr_write_b32 a61, v39
    v_accvgpr_read_b32 v40, a62
    v_mul_f32 v40, v40, v44
    v_accvgpr_write_b32 a62, v40
    v_accvgpr_read_b32 v41, a63
    v_mul_f32 v41, v41, v44
    v_accvgpr_write_b32 a63, v41
    v_accvgpr_read_b32 v38, a64
    v_mul_f32 v38, v38, v44
    v_accvgpr_write_b32 a64, v38
    v_accvgpr_read_b32 v39, a65
    v_mul_f32 v39, v39, v44
    v_accvgpr_write_b32 a65, v39
    v_accvgpr_read_b32 v40, a66
    v_mul_f32 v40, v40, v44
    v_accvgpr_write_b32 a66, v40
    v_accvgpr_read_b32 v41, a67
    v_mul_f32 v41, v41, v44
    v_accvgpr_write_b32 a67, v41
    v_accvgpr_read_b32 v38, a68
    v_mul_f32 v38, v38, v44
    v_accvgpr_write_b32 a68, v38
    v_accvgpr_read_b32 v39, a69
    v_mul_f32 v39, v39, v44
    v_accvgpr_write_b32 a69, v39
    v_accvgpr_read_b32 v40, a70
    v_mul_f32 v40, v40, v44
    v_accvgpr_write_b32 a70, v40
    v_accvgpr_read_b32 v41, a71
    v_mul_f32 v41, v41, v44
    v_accvgpr_write_b32 a71, v41
    v_accvgpr_read_b32 v38, a72
    v_mul_f32 v38, v38, v44
    v_accvgpr_write_b32 a72, v38
    v_accvgpr_read_b32 v39, a73
    v_mul_f32 v39, v39, v44
    v_accvgpr_write_b32 a73, v39
    v_accvgpr_read_b32 v40, a74
    v_mul_f32 v40, v40, v44
    v_accvgpr_write_b32 a74, v40
    v_accvgpr_read_b32 v41, a75
    v_mul_f32 v41, v41, v44
    v_accvgpr_write_b32 a75, v41
    v_accvgpr_read_b32 v38, a76
    v_mul_f32 v38, v38, v44
    v_accvgpr_write_b32 a76, v38
    v_accvgpr_read_b32 v39, a77
    v_mul_f32 v39, v39, v44
    v_accvgpr_write_b32 a77, v39
    v_accvgpr_read_b32 v40, a78
    v_mul_f32 v40, v40, v44
    v_accvgpr_write_b32 a78, v40
    v_accvgpr_read_b32 v41, a79
    v_mul_f32 v41, v41, v44
    v_accvgpr_write_b32 a79, v41
    v_accvgpr_read_b32 v38, a80
    v_mul_f32 v38, v38, v44
    v_accvgpr_write_b32 a80, v38
    v_accvgpr_read_b32 v39, a81
    v_mul_f32 v39, v39, v44
    v_accvgpr_write_b32 a81, v39
    v_accvgpr_read_b32 v40, a82
    v_mul_f32 v40, v40, v44
    v_accvgpr_write_b32 a82, v40
    v_accvgpr_read_b32 v41, a83
    v_mul_f32 v41, v41, v44
    v_accvgpr_write_b32 a83, v41
    v_accvgpr_read_b32 v38, a84
    v_mul_f32 v38, v38, v44
    v_accvgpr_write_b32 a84, v38
    v_accvgpr_read_b32 v39, a85
    v_mul_f32 v39, v39, v44
    v_accvgpr_write_b32 a85, v39
    v_accvgpr_read_b32 v40, a86
    v_mul_f32 v40, v40, v44
    v_accvgpr_write_b32 a86, v40
    v_accvgpr_read_b32 v41, a87
    v_mul_f32 v41, v41, v44
    v_accvgpr_write_b32 a87, v41
    v_accvgpr_read_b32 v38, a88
    v_mul_f32 v38, v38, v44
    v_accvgpr_write_b32 a88, v38
    v_accvgpr_read_b32 v39, a89
    v_mul_f32 v39, v39, v44
    v_accvgpr_write_b32 a89, v39
    v_accvgpr_read_b32 v40, a90
    v_mul_f32 v40, v40, v44
    v_accvgpr_write_b32 a90, v40
    v_accvgpr_read_b32 v41, a91
    v_mul_f32 v41, v41, v44
    v_accvgpr_write_b32 a91, v41
    v_accvgpr_read_b32 v38, a92
    v_mul_f32 v38, v38, v44
    v_accvgpr_write_b32 a92, v38
    v_accvgpr_read_b32 v39, a93
    v_mul_f32 v39, v39, v44
    v_accvgpr_write_b32 a93, v39
    v_accvgpr_read_b32 v40, a94
    v_mul_f32 v40, v40, v44
    v_accvgpr_write_b32 a94, v40
    v_accvgpr_read_b32 v41, a95
    v_mul_f32 v41, v41, v44
    v_accvgpr_write_b32 a95, v41
    v_accvgpr_read_b32 v38, a96
    v_mul_f32 v38, v38, v44
    v_accvgpr_write_b32 a96, v38
    v_accvgpr_read_b32 v39, a97
    v_mul_f32 v39, v39, v44
    v_accvgpr_write_b32 a97, v39
    v_accvgpr_read_b32 v40, a98
    v_mul_f32 v40, v40, v44
    v_accvgpr_write_b32 a98, v40
    v_accvgpr_read_b32 v41, a99
    v_mul_f32 v41, v41, v44
    v_accvgpr_write_b32 a99, v41
    v_accvgpr_read_b32 v38, a100
    v_mul_f32 v38, v38, v44
    v_accvgpr_write_b32 a100, v38
    v_accvgpr_read_b32 v39, a101
    v_mul_f32 v39, v39, v44
    v_accvgpr_write_b32 a101, v39
    v_accvgpr_read_b32 v40, a102
    v_mul_f32 v40, v40, v44
    v_accvgpr_write_b32 a102, v40
    v_accvgpr_read_b32 v41, a103
    v_mul_f32 v41, v41, v44
    v_accvgpr_write_b32 a103, v41
    v_accvgpr_read_b32 v38, a104
    v_mul_f32 v38, v38, v44
    v_accvgpr_write_b32 a104, v38
    v_accvgpr_read_b32 v39, a105
    v_mul_f32 v39, v39, v44
    v_accvgpr_write_b32 a105, v39
    v_accvgpr_read_b32 v40, a106
    v_mul_f32 v40, v40, v44
    v_accvgpr_write_b32 a106, v40
    v_accvgpr_read_b32 v41, a107
    v_mul_f32 v41, v41, v44
    v_accvgpr_write_b32 a107, v41
    v_accvgpr_read_b32 v38, a108
    v_mul_f32 v38, v38, v44
    v_accvgpr_write_b32 a108, v38
    v_accvgpr_read_b32 v39, a109
    v_mul_f32 v39, v39, v44
    v_accvgpr_write_b32 a109, v39
    v_accvgpr_read_b32 v40, a110
    v_mul_f32 v40, v40, v44
    v_accvgpr_write_b32 a110, v40
    v_accvgpr_read_b32 v41, a111
    v_mul_f32 v41, v41, v44
    v_accvgpr_write_b32 a111, v41
    v_accvgpr_read_b32 v38, a112
    v_mul_f32 v38, v38, v44
    v_accvgpr_write_b32 a112, v38
    v_accvgpr_read_b32 v39, a113
    v_mul_f32 v39, v39, v44
    v_accvgpr_write_b32 a113, v39
    v_accvgpr_read_b32 v40, a114
    v_mul_f32 v40, v40, v44
    v_accvgpr_write_b32 a114, v40
    v_accvgpr_read_b32 v41, a115
    v_mul_f32 v41, v41, v44
    v_accvgpr_write_b32 a115, v41
    v_accvgpr_read_b32 v38, a116
    v_mul_f32 v38, v38, v44
    v_accvgpr_write_b32 a116, v38
    v_accvgpr_read_b32 v39, a117
    v_mul_f32 v39, v39, v44
    v_accvgpr_write_b32 a117, v39
    v_accvgpr_read_b32 v40, a118
    v_mul_f32 v40, v40, v44
    v_accvgpr_write_b32 a118, v40
    v_accvgpr_read_b32 v41, a119
    v_mul_f32 v41, v41, v44
    v_accvgpr_write_b32 a119, v41
    v_accvgpr_read_b32 v38, a120
    v_mul_f32 v38, v38, v44
    v_accvgpr_write_b32 a120, v38
    v_accvgpr_read_b32 v39, a121
    v_mul_f32 v39, v39, v44
    v_accvgpr_write_b32 a121, v39
    v_accvgpr_read_b32 v40, a122
    v_mul_f32 v40, v40, v44
    v_accvgpr_write_b32 a122, v40
    v_accvgpr_read_b32 v41, a123
    v_mul_f32 v41, v41, v44
    v_accvgpr_write_b32 a123, v41
    v_accvgpr_read_b32 v38, a124
    v_mul_f32 v38, v38, v44
    v_accvgpr_write_b32 a124, v38
    v_accvgpr_read_b32 v39, a125
    v_mul_f32 v39, v39, v44
    v_accvgpr_write_b32 a125, v39
    v_accvgpr_read_b32 v40, a126
    v_mul_f32 v40, v40, v44
    v_accvgpr_write_b32 a126, v40
    v_accvgpr_read_b32 v41, a127
    v_mul_f32 v41, v41, v44
    v_accvgpr_write_b32 a127, v41
    v_exp_f32 v38, v96
    v_exp_f32 v39, v97
    v_exp_f32 v40, v98
    v_exp_f32 v41, v99
    v_add_f32 v36, v38, v39
    v_cvt_pk_bf16_f32 v48, v38, v39
    v_exp_f32 v38, v100
    v_exp_f32 v39, v101
    v_add_f32 v37, v40, v41
    v_cvt_pk_bf16_f32 v49, v40, v41
    v_exp_f32 v40, v102
    v_exp_f32 v41, v103
    v_add_f32 v36, v36, v38
    v_add_f32 v37, v37, v39
    v_cvt_pk_bf16_f32 v50, v38, v39
    v_exp_f32 v38, v104
    v_exp_f32 v39, v105
    v_add_f32 v36, v36, v40
    v_add_f32 v37, v37, v41
    v_cvt_pk_bf16_f32 v51, v40, v41
    v_exp_f32 v40, v106
    v_exp_f32 v41, v107
    v_add_f32 v36, v36, v38
    v_add_f32 v37, v37, v39
    v_cvt_pk_bf16_f32 v52, v38, v39
    v_exp_f32 v38, v108
    v_exp_f32 v39, v109
    v_add_f32 v36, v36, v40
    v_add_f32 v37, v37, v41
    v_cvt_pk_bf16_f32 v53, v40, v41
    v_exp_f32 v40, v110
    v_exp_f32 v41, v111
    v_add_f32 v36, v36, v38
    v_add_f32 v37, v37, v39
    v_cvt_pk_bf16_f32 v54, v38, v39
    s_nop 0
    v_add_f32 v36, v36, v40
    v_add_f32 v37, v37, v41
    v_cvt_pk_bf16_f32 v55, v40, v41
    v_add_f32 v35, v36, v37
    s_nop 3
    s_branch L_front_back_4
L_front_slow_5:
    s_nop 15
    s_nop 7
    v_max3_f32 v42, v112, v113, v114
    v_max3_f32 v42, v42, v115, v116
    v_max3_f32 v42, v42, v117, v118
    v_max3_f32 v42, v42, v119, v120
    v_max3_f32 v42, v42, v121, v122
    v_max3_f32 v42, v42, v123, v124
    v_max3_f32 v42, v42, v125, v126
    v_max_f32 v42, v42, v127
    v_mov_b32 v43, v42
    s_nop 1
    v_permlane32_swap_b32 v43, v42
    s_nop 1
    v_max_f32 v42, v42, v43
    v_max_f32 v42, 0, v42
    v_sub_f32 v44, 0, v42
    v_exp_f32 v44, v44
    v_sub_f32 v112, v112, v42
    v_sub_f32 v80, v80, v42
    v_sub_f32 v64, v64, v42
    v_sub_f32 v113, v113, v42
    v_sub_f32 v81, v81, v42
    v_sub_f32 v65, v65, v42
    v_sub_f32 v114, v114, v42
    v_sub_f32 v82, v82, v42
    v_sub_f32 v66, v66, v42
    v_sub_f32 v115, v115, v42
    v_sub_f32 v83, v83, v42
    v_sub_f32 v67, v67, v42
    v_sub_f32 v116, v116, v42
    v_sub_f32 v84, v84, v42
    v_sub_f32 v68, v68, v42
    v_sub_f32 v117, v117, v42
    v_sub_f32 v85, v85, v42
    v_sub_f32 v69, v69, v42
    v_sub_f32 v118, v118, v42
    v_sub_f32 v86, v86, v42
    v_sub_f32 v70, v70, v42
    v_sub_f32 v119, v119, v42
    v_sub_f32 v87, v87, v42
    v_sub_f32 v71, v71, v42
    v_sub_f32 v120, v120, v42
    v_sub_f32 v88, v88, v42
    v_sub_f32 v72, v72, v42
    v_sub_f32 v121, v121, v42
    v_sub_f32 v89, v89, v42
    v_sub_f32 v73, v73, v42
    v_sub_f32 v122, v122, v42
    v_sub_f32 v90, v90, v42
    v_sub_f32 v74, v74, v42
    v_sub_f32 v123, v123, v42
    v_sub_f32 v91, v91, v42
    v_sub_f32 v75, v75, v42
    v_sub_f32 v124, v124, v42
    v_sub_f32 v92, v92, v42
    v_sub_f32 v76, v76, v42
    v_sub_f32 v125, v125, v42
    v_sub_f32 v93, v93, v42
    v_sub_f32 v77, v77, v42
    v_sub_f32 v126, v126, v42
    v_sub_f32 v94, v94, v42
    v_sub_f32 v78, v78, v42
    v_sub_f32 v127, v127, v42
    v_sub_f32 v95, v95, v42
    v_sub_f32 v79, v79, v42
    v_mul_f32 v34, v34, v44
    v_accvgpr_read_b32 v38, a0
    v_mul_f32 v38, v38, v44
    v_accvgpr_write_b32 a0, v38
    v_accvgpr_read_b32 v39, a1
    v_mul_f32 v39, v39, v44
    v_accvgpr_write_b32 a1, v39
    v_accvgpr_read_b32 v40, a2
    v_mul_f32 v40, v40, v44
    v_accvgpr_write_b32 a2, v40
    v_accvgpr_read_b32 v41, a3
    v_mul_f32 v41, v41, v44
    v_accvgpr_write_b32 a3, v41
    v_accvgpr_read_b32 v38, a4
    v_mul_f32 v38, v38, v44
    v_accvgpr_write_b32 a4, v38
    v_accvgpr_read_b32 v39, a5
    v_mul_f32 v39, v39, v44
    v_accvgpr_write_b32 a5, v39
    v_accvgpr_read_b32 v40, a6
    v_mul_f32 v40, v40, v44
    v_accvgpr_write_b32 a6, v40
    v_accvgpr_read_b32 v41, a7
    v_mul_f32 v41, v41, v44
    v_accvgpr_write_b32 a7, v41
    v_accvgpr_read_b32 v38, a8
    v_mul_f32 v38, v38, v44
    v_accvgpr_write_b32 a8, v38
    v_accvgpr_read_b32 v39, a9
    v_mul_f32 v39, v39, v44
    v_accvgpr_write_b32 a9, v39
    v_accvgpr_read_b32 v40, a10
    v_mul_f32 v40, v40, v44
    v_accvgpr_write_b32 a10, v40
    v_accvgpr_read_b32 v41, a11
    v_mul_f32 v41, v41, v44
    v_accvgpr_write_b32 a11, v41
    v_accvgpr_read_b32 v38, a12
    v_mul_f32 v38, v38, v44
    v_accvgpr_write_b32 a12, v38
    v_accvgpr_read_b32 v39, a13
    v_mul_f32 v39, v39, v44
    v_accvgpr_write_b32 a13, v39
    v_accvgpr_read_b32 v40, a14
    v_mul_f32 v40, v40, v44
    v_accvgpr_write_b32 a14, v40
    v_accvgpr_read_b32 v41, a15
    v_mul_f32 v41, v41, v44
    v_accvgpr_write_b32 a15, v41
    v_accvgpr_read_b32 v38, a16
    v_mul_f32 v38, v38, v44
    v_accvgpr_write_b32 a16, v38
    v_accvgpr_read_b32 v39, a17
    v_mul_f32 v39, v39, v44
    v_accvgpr_write_b32 a17, v39
    v_accvgpr_read_b32 v40, a18
    v_mul_f32 v40, v40, v44
    v_accvgpr_write_b32 a18, v40
    v_accvgpr_read_b32 v41, a19
    v_mul_f32 v41, v41, v44
    v_accvgpr_write_b32 a19, v41
    v_accvgpr_read_b32 v38, a20
    v_mul_f32 v38, v38, v44
    v_accvgpr_write_b32 a20, v38
    v_accvgpr_read_b32 v39, a21
    v_mul_f32 v39, v39, v44
    v_accvgpr_write_b32 a21, v39
    v_accvgpr_read_b32 v40, a22
    v_mul_f32 v40, v40, v44
    v_accvgpr_write_b32 a22, v40
    v_accvgpr_read_b32 v41, a23
    v_mul_f32 v41, v41, v44
    v_accvgpr_write_b32 a23, v41
    v_accvgpr_read_b32 v38, a24
    v_mul_f32 v38, v38, v44
    v_accvgpr_write_b32 a24, v38
    v_accvgpr_read_b32 v39, a25
    v_mul_f32 v39, v39, v44
    v_accvgpr_write_b32 a25, v39
    v_accvgpr_read_b32 v40, a26
    v_mul_f32 v40, v40, v44
    v_accvgpr_write_b32 a26, v40
    v_accvgpr_read_b32 v41, a27
    v_mul_f32 v41, v41, v44
    v_accvgpr_write_b32 a27, v41
    v_accvgpr_read_b32 v38, a28
    v_mul_f32 v38, v38, v44
    v_accvgpr_write_b32 a28, v38
    v_accvgpr_read_b32 v39, a29
    v_mul_f32 v39, v39, v44
    v_accvgpr_write_b32 a29, v39
    v_accvgpr_read_b32 v40, a30
    v_mul_f32 v40, v40, v44
    v_accvgpr_write_b32 a30, v40
    v_accvgpr_read_b32 v41, a31
    v_mul_f32 v41, v41, v44
    v_accvgpr_write_b32 a31, v41
    v_accvgpr_read_b32 v38, a32
    v_mul_f32 v38, v38, v44
    v_accvgpr_write_b32 a32, v38
    v_accvgpr_read_b32 v39, a33
    v_mul_f32 v39, v39, v44
    v_accvgpr_write_b32 a33, v39
    v_accvgpr_read_b32 v40, a34
    v_mul_f32 v40, v40, v44
    v_accvgpr_write_b32 a34, v40
    v_accvgpr_read_b32 v41, a35
    v_mul_f32 v41, v41, v44
    v_accvgpr_write_b32 a35, v41
    v_accvgpr_read_b32 v38, a36
    v_mul_f32 v38, v38, v44
    v_accvgpr_write_b32 a36, v38
    v_accvgpr_read_b32 v39, a37
    v_mul_f32 v39, v39, v44
    v_accvgpr_write_b32 a37, v39
    v_accvgpr_read_b32 v40, a38
    v_mul_f32 v40, v40, v44
    v_accvgpr_write_b32 a38, v40
    v_accvgpr_read_b32 v41, a39
    v_mul_f32 v41, v41, v44
    v_accvgpr_write_b32 a39, v41
    v_accvgpr_read_b32 v38, a40
    v_mul_f32 v38, v38, v44
    v_accvgpr_write_b32 a40, v38
    v_accvgpr_read_b32 v39, a41
    v_mul_f32 v39, v39, v44
    v_accvgpr_write_b32 a41, v39
    v_accvgpr_read_b32 v40, a42
    v_mul_f32 v40, v40, v44
    v_accvgpr_write_b32 a42, v40
    v_accvgpr_read_b32 v41, a43
    v_mul_f32 v41, v41, v44
    v_accvgpr_write_b32 a43, v41
    v_accvgpr_read_b32 v38, a44
    v_mul_f32 v38, v38, v44
    v_accvgpr_write_b32 a44, v38
    v_accvgpr_read_b32 v39, a45
    v_mul_f32 v39, v39, v44
    v_accvgpr_write_b32 a45, v39
    v_accvgpr_read_b32 v40, a46
    v_mul_f32 v40, v40, v44
    v_accvgpr_write_b32 a46, v40
    v_accvgpr_read_b32 v41, a47
    v_mul_f32 v41, v41, v44
    v_accvgpr_write_b32 a47, v41
    v_accvgpr_read_b32 v38, a48
    v_mul_f32 v38, v38, v44
    v_accvgpr_write_b32 a48, v38
    v_accvgpr_read_b32 v39, a49
    v_mul_f32 v39, v39, v44
    v_accvgpr_write_b32 a49, v39
    v_accvgpr_read_b32 v40, a50
    v_mul_f32 v40, v40, v44
    v_accvgpr_write_b32 a50, v40
    v_accvgpr_read_b32 v41, a51
    v_mul_f32 v41, v41, v44
    v_accvgpr_write_b32 a51, v41
    v_accvgpr_read_b32 v38, a52
    v_mul_f32 v38, v38, v44
    v_accvgpr_write_b32 a52, v38
    v_accvgpr_read_b32 v39, a53
    v_mul_f32 v39, v39, v44
    v_accvgpr_write_b32 a53, v39
    v_accvgpr_read_b32 v40, a54
    v_mul_f32 v40, v40, v44
    v_accvgpr_write_b32 a54, v40
    v_accvgpr_read_b32 v41, a55
    v_mul_f32 v41, v41, v44
    v_accvgpr_write_b32 a55, v41
    v_accvgpr_read_b32 v38, a56
    v_mul_f32 v38, v38, v44
    v_accvgpr_write_b32 a56, v38
    v_accvgpr_read_b32 v39, a57
    v_mul_f32 v39, v39, v44
    v_accvgpr_write_b32 a57, v39
    v_accvgpr_read_b32 v40, a58
    v_mul_f32 v40, v40, v44
    v_accvgpr_write_b32 a58, v40
    v_accvgpr_read_b32 v41, a59
    v_mul_f32 v41, v41, v44
    v_accvgpr_write_b32 a59, v41
    v_accvgpr_read_b32 v38, a60
    v_mul_f32 v38, v38, v44
    v_accvgpr_write_b32 a60, v38
    v_accvgpr_read_b32 v39, a61
    v_mul_f32 v39, v39, v44
    v_accvgpr_write_b32 a61, v39
    v_accvgpr_read_b32 v40, a62
    v_mul_f32 v40, v40, v44
    v_accvgpr_write_b32 a62, v40
    v_accvgpr_read_b32 v41, a63
    v_mul_f32 v41, v41, v44
    v_accvgpr_write_b32 a63, v41
    v_accvgpr_read_b32 v38, a64
    v_mul_f32 v38, v38, v44
    v_accvgpr_write_b32 a64, v38
    v_accvgpr_read_b32 v39, a65
    v_mul_f32 v39, v39, v44
    v_accvgpr_write_b32 a65, v39
    v_accvgpr_read_b32 v40, a66
    v_mul_f32 v40, v40, v44
    v_accvgpr_write_b32 a66, v40
    v_accvgpr_read_b32 v41, a67
    v_mul_f32 v41, v41, v44
    v_accvgpr_write_b32 a67, v41
    v_accvgpr_read_b32 v38, a68
    v_mul_f32 v38, v38, v44
    v_accvgpr_write_b32 a68, v38
    v_accvgpr_read_b32 v39, a69
    v_mul_f32 v39, v39, v44
    v_accvgpr_write_b32 a69, v39
    v_accvgpr_read_b32 v40, a70
    v_mul_f32 v40, v40, v44
    v_accvgpr_write_b32 a70, v40
    v_accvgpr_read_b32 v41, a71
    v_mul_f32 v41, v41, v44
    v_accvgpr_write_b32 a71, v41
    v_accvgpr_read_b32 v38, a72
    v_mul_f32 v38, v38, v44
    v_accvgpr_write_b32 a72, v38
    v_accvgpr_read_b32 v39, a73
    v_mul_f32 v39, v39, v44
    v_accvgpr_write_b32 a73, v39
    v_accvgpr_read_b32 v40, a74
    v_mul_f32 v40, v40, v44
    v_accvgpr_write_b32 a74, v40
    v_accvgpr_read_b32 v41, a75
    v_mul_f32 v41, v41, v44
    v_accvgpr_write_b32 a75, v41
    v_accvgpr_read_b32 v38, a76
    v_mul_f32 v38, v38, v44
    v_accvgpr_write_b32 a76, v38
    v_accvgpr_read_b32 v39, a77
    v_mul_f32 v39, v39, v44
    v_accvgpr_write_b32 a77, v39
    v_accvgpr_read_b32 v40, a78
    v_mul_f32 v40, v40, v44
    v_accvgpr_write_b32 a78, v40
    v_accvgpr_read_b32 v41, a79
    v_mul_f32 v41, v41, v44
    v_accvgpr_write_b32 a79, v41
    v_accvgpr_read_b32 v38, a80
    v_mul_f32 v38, v38, v44
    v_accvgpr_write_b32 a80, v38
    v_accvgpr_read_b32 v39, a81
    v_mul_f32 v39, v39, v44
    v_accvgpr_write_b32 a81, v39
    v_accvgpr_read_b32 v40, a82
    v_mul_f32 v40, v40, v44
    v_accvgpr_write_b32 a82, v40
    v_accvgpr_read_b32 v41, a83
    v_mul_f32 v41, v41, v44
    v_accvgpr_write_b32 a83, v41
    v_accvgpr_read_b32 v38, a84
    v_mul_f32 v38, v38, v44
    v_accvgpr_write_b32 a84, v38
    v_accvgpr_read_b32 v39, a85
    v_mul_f32 v39, v39, v44
    v_accvgpr_write_b32 a85, v39
    v_accvgpr_read_b32 v40, a86
    v_mul_f32 v40, v40, v44
    v_accvgpr_write_b32 a86, v40
    v_accvgpr_read_b32 v41, a87
    v_mul_f32 v41, v41, v44
    v_accvgpr_write_b32 a87, v41
    v_accvgpr_read_b32 v38, a88
    v_mul_f32 v38, v38, v44
    v_accvgpr_write_b32 a88, v38
    v_accvgpr_read_b32 v39, a89
    v_mul_f32 v39, v39, v44
    v_accvgpr_write_b32 a89, v39
    v_accvgpr_read_b32 v40, a90
    v_mul_f32 v40, v40, v44
    v_accvgpr_write_b32 a90, v40
    v_accvgpr_read_b32 v41, a91
    v_mul_f32 v41, v41, v44
    v_accvgpr_write_b32 a91, v41
    v_accvgpr_read_b32 v38, a92
    v_mul_f32 v38, v38, v44
    v_accvgpr_write_b32 a92, v38
    v_accvgpr_read_b32 v39, a93
    v_mul_f32 v39, v39, v44
    v_accvgpr_write_b32 a93, v39
    v_accvgpr_read_b32 v40, a94
    v_mul_f32 v40, v40, v44
    v_accvgpr_write_b32 a94, v40
    v_accvgpr_read_b32 v41, a95
    v_mul_f32 v41, v41, v44
    v_accvgpr_write_b32 a95, v41
    v_accvgpr_read_b32 v38, a96
    v_mul_f32 v38, v38, v44
    v_accvgpr_write_b32 a96, v38
    v_accvgpr_read_b32 v39, a97
    v_mul_f32 v39, v39, v44
    v_accvgpr_write_b32 a97, v39
    v_accvgpr_read_b32 v40, a98
    v_mul_f32 v40, v40, v44
    v_accvgpr_write_b32 a98, v40
    v_accvgpr_read_b32 v41, a99
    v_mul_f32 v41, v41, v44
    v_accvgpr_write_b32 a99, v41
    v_accvgpr_read_b32 v38, a100
    v_mul_f32 v38, v38, v44
    v_accvgpr_write_b32 a100, v38
    v_accvgpr_read_b32 v39, a101
    v_mul_f32 v39, v39, v44
    v_accvgpr_write_b32 a101, v39
    v_accvgpr_read_b32 v40, a102
    v_mul_f32 v40, v40, v44
    v_accvgpr_write_b32 a102, v40
    v_accvgpr_read_b32 v41, a103
    v_mul_f32 v41, v41, v44
    v_accvgpr_write_b32 a103, v41
    v_accvgpr_read_b32 v38, a104
    v_mul_f32 v38, v38, v44
    v_accvgpr_write_b32 a104, v38
    v_accvgpr_read_b32 v39, a105
    v_mul_f32 v39, v39, v44
    v_accvgpr_write_b32 a105, v39
    v_accvgpr_read_b32 v40, a106
    v_mul_f32 v40, v40, v44
    v_accvgpr_write_b32 a106, v40
    v_accvgpr_read_b32 v41, a107
    v_mul_f32 v41, v41, v44
    v_accvgpr_write_b32 a107, v41
    v_accvgpr_read_b32 v38, a108
    v_mul_f32 v38, v38, v44
    v_accvgpr_write_b32 a108, v38
    v_accvgpr_read_b32 v39, a109
    v_mul_f32 v39, v39, v44
    v_accvgpr_write_b32 a109, v39
    v_accvgpr_read_b32 v40, a110
    v_mul_f32 v40, v40, v44
    v_accvgpr_write_b32 a110, v40
    v_accvgpr_read_b32 v41, a111
    v_mul_f32 v41, v41, v44
    v_accvgpr_write_b32 a111, v41
    v_accvgpr_read_b32 v38, a112
    v_mul_f32 v38, v38, v44
    v_accvgpr_write_b32 a112, v38
    v_accvgpr_read_b32 v39, a113
    v_mul_f32 v39, v39, v44
    v_accvgpr_write_b32 a113, v39
    v_accvgpr_read_b32 v40, a114
    v_mul_f32 v40, v40, v44
    v_accvgpr_write_b32 a114, v40
    v_accvgpr_read_b32 v41, a115
    v_mul_f32 v41, v41, v44
    v_accvgpr_write_b32 a115, v41
    v_accvgpr_read_b32 v38, a116
    v_mul_f32 v38, v38, v44
    v_accvgpr_write_b32 a116, v38
    v_accvgpr_read_b32 v39, a117
    v_mul_f32 v39, v39, v44
    v_accvgpr_write_b32 a117, v39
    v_accvgpr_read_b32 v40, a118
    v_mul_f32 v40, v40, v44
    v_accvgpr_write_b32 a118, v40
    v_accvgpr_read_b32 v41, a119
    v_mul_f32 v41, v41, v44
    v_accvgpr_write_b32 a119, v41
    v_accvgpr_read_b32 v38, a120
    v_mul_f32 v38, v38, v44
    v_accvgpr_write_b32 a120, v38
    v_accvgpr_read_b32 v39, a121
    v_mul_f32 v39, v39, v44
    v_accvgpr_write_b32 a121, v39
    v_accvgpr_read_b32 v40, a122
    v_mul_f32 v40, v40, v44
    v_accvgpr_write_b32 a122, v40
    v_accvgpr_read_b32 v41, a123
    v_mul_f32 v41, v41, v44
    v_accvgpr_write_b32 a123, v41
    v_accvgpr_read_b32 v38, a124
    v_mul_f32 v38, v38, v44
    v_accvgpr_write_b32 a124, v38
    v_accvgpr_read_b32 v39, a125
    v_mul_f32 v39, v39, v44
    v_accvgpr_write_b32 a125, v39
    v_accvgpr_read_b32 v40, a126
    v_mul_f32 v40, v40, v44
    v_accvgpr_write_b32 a126, v40
    v_accvgpr_read_b32 v41, a127
    v_mul_f32 v41, v41, v44
    v_accvgpr_write_b32 a127, v41
    v_exp_f32 v38, v112
    v_exp_f32 v39, v113
    v_exp_f32 v40, v114
    v_exp_f32 v41, v115
    v_add_f32 v36, v38, v39
    v_cvt_pk_bf16_f32 v48, v38, v39
    v_exp_f32 v38, v116
    v_exp_f32 v39, v117
    v_add_f32 v37, v40, v41
    v_cvt_pk_bf16_f32 v49, v40, v41
    v_exp_f32 v40, v118
    v_exp_f32 v41, v119
    v_add_f32 v36, v36, v38
    v_add_f32 v37, v37, v39
    v_cvt_pk_bf16_f32 v50, v38, v39
    v_exp_f32 v38, v120
    v_exp_f32 v39, v121
    v_add_f32 v36, v36, v40
    v_add_f32 v37, v37, v41
    v_cvt_pk_bf16_f32 v51, v40, v41
    v_exp_f32 v40, v122
    v_exp_f32 v41, v123
    v_add_f32 v36, v36, v38
    v_add_f32 v37, v37, v39
    v_cvt_pk_bf16_f32 v52, v38, v39
    v_exp_f32 v38, v124
    v_exp_f32 v39, v125
    v_add_f32 v36, v36, v40
    v_add_f32 v37, v37, v41
    v_cvt_pk_bf16_f32 v53, v40, v41
    v_exp_f32 v40, v126
    v_exp_f32 v41, v127
    v_add_f32 v36, v36, v38
    v_add_f32 v37, v37, v39
    v_cvt_pk_bf16_f32 v54, v38, v39
    s_nop 0
    v_add_f32 v36, v36, v40
    v_add_f32 v37, v37, v41
    v_cvt_pk_bf16_f32 v55, v40, v41
    v_add_f32 v35, v36, v37
    s_nop 3
    s_branch L_front_back_6
L_front_slow_7:
    s_nop 15
    s_nop 7
    v_max3_f32 v42, v80, v81, v82
    v_max3_f32 v42, v42, v83, v84
    v_max3_f32 v42, v42, v85, v86
    v_max3_f32 v42, v42, v87, v88
    v_max3_f32 v42, v42, v89, v90
    v_max3_f32 v42, v42, v91, v92
    v_max3_f32 v42, v42, v93, v94
    v_max_f32 v42, v42, v95
    v_mov_b32 v43, v42
    s_nop 1
    v_permlane32_swap_b32 v43, v42
    s_nop 1
    v_max_f32 v42, v42, v43
    v_max_f32 v42, 0, v42
    v_sub_f32 v44, 0, v42
    v_exp_f32 v44, v44
    v_sub_f32 v80, v80, v42
    v_sub_f32 v96, v96, v42
    v_sub_f32 v64, v64, v42
    v_sub_f32 v81, v81, v42
    v_sub_f32 v97, v97, v42
    v_sub_f32 v65, v65, v42
    v_sub_f32 v82, v82, v42
    v_sub_f32 v98, v98, v42
    v_sub_f32 v66, v66, v42
    v_sub_f32 v83, v83, v42
    v_sub_f32 v99, v99, v42
    v_sub_f32 v67, v67, v42
    v_sub_f32 v84, v84, v42
    v_sub_f32 v100, v100, v42
    v_sub_f32 v68, v68, v42
    v_sub_f32 v85, v85, v42
    v_sub_f32 v101, v101, v42
    v_sub_f32 v69, v69, v42
    v_sub_f32 v86, v86, v42
    v_sub_f32 v102, v102, v42
    v_sub_f32 v70, v70, v42
    v_sub_f32 v87, v87, v42
    v_sub_f32 v103, v103, v42
    v_sub_f32 v71, v71, v42
    v_sub_f32 v88, v88, v42
    v_sub_f32 v104, v104, v42
    v_sub_f32 v72, v72, v42
    v_sub_f32 v89, v89, v42
    v_sub_f32 v105, v105, v42
    v_sub_f32 v73, v73, v42
    v_sub_f32 v90, v90, v42
    v_sub_f32 v106, v106, v42
    v_sub_f32 v74, v74, v42
    v_sub_f32 v91, v91, v42
    v_sub_f32 v107, v107, v42
    v_sub_f32 v75, v75, v42
    v_sub_f32 v92, v92, v42
    v_sub_f32 v108, v108, v42
    v_sub_f32 v76, v76, v42
    v_sub_f32 v93, v93, v42
    v_sub_f32 v109, v109, v42
    v_sub_f32 v77, v77, v42
    v_sub_f32 v94, v94, v42
    v_sub_f32 v110, v110, v42
    v_sub_f32 v78, v78, v42
    v_sub_f32 v95, v95, v42
    v_sub_f32 v111, v111, v42
    v_sub_f32 v79, v79, v42
    v_mul_f32 v34, v34, v44
    v_accvgpr_read_b32 v38, a0
    v_mul_f32 v38, v38, v44
    v_accvgpr_write_b32 a0, v38
    v_accvgpr_read_b32 v39, a1
    v_mul_f32 v39, v39, v44
    v_accvgpr_write_b32 a1, v39
    v_accvgpr_read_b32 v40, a2
    v_mul_f32 v40, v40, v44
    v_accvgpr_write_b32 a2, v40
    v_accvgpr_read_b32 v41, a3
    v_mul_f32 v41, v41, v44
    v_accvgpr_write_b32 a3, v41
    v_accvgpr_read_b32 v38, a4
    v_mul_f32 v38, v38, v44
    v_accvgpr_write_b32 a4, v38
    v_accvgpr_read_b32 v39, a5
    v_mul_f32 v39, v39, v44
    v_accvgpr_write_b32 a5, v39
    v_accvgpr_read_b32 v40, a6
    v_mul_f32 v40, v40, v44
    v_accvgpr_write_b32 a6, v40
    v_accvgpr_read_b32 v41, a7
    v_mul_f32 v41, v41, v44
    v_accvgpr_write_b32 a7, v41
    v_accvgpr_read_b32 v38, a8
    v_mul_f32 v38, v38, v44
    v_accvgpr_write_b32 a8, v38
    v_accvgpr_read_b32 v39, a9
    v_mul_f32 v39, v39, v44
    v_accvgpr_write_b32 a9, v39
    v_accvgpr_read_b32 v40, a10
    v_mul_f32 v40, v40, v44
    v_accvgpr_write_b32 a10, v40
    v_accvgpr_read_b32 v41, a11
    v_mul_f32 v41, v41, v44
    v_accvgpr_write_b32 a11, v41
    v_accvgpr_read_b32 v38, a12
    v_mul_f32 v38, v38, v44
    v_accvgpr_write_b32 a12, v38
    v_accvgpr_read_b32 v39, a13
    v_mul_f32 v39, v39, v44
    v_accvgpr_write_b32 a13, v39
    v_accvgpr_read_b32 v40, a14
    v_mul_f32 v40, v40, v44
    v_accvgpr_write_b32 a14, v40
    v_accvgpr_read_b32 v41, a15
    v_mul_f32 v41, v41, v44
    v_accvgpr_write_b32 a15, v41
    v_accvgpr_read_b32 v38, a16
    v_mul_f32 v38, v38, v44
    v_accvgpr_write_b32 a16, v38
    v_accvgpr_read_b32 v39, a17
    v_mul_f32 v39, v39, v44
    v_accvgpr_write_b32 a17, v39
    v_accvgpr_read_b32 v40, a18
    v_mul_f32 v40, v40, v44
    v_accvgpr_write_b32 a18, v40
    v_accvgpr_read_b32 v41, a19
    v_mul_f32 v41, v41, v44
    v_accvgpr_write_b32 a19, v41
    v_accvgpr_read_b32 v38, a20
    v_mul_f32 v38, v38, v44
    v_accvgpr_write_b32 a20, v38
    v_accvgpr_read_b32 v39, a21
    v_mul_f32 v39, v39, v44
    v_accvgpr_write_b32 a21, v39
    v_accvgpr_read_b32 v40, a22
    v_mul_f32 v40, v40, v44
    v_accvgpr_write_b32 a22, v40
    v_accvgpr_read_b32 v41, a23
    v_mul_f32 v41, v41, v44
    v_accvgpr_write_b32 a23, v41
    v_accvgpr_read_b32 v38, a24
    v_mul_f32 v38, v38, v44
    v_accvgpr_write_b32 a24, v38
    v_accvgpr_read_b32 v39, a25
    v_mul_f32 v39, v39, v44
    v_accvgpr_write_b32 a25, v39
    v_accvgpr_read_b32 v40, a26
    v_mul_f32 v40, v40, v44
    v_accvgpr_write_b32 a26, v40
    v_accvgpr_read_b32 v41, a27
    v_mul_f32 v41, v41, v44
    v_accvgpr_write_b32 a27, v41
    v_accvgpr_read_b32 v38, a28
    v_mul_f32 v38, v38, v44
    v_accvgpr_write_b32 a28, v38
    v_accvgpr_read_b32 v39, a29
    v_mul_f32 v39, v39, v44
    v_accvgpr_write_b32 a29, v39
    v_accvgpr_read_b32 v40, a30
    v_mul_f32 v40, v40, v44
    v_accvgpr_write_b32 a30, v40
    v_accvgpr_read_b32 v41, a31
    v_mul_f32 v41, v41, v44
    v_accvgpr_write_b32 a31, v41
    v_accvgpr_read_b32 v38, a32
    v_mul_f32 v38, v38, v44
    v_accvgpr_write_b32 a32, v38
    v_accvgpr_read_b32 v39, a33
    v_mul_f32 v39, v39, v44
    v_accvgpr_write_b32 a33, v39
    v_accvgpr_read_b32 v40, a34
    v_mul_f32 v40, v40, v44
    v_accvgpr_write_b32 a34, v40
    v_accvgpr_read_b32 v41, a35
    v_mul_f32 v41, v41, v44
    v_accvgpr_write_b32 a35, v41
    v_accvgpr_read_b32 v38, a36
    v_mul_f32 v38, v38, v44
    v_accvgpr_write_b32 a36, v38
    v_accvgpr_read_b32 v39, a37
    v_mul_f32 v39, v39, v44
    v_accvgpr_write_b32 a37, v39
    v_accvgpr_read_b32 v40, a38
    v_mul_f32 v40, v40, v44
    v_accvgpr_write_b32 a38, v40
    v_accvgpr_read_b32 v41, a39
    v_mul_f32 v41, v41, v44
    v_accvgpr_write_b32 a39, v41
    v_accvgpr_read_b32 v38, a40
    v_mul_f32 v38, v38, v44
    v_accvgpr_write_b32 a40, v38
    v_accvgpr_read_b32 v39, a41
    v_mul_f32 v39, v39, v44
    v_accvgpr_write_b32 a41, v39
    v_accvgpr_read_b32 v40, a42
    v_mul_f32 v40, v40, v44
    v_accvgpr_write_b32 a42, v40
    v_accvgpr_read_b32 v41, a43
    v_mul_f32 v41, v41, v44
    v_accvgpr_write_b32 a43, v41
    v_accvgpr_read_b32 v38, a44
    v_mul_f32 v38, v38, v44
    v_accvgpr_write_b32 a44, v38
    v_accvgpr_read_b32 v39, a45
    v_mul_f32 v39, v39, v44
    v_accvgpr_write_b32 a45, v39
    v_accvgpr_read_b32 v40, a46
    v_mul_f32 v40, v40, v44
    v_accvgpr_write_b32 a46, v40
    v_accvgpr_read_b32 v41, a47
    v_mul_f32 v41, v41, v44
    v_accvgpr_write_b32 a47, v41
    v_accvgpr_read_b32 v38, a48
    v_mul_f32 v38, v38, v44
    v_accvgpr_write_b32 a48, v38
    v_accvgpr_read_b32 v39, a49
    v_mul_f32 v39, v39, v44
    v_accvgpr_write_b32 a49, v39
    v_accvgpr_read_b32 v40, a50
    v_mul_f32 v40, v40, v44
    v_accvgpr_write_b32 a50, v40
    v_accvgpr_read_b32 v41, a51
    v_mul_f32 v41, v41, v44
    v_accvgpr_write_b32 a51, v41
    v_accvgpr_read_b32 v38, a52
    v_mul_f32 v38, v38, v44
    v_accvgpr_write_b32 a52, v38
    v_accvgpr_read_b32 v39, a53
    v_mul_f32 v39, v39, v44
    v_accvgpr_write_b32 a53, v39
    v_accvgpr_read_b32 v40, a54
    v_mul_f32 v40, v40, v44
    v_accvgpr_write_b32 a54, v40
    v_accvgpr_read_b32 v41, a55
    v_mul_f32 v41, v41, v44
    v_accvgpr_write_b32 a55, v41
    v_accvgpr_read_b32 v38, a56
    v_mul_f32 v38, v38, v44
    v_accvgpr_write_b32 a56, v38
    v_accvgpr_read_b32 v39, a57
    v_mul_f32 v39, v39, v44
    v_accvgpr_write_b32 a57, v39
    v_accvgpr_read_b32 v40, a58
    v_mul_f32 v40, v40, v44
    v_accvgpr_write_b32 a58, v40
    v_accvgpr_read_b32 v41, a59
    v_mul_f32 v41, v41, v44
    v_accvgpr_write_b32 a59, v41
    v_accvgpr_read_b32 v38, a60
    v_mul_f32 v38, v38, v44
    v_accvgpr_write_b32 a60, v38
    v_accvgpr_read_b32 v39, a61
    v_mul_f32 v39, v39, v44
    v_accvgpr_write_b32 a61, v39
    v_accvgpr_read_b32 v40, a62
    v_mul_f32 v40, v40, v44
    v_accvgpr_write_b32 a62, v40
    v_accvgpr_read_b32 v41, a63
    v_mul_f32 v41, v41, v44
    v_accvgpr_write_b32 a63, v41
    v_accvgpr_read_b32 v38, a64
    v_mul_f32 v38, v38, v44
    v_accvgpr_write_b32 a64, v38
    v_accvgpr_read_b32 v39, a65
    v_mul_f32 v39, v39, v44
    v_accvgpr_write_b32 a65, v39
    v_accvgpr_read_b32 v40, a66
    v_mul_f32 v40, v40, v44
    v_accvgpr_write_b32 a66, v40
    v_accvgpr_read_b32 v41, a67
    v_mul_f32 v41, v41, v44
    v_accvgpr_write_b32 a67, v41
    v_accvgpr_read_b32 v38, a68
    v_mul_f32 v38, v38, v44
    v_accvgpr_write_b32 a68, v38
    v_accvgpr_read_b32 v39, a69
    v_mul_f32 v39, v39, v44
    v_accvgpr_write_b32 a69, v39
    v_accvgpr_read_b32 v40, a70
    v_mul_f32 v40, v40, v44
    v_accvgpr_write_b32 a70, v40
    v_accvgpr_read_b32 v41, a71
    v_mul_f32 v41, v41, v44
    v_accvgpr_write_b32 a71, v41
    v_accvgpr_read_b32 v38, a72
    v_mul_f32 v38, v38, v44
    v_accvgpr_write_b32 a72, v38
    v_accvgpr_read_b32 v39, a73
    v_mul_f32 v39, v39, v44
    v_accvgpr_write_b32 a73, v39
    v_accvgpr_read_b32 v40, a74
    v_mul_f32 v40, v40, v44
    v_accvgpr_write_b32 a74, v40
    v_accvgpr_read_b32 v41, a75
    v_mul_f32 v41, v41, v44
    v_accvgpr_write_b32 a75, v41
    v_accvgpr_read_b32 v38, a76
    v_mul_f32 v38, v38, v44
    v_accvgpr_write_b32 a76, v38
    v_accvgpr_read_b32 v39, a77
    v_mul_f32 v39, v39, v44
    v_accvgpr_write_b32 a77, v39
    v_accvgpr_read_b32 v40, a78
    v_mul_f32 v40, v40, v44
    v_accvgpr_write_b32 a78, v40
    v_accvgpr_read_b32 v41, a79
    v_mul_f32 v41, v41, v44
    v_accvgpr_write_b32 a79, v41
    v_accvgpr_read_b32 v38, a80
    v_mul_f32 v38, v38, v44
    v_accvgpr_write_b32 a80, v38
    v_accvgpr_read_b32 v39, a81
    v_mul_f32 v39, v39, v44
    v_accvgpr_write_b32 a81, v39
    v_accvgpr_read_b32 v40, a82
    v_mul_f32 v40, v40, v44
    v_accvgpr_write_b32 a82, v40
    v_accvgpr_read_b32 v41, a83
    v_mul_f32 v41, v41, v44
    v_accvgpr_write_b32 a83, v41
    v_accvgpr_read_b32 v38, a84
    v_mul_f32 v38, v38, v44
    v_accvgpr_write_b32 a84, v38
    v_accvgpr_read_b32 v39, a85
    v_mul_f32 v39, v39, v44
    v_accvgpr_write_b32 a85, v39
    v_accvgpr_read_b32 v40, a86
    v_mul_f32 v40, v40, v44
    v_accvgpr_write_b32 a86, v40
    v_accvgpr_read_b32 v41, a87
    v_mul_f32 v41, v41, v44
    v_accvgpr_write_b32 a87, v41
    v_accvgpr_read_b32 v38, a88
    v_mul_f32 v38, v38, v44
    v_accvgpr_write_b32 a88, v38
    v_accvgpr_read_b32 v39, a89
    v_mul_f32 v39, v39, v44
    v_accvgpr_write_b32 a89, v39
    v_accvgpr_read_b32 v40, a90
    v_mul_f32 v40, v40, v44
    v_accvgpr_write_b32 a90, v40
    v_accvgpr_read_b32 v41, a91
    v_mul_f32 v41, v41, v44
    v_accvgpr_write_b32 a91, v41
    v_accvgpr_read_b32 v38, a92
    v_mul_f32 v38, v38, v44
    v_accvgpr_write_b32 a92, v38
    v_accvgpr_read_b32 v39, a93
    v_mul_f32 v39, v39, v44
    v_accvgpr_write_b32 a93, v39
    v_accvgpr_read_b32 v40, a94
    v_mul_f32 v40, v40, v44
    v_accvgpr_write_b32 a94, v40
    v_accvgpr_read_b32 v41, a95
    v_mul_f32 v41, v41, v44
    v_accvgpr_write_b32 a95, v41
    v_accvgpr_read_b32 v38, a96
    v_mul_f32 v38, v38, v44
    v_accvgpr_write_b32 a96, v38
    v_accvgpr_read_b32 v39, a97
    v_mul_f32 v39, v39, v44
    v_accvgpr_write_b32 a97, v39
    v_accvgpr_read_b32 v40, a98
    v_mul_f32 v40, v40, v44
    v_accvgpr_write_b32 a98, v40
    v_accvgpr_read_b32 v41, a99
    v_mul_f32 v41, v41, v44
    v_accvgpr_write_b32 a99, v41
    v_accvgpr_read_b32 v38, a100
    v_mul_f32 v38, v38, v44
    v_accvgpr_write_b32 a100, v38
    v_accvgpr_read_b32 v39, a101
    v_mul_f32 v39, v39, v44
    v_accvgpr_write_b32 a101, v39
    v_accvgpr_read_b32 v40, a102
    v_mul_f32 v40, v40, v44
    v_accvgpr_write_b32 a102, v40
    v_accvgpr_read_b32 v41, a103
    v_mul_f32 v41, v41, v44
    v_accvgpr_write_b32 a103, v41
    v_accvgpr_read_b32 v38, a104
    v_mul_f32 v38, v38, v44
    v_accvgpr_write_b32 a104, v38
    v_accvgpr_read_b32 v39, a105
    v_mul_f32 v39, v39, v44
    v_accvgpr_write_b32 a105, v39
    v_accvgpr_read_b32 v40, a106
    v_mul_f32 v40, v40, v44
    v_accvgpr_write_b32 a106, v40
    v_accvgpr_read_b32 v41, a107
    v_mul_f32 v41, v41, v44
    v_accvgpr_write_b32 a107, v41
    v_accvgpr_read_b32 v38, a108
    v_mul_f32 v38, v38, v44
    v_accvgpr_write_b32 a108, v38
    v_accvgpr_read_b32 v39, a109
    v_mul_f32 v39, v39, v44
    v_accvgpr_write_b32 a109, v39
    v_accvgpr_read_b32 v40, a110
    v_mul_f32 v40, v40, v44
    v_accvgpr_write_b32 a110, v40
    v_accvgpr_read_b32 v41, a111
    v_mul_f32 v41, v41, v44
    v_accvgpr_write_b32 a111, v41
    v_accvgpr_read_b32 v38, a112
    v_mul_f32 v38, v38, v44
    v_accvgpr_write_b32 a112, v38
    v_accvgpr_read_b32 v39, a113
    v_mul_f32 v39, v39, v44
    v_accvgpr_write_b32 a113, v39
    v_accvgpr_read_b32 v40, a114
    v_mul_f32 v40, v40, v44
    v_accvgpr_write_b32 a114, v40
    v_accvgpr_read_b32 v41, a115
    v_mul_f32 v41, v41, v44
    v_accvgpr_write_b32 a115, v41
    v_accvgpr_read_b32 v38, a116
    v_mul_f32 v38, v38, v44
    v_accvgpr_write_b32 a116, v38
    v_accvgpr_read_b32 v39, a117
    v_mul_f32 v39, v39, v44
    v_accvgpr_write_b32 a117, v39
    v_accvgpr_read_b32 v40, a118
    v_mul_f32 v40, v40, v44
    v_accvgpr_write_b32 a118, v40
    v_accvgpr_read_b32 v41, a119
    v_mul_f32 v41, v41, v44
    v_accvgpr_write_b32 a119, v41
    v_accvgpr_read_b32 v38, a120
    v_mul_f32 v38, v38, v44
    v_accvgpr_write_b32 a120, v38
    v_accvgpr_read_b32 v39, a121
    v_mul_f32 v39, v39, v44
    v_accvgpr_write_b32 a121, v39
    v_accvgpr_read_b32 v40, a122
    v_mul_f32 v40, v40, v44
    v_accvgpr_write_b32 a122, v40
    v_accvgpr_read_b32 v41, a123
    v_mul_f32 v41, v41, v44
    v_accvgpr_write_b32 a123, v41
    v_accvgpr_read_b32 v38, a124
    v_mul_f32 v38, v38, v44
    v_accvgpr_write_b32 a124, v38
    v_accvgpr_read_b32 v39, a125
    v_mul_f32 v39, v39, v44
    v_accvgpr_write_b32 a125, v39
    v_accvgpr_read_b32 v40, a126
    v_mul_f32 v40, v40, v44
    v_accvgpr_write_b32 a126, v40
    v_accvgpr_read_b32 v41, a127
    v_mul_f32 v41, v41, v44
    v_accvgpr_write_b32 a127, v41
    v_exp_f32 v38, v80
    v_exp_f32 v39, v81
    v_exp_f32 v40, v82
    v_exp_f32 v41, v83
    v_add_f32 v36, v38, v39
    v_cvt_pk_bf16_f32 v48, v38, v39
    v_exp_f32 v38, v84
    v_exp_f32 v39, v85
    v_add_f32 v37, v40, v41
    v_cvt_pk_bf16_f32 v49, v40, v41
    v_exp_f32 v40, v86
    v_exp_f32 v41, v87
    v_add_f32 v36, v36, v38
    v_add_f32 v37, v37, v39
    v_cvt_pk_bf16_f32 v50, v38, v39
    v_exp_f32 v38, v88
    v_exp_f32 v39, v89
    v_add_f32 v36, v36, v40
    v_add_f32 v37, v37, v41
    v_cvt_pk_bf16_f32 v51, v40, v41
    v_exp_f32 v40, v90
    v_exp_f32 v41, v91
    v_add_f32 v36, v36, v38
    v_add_f32 v37, v37, v39
    v_cvt_pk_bf16_f32 v52, v38, v39
    v_exp_f32 v38, v92
    v_exp_f32 v39, v93
    v_add_f32 v36, v36, v40
    v_add_f32 v37, v37, v41
    v_cvt_pk_bf16_f32 v53, v40, v41
    v_exp_f32 v40, v94
    v_exp_f32 v41, v95
    v_add_f32 v36, v36, v38
    v_add_f32 v37, v37, v39
    v_cvt_pk_bf16_f32 v54, v38, v39
    s_nop 0
    v_add_f32 v36, v36, v40
    v_add_f32 v37, v37, v41
    v_cvt_pk_bf16_f32 v55, v40, v41
    v_add_f32 v35, v36, v37
    s_nop 3
    s_branch L_front_back_8
L_front_slow_9:
    s_nop 15
    s_nop 7
    v_max3_f32 v42, v96, v97, v98
    v_max3_f32 v42, v42, v99, v100
    v_max3_f32 v42, v42, v101, v102
    v_max3_f32 v42, v42, v103, v104
    v_max3_f32 v42, v42, v105, v106
    v_max3_f32 v42, v42, v107, v108
    v_max3_f32 v42, v42, v109, v110
    v_max_f32 v42, v42, v111
    v_mov_b32 v43, v42
    s_nop 1
    v_permlane32_swap_b32 v43, v42
    s_nop 1
    v_max_f32 v42, v42, v43
    v_max_f32 v42, 0, v42
    v_sub_f32 v44, 0, v42
    v_exp_f32 v44, v44
    v_sub_f32 v96, v96, v42
    v_sub_f32 v112, v112, v42
    v_sub_f32 v64, v64, v42
    v_sub_f32 v97, v97, v42
    v_sub_f32 v113, v113, v42
    v_sub_f32 v65, v65, v42
    v_sub_f32 v98, v98, v42
    v_sub_f32 v114, v114, v42
    v_sub_f32 v66, v66, v42
    v_sub_f32 v99, v99, v42
    v_sub_f32 v115, v115, v42
    v_sub_f32 v67, v67, v42
    v_sub_f32 v100, v100, v42
    v_sub_f32 v116, v116, v42
    v_sub_f32 v68, v68, v42
    v_sub_f32 v101, v101, v42
    v_sub_f32 v117, v117, v42
    v_sub_f32 v69, v69, v42
    v_sub_f32 v102, v102, v42
    v_sub_f32 v118, v118, v42
    v_sub_f32 v70, v70, v42
    v_sub_f32 v103, v103, v42
    v_sub_f32 v119, v119, v42
    v_sub_f32 v71, v71, v42
    v_sub_f32 v104, v104, v42
    v_sub_f32 v120, v120, v42
    v_sub_f32 v72, v72, v42
    v_sub_f32 v105, v105, v42
    v_sub_f32 v121, v121, v42
    v_sub_f32 v73, v73, v42
    v_sub_f32 v106, v106, v42
    v_sub_f32 v122, v122, v42
    v_sub_f32 v74, v74, v42
    v_sub_f32 v107, v107, v42
    v_sub_f32 v123, v123, v42
    v_sub_f32 v75, v75, v42
    v_sub_f32 v108, v108, v42
    v_sub_f32 v124, v124, v42
    v_sub_f32 v76, v76, v42
    v_sub_f32 v109, v109, v42
    v_sub_f32 v125, v125, v42
    v_sub_f32 v77, v77, v42
    v_sub_f32 v110, v110, v42
    v_sub_f32 v126, v126, v42
    v_sub_f32 v78, v78, v42
    v_sub_f32 v111, v111, v42
    v_sub_f32 v127, v127, v42
    v_sub_f32 v79, v79, v42
    v_mul_f32 v34, v34, v44
    v_accvgpr_read_b32 v38, a0
    v_mul_f32 v38, v38, v44
    v_accvgpr_write_b32 a0, v38
    v_accvgpr_read_b32 v39, a1
    v_mul_f32 v39, v39, v44
    v_accvgpr_write_b32 a1, v39
    v_accvgpr_read_b32 v40, a2
    v_mul_f32 v40, v40, v44
    v_accvgpr_write_b32 a2, v40
    v_accvgpr_read_b32 v41, a3
    v_mul_f32 v41, v41, v44
    v_accvgpr_write_b32 a3, v41
    v_accvgpr_read_b32 v38, a4
    v_mul_f32 v38, v38, v44
    v_accvgpr_write_b32 a4, v38
    v_accvgpr_read_b32 v39, a5
    v_mul_f32 v39, v39, v44
    v_accvgpr_write_b32 a5, v39
    v_accvgpr_read_b32 v40, a6
    v_mul_f32 v40, v40, v44
    v_accvgpr_write_b32 a6, v40
    v_accvgpr_read_b32 v41, a7
    v_mul_f32 v41, v41, v44
    v_accvgpr_write_b32 a7, v41
    v_accvgpr_read_b32 v38, a8
    v_mul_f32 v38, v38, v44
    v_accvgpr_write_b32 a8, v38
    v_accvgpr_read_b32 v39, a9
    v_mul_f32 v39, v39, v44
    v_accvgpr_write_b32 a9, v39
    v_accvgpr_read_b32 v40, a10
    v_mul_f32 v40, v40, v44
    v_accvgpr_write_b32 a10, v40
    v_accvgpr_read_b32 v41, a11
    v_mul_f32 v41, v41, v44
    v_accvgpr_write_b32 a11, v41
    v_accvgpr_read_b32 v38, a12
    v_mul_f32 v38, v38, v44
    v_accvgpr_write_b32 a12, v38
    v_accvgpr_read_b32 v39, a13
    v_mul_f32 v39, v39, v44
    v_accvgpr_write_b32 a13, v39
    v_accvgpr_read_b32 v40, a14
    v_mul_f32 v40, v40, v44
    v_accvgpr_write_b32 a14, v40
    v_accvgpr_read_b32 v41, a15
    v_mul_f32 v41, v41, v44
    v_accvgpr_write_b32 a15, v41
    v_accvgpr_read_b32 v38, a16
    v_mul_f32 v38, v38, v44
    v_accvgpr_write_b32 a16, v38
    v_accvgpr_read_b32 v39, a17
    v_mul_f32 v39, v39, v44
    v_accvgpr_write_b32 a17, v39
    v_accvgpr_read_b32 v40, a18
    v_mul_f32 v40, v40, v44
    v_accvgpr_write_b32 a18, v40
    v_accvgpr_read_b32 v41, a19
    v_mul_f32 v41, v41, v44
    v_accvgpr_write_b32 a19, v41
    v_accvgpr_read_b32 v38, a20
    v_mul_f32 v38, v38, v44
    v_accvgpr_write_b32 a20, v38
    v_accvgpr_read_b32 v39, a21
    v_mul_f32 v39, v39, v44
    v_accvgpr_write_b32 a21, v39
    v_accvgpr_read_b32 v40, a22
    v_mul_f32 v40, v40, v44
    v_accvgpr_write_b32 a22, v40
    v_accvgpr_read_b32 v41, a23
    v_mul_f32 v41, v41, v44
    v_accvgpr_write_b32 a23, v41
    v_accvgpr_read_b32 v38, a24
    v_mul_f32 v38, v38, v44
    v_accvgpr_write_b32 a24, v38
    v_accvgpr_read_b32 v39, a25
    v_mul_f32 v39, v39, v44
    v_accvgpr_write_b32 a25, v39
    v_accvgpr_read_b32 v40, a26
    v_mul_f32 v40, v40, v44
    v_accvgpr_write_b32 a26, v40
    v_accvgpr_read_b32 v41, a27
    v_mul_f32 v41, v41, v44
    v_accvgpr_write_b32 a27, v41
    v_accvgpr_read_b32 v38, a28
    v_mul_f32 v38, v38, v44
    v_accvgpr_write_b32 a28, v38
    v_accvgpr_read_b32 v39, a29
    v_mul_f32 v39, v39, v44
    v_accvgpr_write_b32 a29, v39
    v_accvgpr_read_b32 v40, a30
    v_mul_f32 v40, v40, v44
    v_accvgpr_write_b32 a30, v40
    v_accvgpr_read_b32 v41, a31
    v_mul_f32 v41, v41, v44
    v_accvgpr_write_b32 a31, v41
    v_accvgpr_read_b32 v38, a32
    v_mul_f32 v38, v38, v44
    v_accvgpr_write_b32 a32, v38
    v_accvgpr_read_b32 v39, a33
    v_mul_f32 v39, v39, v44
    v_accvgpr_write_b32 a33, v39
    v_accvgpr_read_b32 v40, a34
    v_mul_f32 v40, v40, v44
    v_accvgpr_write_b32 a34, v40
    v_accvgpr_read_b32 v41, a35
    v_mul_f32 v41, v41, v44
    v_accvgpr_write_b32 a35, v41
    v_accvgpr_read_b32 v38, a36
    v_mul_f32 v38, v38, v44
    v_accvgpr_write_b32 a36, v38
    v_accvgpr_read_b32 v39, a37
    v_mul_f32 v39, v39, v44
    v_accvgpr_write_b32 a37, v39
    v_accvgpr_read_b32 v40, a38
    v_mul_f32 v40, v40, v44
    v_accvgpr_write_b32 a38, v40
    v_accvgpr_read_b32 v41, a39
    v_mul_f32 v41, v41, v44
    v_accvgpr_write_b32 a39, v41
    v_accvgpr_read_b32 v38, a40
    v_mul_f32 v38, v38, v44
    v_accvgpr_write_b32 a40, v38
    v_accvgpr_read_b32 v39, a41
    v_mul_f32 v39, v39, v44
    v_accvgpr_write_b32 a41, v39
    v_accvgpr_read_b32 v40, a42
    v_mul_f32 v40, v40, v44
    v_accvgpr_write_b32 a42, v40
    v_accvgpr_read_b32 v41, a43
    v_mul_f32 v41, v41, v44
    v_accvgpr_write_b32 a43, v41
    v_accvgpr_read_b32 v38, a44
    v_mul_f32 v38, v38, v44
    v_accvgpr_write_b32 a44, v38
    v_accvgpr_read_b32 v39, a45
    v_mul_f32 v39, v39, v44
    v_accvgpr_write_b32 a45, v39
    v_accvgpr_read_b32 v40, a46
    v_mul_f32 v40, v40, v44
    v_accvgpr_write_b32 a46, v40
    v_accvgpr_read_b32 v41, a47
    v_mul_f32 v41, v41, v44
    v_accvgpr_write_b32 a47, v41
    v_accvgpr_read_b32 v38, a48
    v_mul_f32 v38, v38, v44
    v_accvgpr_write_b32 a48, v38
    v_accvgpr_read_b32 v39, a49
    v_mul_f32 v39, v39, v44
    v_accvgpr_write_b32 a49, v39
    v_accvgpr_read_b32 v40, a50
    v_mul_f32 v40, v40, v44
    v_accvgpr_write_b32 a50, v40
    v_accvgpr_read_b32 v41, a51
    v_mul_f32 v41, v41, v44
    v_accvgpr_write_b32 a51, v41
    v_accvgpr_read_b32 v38, a52
    v_mul_f32 v38, v38, v44
    v_accvgpr_write_b32 a52, v38
    v_accvgpr_read_b32 v39, a53
    v_mul_f32 v39, v39, v44
    v_accvgpr_write_b32 a53, v39
    v_accvgpr_read_b32 v40, a54
    v_mul_f32 v40, v40, v44
    v_accvgpr_write_b32 a54, v40
    v_accvgpr_read_b32 v41, a55
    v_mul_f32 v41, v41, v44
    v_accvgpr_write_b32 a55, v41
    v_accvgpr_read_b32 v38, a56
    v_mul_f32 v38, v38, v44
    v_accvgpr_write_b32 a56, v38
    v_accvgpr_read_b32 v39, a57
    v_mul_f32 v39, v39, v44
    v_accvgpr_write_b32 a57, v39
    v_accvgpr_read_b32 v40, a58
    v_mul_f32 v40, v40, v44
    v_accvgpr_write_b32 a58, v40
    v_accvgpr_read_b32 v41, a59
    v_mul_f32 v41, v41, v44
    v_accvgpr_write_b32 a59, v41
    v_accvgpr_read_b32 v38, a60
    v_mul_f32 v38, v38, v44
    v_accvgpr_write_b32 a60, v38
    v_accvgpr_read_b32 v39, a61
    v_mul_f32 v39, v39, v44
    v_accvgpr_write_b32 a61, v39
    v_accvgpr_read_b32 v40, a62
    v_mul_f32 v40, v40, v44
    v_accvgpr_write_b32 a62, v40
    v_accvgpr_read_b32 v41, a63
    v_mul_f32 v41, v41, v44
    v_accvgpr_write_b32 a63, v41
    v_accvgpr_read_b32 v38, a64
    v_mul_f32 v38, v38, v44
    v_accvgpr_write_b32 a64, v38
    v_accvgpr_read_b32 v39, a65
    v_mul_f32 v39, v39, v44
    v_accvgpr_write_b32 a65, v39
    v_accvgpr_read_b32 v40, a66
    v_mul_f32 v40, v40, v44
    v_accvgpr_write_b32 a66, v40
    v_accvgpr_read_b32 v41, a67
    v_mul_f32 v41, v41, v44
    v_accvgpr_write_b32 a67, v41
    v_accvgpr_read_b32 v38, a68
    v_mul_f32 v38, v38, v44
    v_accvgpr_write_b32 a68, v38
    v_accvgpr_read_b32 v39, a69
    v_mul_f32 v39, v39, v44
    v_accvgpr_write_b32 a69, v39
    v_accvgpr_read_b32 v40, a70
    v_mul_f32 v40, v40, v44
    v_accvgpr_write_b32 a70, v40
    v_accvgpr_read_b32 v41, a71
    v_mul_f32 v41, v41, v44
    v_accvgpr_write_b32 a71, v41
    v_accvgpr_read_b32 v38, a72
    v_mul_f32 v38, v38, v44
    v_accvgpr_write_b32 a72, v38
    v_accvgpr_read_b32 v39, a73
    v_mul_f32 v39, v39, v44
    v_accvgpr_write_b32 a73, v39
    v_accvgpr_read_b32 v40, a74
    v_mul_f32 v40, v40, v44
    v_accvgpr_write_b32 a74, v40
    v_accvgpr_read_b32 v41, a75
    v_mul_f32 v41, v41, v44
    v_accvgpr_write_b32 a75, v41
    v_accvgpr_read_b32 v38, a76
    v_mul_f32 v38, v38, v44
    v_accvgpr_write_b32 a76, v38
    v_accvgpr_read_b32 v39, a77
    v_mul_f32 v39, v39, v44
    v_accvgpr_write_b32 a77, v39
    v_accvgpr_read_b32 v40, a78
    v_mul_f32 v40, v40, v44
    v_accvgpr_write_b32 a78, v40
    v_accvgpr_read_b32 v41, a79
    v_mul_f32 v41, v41, v44
    v_accvgpr_write_b32 a79, v41
    v_accvgpr_read_b32 v38, a80
    v_mul_f32 v38, v38, v44
    v_accvgpr_write_b32 a80, v38
    v_accvgpr_read_b32 v39, a81
    v_mul_f32 v39, v39, v44
    v_accvgpr_write_b32 a81, v39
    v_accvgpr_read_b32 v40, a82
    v_mul_f32 v40, v40, v44
    v_accvgpr_write_b32 a82, v40
    v_accvgpr_read_b32 v41, a83
    v_mul_f32 v41, v41, v44
    v_accvgpr_write_b32 a83, v41
    v_accvgpr_read_b32 v38, a84
    v_mul_f32 v38, v38, v44
    v_accvgpr_write_b32 a84, v38
    v_accvgpr_read_b32 v39, a85
    v_mul_f32 v39, v39, v44
    v_accvgpr_write_b32 a85, v39
    v_accvgpr_read_b32 v40, a86
    v_mul_f32 v40, v40, v44
    v_accvgpr_write_b32 a86, v40
    v_accvgpr_read_b32 v41, a87
    v_mul_f32 v41, v41, v44
    v_accvgpr_write_b32 a87, v41
    v_accvgpr_read_b32 v38, a88
    v_mul_f32 v38, v38, v44
    v_accvgpr_write_b32 a88, v38
    v_accvgpr_read_b32 v39, a89
    v_mul_f32 v39, v39, v44
    v_accvgpr_write_b32 a89, v39
    v_accvgpr_read_b32 v40, a90
    v_mul_f32 v40, v40, v44
    v_accvgpr_write_b32 a90, v40
    v_accvgpr_read_b32 v41, a91
    v_mul_f32 v41, v41, v44
    v_accvgpr_write_b32 a91, v41
    v_accvgpr_read_b32 v38, a92
    v_mul_f32 v38, v38, v44
    v_accvgpr_write_b32 a92, v38
    v_accvgpr_read_b32 v39, a93
    v_mul_f32 v39, v39, v44
    v_accvgpr_write_b32 a93, v39
    v_accvgpr_read_b32 v40, a94
    v_mul_f32 v40, v40, v44
    v_accvgpr_write_b32 a94, v40
    v_accvgpr_read_b32 v41, a95
    v_mul_f32 v41, v41, v44
    v_accvgpr_write_b32 a95, v41
    v_accvgpr_read_b32 v38, a96
    v_mul_f32 v38, v38, v44
    v_accvgpr_write_b32 a96, v38
    v_accvgpr_read_b32 v39, a97
    v_mul_f32 v39, v39, v44
    v_accvgpr_write_b32 a97, v39
    v_accvgpr_read_b32 v40, a98
    v_mul_f32 v40, v40, v44
    v_accvgpr_write_b32 a98, v40
    v_accvgpr_read_b32 v41, a99
    v_mul_f32 v41, v41, v44
    v_accvgpr_write_b32 a99, v41
    v_accvgpr_read_b32 v38, a100
    v_mul_f32 v38, v38, v44
    v_accvgpr_write_b32 a100, v38
    v_accvgpr_read_b32 v39, a101
    v_mul_f32 v39, v39, v44
    v_accvgpr_write_b32 a101, v39
    v_accvgpr_read_b32 v40, a102
    v_mul_f32 v40, v40, v44
    v_accvgpr_write_b32 a102, v40
    v_accvgpr_read_b32 v41, a103
    v_mul_f32 v41, v41, v44
    v_accvgpr_write_b32 a103, v41
    v_accvgpr_read_b32 v38, a104
    v_mul_f32 v38, v38, v44
    v_accvgpr_write_b32 a104, v38
    v_accvgpr_read_b32 v39, a105
    v_mul_f32 v39, v39, v44
    v_accvgpr_write_b32 a105, v39
    v_accvgpr_read_b32 v40, a106
    v_mul_f32 v40, v40, v44
    v_accvgpr_write_b32 a106, v40
    v_accvgpr_read_b32 v41, a107
    v_mul_f32 v41, v41, v44
    v_accvgpr_write_b32 a107, v41
    v_accvgpr_read_b32 v38, a108
    v_mul_f32 v38, v38, v44
    v_accvgpr_write_b32 a108, v38
    v_accvgpr_read_b32 v39, a109
    v_mul_f32 v39, v39, v44
    v_accvgpr_write_b32 a109, v39
    v_accvgpr_read_b32 v40, a110
    v_mul_f32 v40, v40, v44
    v_accvgpr_write_b32 a110, v40
    v_accvgpr_read_b32 v41, a111
    v_mul_f32 v41, v41, v44
    v_accvgpr_write_b32 a111, v41
    v_accvgpr_read_b32 v38, a112
    v_mul_f32 v38, v38, v44
    v_accvgpr_write_b32 a112, v38
    v_accvgpr_read_b32 v39, a113
    v_mul_f32 v39, v39, v44
    v_accvgpr_write_b32 a113, v39
    v_accvgpr_read_b32 v40, a114
    v_mul_f32 v40, v40, v44
    v_accvgpr_write_b32 a114, v40
    v_accvgpr_read_b32 v41, a115
    v_mul_f32 v41, v41, v44
    v_accvgpr_write_b32 a115, v41
    v_accvgpr_read_b32 v38, a116
    v_mul_f32 v38, v38, v44
    v_accvgpr_write_b32 a116, v38
    v_accvgpr_read_b32 v39, a117
    v_mul_f32 v39, v39, v44
    v_accvgpr_write_b32 a117, v39
    v_accvgpr_read_b32 v40, a118
    v_mul_f32 v40, v40, v44
    v_accvgpr_write_b32 a118, v40
    v_accvgpr_read_b32 v41, a119
    v_mul_f32 v41, v41, v44
    v_accvgpr_write_b32 a119, v41
    v_accvgpr_read_b32 v38, a120
    v_mul_f32 v38, v38, v44
    v_accvgpr_write_b32 a120, v38
    v_accvgpr_read_b32 v39, a121
    v_mul_f32 v39, v39, v44
    v_accvgpr_write_b32 a121, v39
    v_accvgpr_read_b32 v40, a122
    v_mul_f32 v40, v40, v44
    v_accvgpr_write_b32 a122, v40
    v_accvgpr_read_b32 v41, a123
    v_mul_f32 v41, v41, v44
    v_accvgpr_write_b32 a123, v41
    v_accvgpr_read_b32 v38, a124
    v_mul_f32 v38, v38, v44
    v_accvgpr_write_b32 a124, v38
    v_accvgpr_read_b32 v39, a125
    v_mul_f32 v39, v39, v44
    v_accvgpr_write_b32 a125, v39
    v_accvgpr_read_b32 v40, a126
    v_mul_f32 v40, v40, v44
    v_accvgpr_write_b32 a126, v40
    v_accvgpr_read_b32 v41, a127
    v_mul_f32 v41, v41, v44
    v_accvgpr_write_b32 a127, v41
    v_exp_f32 v38, v96
    v_exp_f32 v39, v97
    v_exp_f32 v40, v98
    v_exp_f32 v41, v99
    v_add_f32 v36, v38, v39
    v_cvt_pk_bf16_f32 v48, v38, v39
    v_exp_f32 v38, v100
    v_exp_f32 v39, v101
    v_add_f32 v37, v40, v41
    v_cvt_pk_bf16_f32 v49, v40, v41
    v_exp_f32 v40, v102
    v_exp_f32 v41, v103
    v_add_f32 v36, v36, v38
    v_add_f32 v37, v37, v39
    v_cvt_pk_bf16_f32 v50, v38, v39
    v_exp_f32 v38, v104
    v_exp_f32 v39, v105
    v_add_f32 v36, v36, v40
    v_add_f32 v37, v37, v41
    v_cvt_pk_bf16_f32 v51, v40, v41
    v_exp_f32 v40, v106
    v_exp_f32 v41, v107
    v_add_f32 v36, v36, v38
    v_add_f32 v37, v37, v39
    v_cvt_pk_bf16_f32 v52, v38, v39
    v_exp_f32 v38, v108
    v_exp_f32 v39, v109
    v_add_f32 v36, v36, v40
    v_add_f32 v37, v37, v41
    v_cvt_pk_bf16_f32 v53, v40, v41
    v_exp_f32 v40, v110
    v_exp_f32 v41, v111
    v_add_f32 v36, v36, v38
    v_add_f32 v37, v37, v39
    v_cvt_pk_bf16_f32 v54, v38, v39
    s_nop 0
    v_add_f32 v36, v36, v40
    v_add_f32 v37, v37, v41
    v_cvt_pk_bf16_f32 v55, v40, v41
    v_add_f32 v35, v36, v37
    s_nop 3
    s_branch L_front_back_10
L_front_slow_11:
    s_nop 15
    s_nop 7
    v_max3_f32 v42, v112, v113, v114
    v_max3_f32 v42, v42, v115, v116
    v_max3_f32 v42, v42, v117, v118
    v_max3_f32 v42, v42, v119, v120
    v_max3_f32 v42, v42, v121, v122
    v_max3_f32 v42, v42, v123, v124
    v_max3_f32 v42, v42, v125, v126
    v_max_f32 v42, v42, v127
    v_mov_b32 v43, v42
    s_nop 1
    v_permlane32_swap_b32 v43, v42
    s_nop 1
    v_max_f32 v42, v42, v43
    v_max_f32 v42, 0, v42
    v_sub_f32 v44, 0, v42
    v_exp_f32 v44, v44
    v_sub_f32 v112, v112, v42
    v_sub_f32 v80, v80, v42
    v_sub_f32 v64, v64, v42
    v_sub_f32 v113, v113, v42
    v_sub_f32 v81, v81, v42
    v_sub_f32 v65, v65, v42
    v_sub_f32 v114, v114, v42
    v_sub_f32 v82, v82, v42
    v_sub_f32 v66, v66, v42
    v_sub_f32 v115, v115, v42
    v_sub_f32 v83, v83, v42
    v_sub_f32 v67, v67, v42
    v_sub_f32 v116, v116, v42
    v_sub_f32 v84, v84, v42
    v_sub_f32 v68, v68, v42
    v_sub_f32 v117, v117, v42
    v_sub_f32 v85, v85, v42
    v_sub_f32 v69, v69, v42
    v_sub_f32 v118, v118, v42
    v_sub_f32 v86, v86, v42
    v_sub_f32 v70, v70, v42
    v_sub_f32 v119, v119, v42
    v_sub_f32 v87, v87, v42
    v_sub_f32 v71, v71, v42
    v_sub_f32 v120, v120, v42
    v_sub_f32 v88, v88, v42
    v_sub_f32 v72, v72, v42
    v_sub_f32 v121, v121, v42
    v_sub_f32 v89, v89, v42
    v_sub_f32 v73, v73, v42
    v_sub_f32 v122, v122, v42
    v_sub_f32 v90, v90, v42
    v_sub_f32 v74, v74, v42
    v_sub_f32 v123, v123, v42
    v_sub_f32 v91, v91, v42
    v_sub_f32 v75, v75, v42
    v_sub_f32 v124, v124, v42
    v_sub_f32 v92, v92, v42
    v_sub_f32 v76, v76, v42
    v_sub_f32 v125, v125, v42
    v_sub_f32 v93, v93, v42
    v_sub_f32 v77, v77, v42
    v_sub_f32 v126, v126, v42
    v_sub_f32 v94, v94, v42
    v_sub_f32 v78, v78, v42
    v_sub_f32 v127, v127, v42
    v_sub_f32 v95, v95, v42
    v_sub_f32 v79, v79, v42
    v_mul_f32 v34, v34, v44
    v_accvgpr_read_b32 v38, a0
    v_mul_f32 v38, v38, v44
    v_accvgpr_write_b32 a0, v38
    v_accvgpr_read_b32 v39, a1
    v_mul_f32 v39, v39, v44
    v_accvgpr_write_b32 a1, v39
    v_accvgpr_read_b32 v40, a2
    v_mul_f32 v40, v40, v44
    v_accvgpr_write_b32 a2, v40
    v_accvgpr_read_b32 v41, a3
    v_mul_f32 v41, v41, v44
    v_accvgpr_write_b32 a3, v41
    v_accvgpr_read_b32 v38, a4
    v_mul_f32 v38, v38, v44
    v_accvgpr_write_b32 a4, v38
    v_accvgpr_read_b32 v39, a5
    v_mul_f32 v39, v39, v44
    v_accvgpr_write_b32 a5, v39
    v_accvgpr_read_b32 v40, a6
    v_mul_f32 v40, v40, v44
    v_accvgpr_write_b32 a6, v40
    v_accvgpr_read_b32 v41, a7
    v_mul_f32 v41, v41, v44
    v_accvgpr_write_b32 a7, v41
    v_accvgpr_read_b32 v38, a8
    v_mul_f32 v38, v38, v44
    v_accvgpr_write_b32 a8, v38
    v_accvgpr_read_b32 v39, a9
    v_mul_f32 v39, v39, v44
    v_accvgpr_write_b32 a9, v39
    v_accvgpr_read_b32 v40, a10
    v_mul_f32 v40, v40, v44
    v_accvgpr_write_b32 a10, v40
    v_accvgpr_read_b32 v41, a11
    v_mul_f32 v41, v41, v44
    v_accvgpr_write_b32 a11, v41
    v_accvgpr_read_b32 v38, a12
    v_mul_f32 v38, v38, v44
    v_accvgpr_write_b32 a12, v38
    v_accvgpr_read_b32 v39, a13
    v_mul_f32 v39, v39, v44
    v_accvgpr_write_b32 a13, v39
    v_accvgpr_read_b32 v40, a14
    v_mul_f32 v40, v40, v44
    v_accvgpr_write_b32 a14, v40
    v_accvgpr_read_b32 v41, a15
    v_mul_f32 v41, v41, v44
    v_accvgpr_write_b32 a15, v41
    v_accvgpr_read_b32 v38, a16
    v_mul_f32 v38, v38, v44
    v_accvgpr_write_b32 a16, v38
    v_accvgpr_read_b32 v39, a17
    v_mul_f32 v39, v39, v44
    v_accvgpr_write_b32 a17, v39
    v_accvgpr_read_b32 v40, a18
    v_mul_f32 v40, v40, v44
    v_accvgpr_write_b32 a18, v40
    v_accvgpr_read_b32 v41, a19
    v_mul_f32 v41, v41, v44
    v_accvgpr_write_b32 a19, v41
    v_accvgpr_read_b32 v38, a20
    v_mul_f32 v38, v38, v44
    v_accvgpr_write_b32 a20, v38
    v_accvgpr_read_b32 v39, a21
    v_mul_f32 v39, v39, v44
    v_accvgpr_write_b32 a21, v39
    v_accvgpr_read_b32 v40, a22
    v_mul_f32 v40, v40, v44
    v_accvgpr_write_b32 a22, v40
    v_accvgpr_read_b32 v41, a23
    v_mul_f32 v41, v41, v44
    v_accvgpr_write_b32 a23, v41
    v_accvgpr_read_b32 v38, a24
    v_mul_f32 v38, v38, v44
    v_accvgpr_write_b32 a24, v38
    v_accvgpr_read_b32 v39, a25
    v_mul_f32 v39, v39, v44
    v_accvgpr_write_b32 a25, v39
    v_accvgpr_read_b32 v40, a26
    v_mul_f32 v40, v40, v44
    v_accvgpr_write_b32 a26, v40
    v_accvgpr_read_b32 v41, a27
    v_mul_f32 v41, v41, v44
    v_accvgpr_write_b32 a27, v41
    v_accvgpr_read_b32 v38, a28
    v_mul_f32 v38, v38, v44
    v_accvgpr_write_b32 a28, v38
    v_accvgpr_read_b32 v39, a29
    v_mul_f32 v39, v39, v44
    v_accvgpr_write_b32 a29, v39
    v_accvgpr_read_b32 v40, a30
    v_mul_f32 v40, v40, v44
    v_accvgpr_write_b32 a30, v40
    v_accvgpr_read_b32 v41, a31
    v_mul_f32 v41, v41, v44
    v_accvgpr_write_b32 a31, v41
    v_accvgpr_read_b32 v38, a32
    v_mul_f32 v38, v38, v44
    v_accvgpr_write_b32 a32, v38
    v_accvgpr_read_b32 v39, a33
    v_mul_f32 v39, v39, v44
    v_accvgpr_write_b32 a33, v39
    v_accvgpr_read_b32 v40, a34
    v_mul_f32 v40, v40, v44
    v_accvgpr_write_b32 a34, v40
    v_accvgpr_read_b32 v41, a35
    v_mul_f32 v41, v41, v44
    v_accvgpr_write_b32 a35, v41
    v_accvgpr_read_b32 v38, a36
    v_mul_f32 v38, v38, v44
    v_accvgpr_write_b32 a36, v38
    v_accvgpr_read_b32 v39, a37
    v_mul_f32 v39, v39, v44
    v_accvgpr_write_b32 a37, v39
    v_accvgpr_read_b32 v40, a38
    v_mul_f32 v40, v40, v44
    v_accvgpr_write_b32 a38, v40
    v_accvgpr_read_b32 v41, a39
    v_mul_f32 v41, v41, v44
    v_accvgpr_write_b32 a39, v41
    v_accvgpr_read_b32 v38, a40
    v_mul_f32 v38, v38, v44
    v_accvgpr_write_b32 a40, v38
    v_accvgpr_read_b32 v39, a41
    v_mul_f32 v39, v39, v44
    v_accvgpr_write_b32 a41, v39
    v_accvgpr_read_b32 v40, a42
    v_mul_f32 v40, v40, v44
    v_accvgpr_write_b32 a42, v40
    v_accvgpr_read_b32 v41, a43
    v_mul_f32 v41, v41, v44
    v_accvgpr_write_b32 a43, v41
    v_accvgpr_read_b32 v38, a44
    v_mul_f32 v38, v38, v44
    v_accvgpr_write_b32 a44, v38
    v_accvgpr_read_b32 v39, a45
    v_mul_f32 v39, v39, v44
    v_accvgpr_write_b32 a45, v39
    v_accvgpr_read_b32 v40, a46
    v_mul_f32 v40, v40, v44
    v_accvgpr_write_b32 a46, v40
    v_accvgpr_read_b32 v41, a47
    v_mul_f32 v41, v41, v44
    v_accvgpr_write_b32 a47, v41
    v_accvgpr_read_b32 v38, a48
    v_mul_f32 v38, v38, v44
    v_accvgpr_write_b32 a48, v38
    v_accvgpr_read_b32 v39, a49
    v_mul_f32 v39, v39, v44
    v_accvgpr_write_b32 a49, v39
    v_accvgpr_read_b32 v40, a50
    v_mul_f32 v40, v40, v44
    v_accvgpr_write_b32 a50, v40
    v_accvgpr_read_b32 v41, a51
    v_mul_f32 v41, v41, v44
    v_accvgpr_write_b32 a51, v41
    v_accvgpr_read_b32 v38, a52
    v_mul_f32 v38, v38, v44
    v_accvgpr_write_b32 a52, v38
    v_accvgpr_read_b32 v39, a53
    v_mul_f32 v39, v39, v44
    v_accvgpr_write_b32 a53, v39
    v_accvgpr_read_b32 v40, a54
    v_mul_f32 v40, v40, v44
    v_accvgpr_write_b32 a54, v40
    v_accvgpr_read_b32 v41, a55
    v_mul_f32 v41, v41, v44
    v_accvgpr_write_b32 a55, v41
    v_accvgpr_read_b32 v38, a56
    v_mul_f32 v38, v38, v44
    v_accvgpr_write_b32 a56, v38
    v_accvgpr_read_b32 v39, a57
    v_mul_f32 v39, v39, v44
    v_accvgpr_write_b32 a57, v39
    v_accvgpr_read_b32 v40, a58
    v_mul_f32 v40, v40, v44
    v_accvgpr_write_b32 a58, v40
    v_accvgpr_read_b32 v41, a59
    v_mul_f32 v41, v41, v44
    v_accvgpr_write_b32 a59, v41
    v_accvgpr_read_b32 v38, a60
    v_mul_f32 v38, v38, v44
    v_accvgpr_write_b32 a60, v38
    v_accvgpr_read_b32 v39, a61
    v_mul_f32 v39, v39, v44
    v_accvgpr_write_b32 a61, v39
    v_accvgpr_read_b32 v40, a62
    v_mul_f32 v40, v40, v44
    v_accvgpr_write_b32 a62, v40
    v_accvgpr_read_b32 v41, a63
    v_mul_f32 v41, v41, v44
    v_accvgpr_write_b32 a63, v41
    v_accvgpr_read_b32 v38, a64
    v_mul_f32 v38, v38, v44
    v_accvgpr_write_b32 a64, v38
    v_accvgpr_read_b32 v39, a65
    v_mul_f32 v39, v39, v44
    v_accvgpr_write_b32 a65, v39
    v_accvgpr_read_b32 v40, a66
    v_mul_f32 v40, v40, v44
    v_accvgpr_write_b32 a66, v40
    v_accvgpr_read_b32 v41, a67
    v_mul_f32 v41, v41, v44
    v_accvgpr_write_b32 a67, v41
    v_accvgpr_read_b32 v38, a68
    v_mul_f32 v38, v38, v44
    v_accvgpr_write_b32 a68, v38
    v_accvgpr_read_b32 v39, a69
    v_mul_f32 v39, v39, v44
    v_accvgpr_write_b32 a69, v39
    v_accvgpr_read_b32 v40, a70
    v_mul_f32 v40, v40, v44
    v_accvgpr_write_b32 a70, v40
    v_accvgpr_read_b32 v41, a71
    v_mul_f32 v41, v41, v44
    v_accvgpr_write_b32 a71, v41
    v_accvgpr_read_b32 v38, a72
    v_mul_f32 v38, v38, v44
    v_accvgpr_write_b32 a72, v38
    v_accvgpr_read_b32 v39, a73
    v_mul_f32 v39, v39, v44
    v_accvgpr_write_b32 a73, v39
    v_accvgpr_read_b32 v40, a74
    v_mul_f32 v40, v40, v44
    v_accvgpr_write_b32 a74, v40
    v_accvgpr_read_b32 v41, a75
    v_mul_f32 v41, v41, v44
    v_accvgpr_write_b32 a75, v41
    v_accvgpr_read_b32 v38, a76
    v_mul_f32 v38, v38, v44
    v_accvgpr_write_b32 a76, v38
    v_accvgpr_read_b32 v39, a77
    v_mul_f32 v39, v39, v44
    v_accvgpr_write_b32 a77, v39
    v_accvgpr_read_b32 v40, a78
    v_mul_f32 v40, v40, v44
    v_accvgpr_write_b32 a78, v40
    v_accvgpr_read_b32 v41, a79
    v_mul_f32 v41, v41, v44
    v_accvgpr_write_b32 a79, v41
    v_accvgpr_read_b32 v38, a80
    v_mul_f32 v38, v38, v44
    v_accvgpr_write_b32 a80, v38
    v_accvgpr_read_b32 v39, a81
    v_mul_f32 v39, v39, v44
    v_accvgpr_write_b32 a81, v39
    v_accvgpr_read_b32 v40, a82
    v_mul_f32 v40, v40, v44
    v_accvgpr_write_b32 a82, v40
    v_accvgpr_read_b32 v41, a83
    v_mul_f32 v41, v41, v44
    v_accvgpr_write_b32 a83, v41
    v_accvgpr_read_b32 v38, a84
    v_mul_f32 v38, v38, v44
    v_accvgpr_write_b32 a84, v38
    v_accvgpr_read_b32 v39, a85
    v_mul_f32 v39, v39, v44
    v_accvgpr_write_b32 a85, v39
    v_accvgpr_read_b32 v40, a86
    v_mul_f32 v40, v40, v44
    v_accvgpr_write_b32 a86, v40
    v_accvgpr_read_b32 v41, a87
    v_mul_f32 v41, v41, v44
    v_accvgpr_write_b32 a87, v41
    v_accvgpr_read_b32 v38, a88
    v_mul_f32 v38, v38, v44
    v_accvgpr_write_b32 a88, v38
    v_accvgpr_read_b32 v39, a89
    v_mul_f32 v39, v39, v44
    v_accvgpr_write_b32 a89, v39
    v_accvgpr_read_b32 v40, a90
    v_mul_f32 v40, v40, v44
    v_accvgpr_write_b32 a90, v40
    v_accvgpr_read_b32 v41, a91
    v_mul_f32 v41, v41, v44
    v_accvgpr_write_b32 a91, v41
    v_accvgpr_read_b32 v38, a92
    v_mul_f32 v38, v38, v44
    v_accvgpr_write_b32 a92, v38
    v_accvgpr_read_b32 v39, a93
    v_mul_f32 v39, v39, v44
    v_accvgpr_write_b32 a93, v39
    v_accvgpr_read_b32 v40, a94
    v_mul_f32 v40, v40, v44
    v_accvgpr_write_b32 a94, v40
    v_accvgpr_read_b32 v41, a95
    v_mul_f32 v41, v41, v44
    v_accvgpr_write_b32 a95, v41
    v_accvgpr_read_b32 v38, a96
    v_mul_f32 v38, v38, v44
    v_accvgpr_write_b32 a96, v38
    v_accvgpr_read_b32 v39, a97
    v_mul_f32 v39, v39, v44
    v_accvgpr_write_b32 a97, v39
    v_accvgpr_read_b32 v40, a98
    v_mul_f32 v40, v40, v44
    v_accvgpr_write_b32 a98, v40
    v_accvgpr_read_b32 v41, a99
    v_mul_f32 v41, v41, v44
    v_accvgpr_write_b32 a99, v41
    v_accvgpr_read_b32 v38, a100
    v_mul_f32 v38, v38, v44
    v_accvgpr_write_b32 a100, v38
    v_accvgpr_read_b32 v39, a101
    v_mul_f32 v39, v39, v44
    v_accvgpr_write_b32 a101, v39
    v_accvgpr_read_b32 v40, a102
    v_mul_f32 v40, v40, v44
    v_accvgpr_write_b32 a102, v40
    v_accvgpr_read_b32 v41, a103
    v_mul_f32 v41, v41, v44
    v_accvgpr_write_b32 a103, v41
    v_accvgpr_read_b32 v38, a104
    v_mul_f32 v38, v38, v44
    v_accvgpr_write_b32 a104, v38
    v_accvgpr_read_b32 v39, a105
    v_mul_f32 v39, v39, v44
    v_accvgpr_write_b32 a105, v39
    v_accvgpr_read_b32 v40, a106
    v_mul_f32 v40, v40, v44
    v_accvgpr_write_b32 a106, v40
    v_accvgpr_read_b32 v41, a107
    v_mul_f32 v41, v41, v44
    v_accvgpr_write_b32 a107, v41
    v_accvgpr_read_b32 v38, a108
    v_mul_f32 v38, v38, v44
    v_accvgpr_write_b32 a108, v38
    v_accvgpr_read_b32 v39, a109
    v_mul_f32 v39, v39, v44
    v_accvgpr_write_b32 a109, v39
    v_accvgpr_read_b32 v40, a110
    v_mul_f32 v40, v40, v44
    v_accvgpr_write_b32 a110, v40
    v_accvgpr_read_b32 v41, a111
    v_mul_f32 v41, v41, v44
    v_accvgpr_write_b32 a111, v41
    v_accvgpr_read_b32 v38, a112
    v_mul_f32 v38, v38, v44
    v_accvgpr_write_b32 a112, v38
    v_accvgpr_read_b32 v39, a113
    v_mul_f32 v39, v39, v44
    v_accvgpr_write_b32 a113, v39
    v_accvgpr_read_b32 v40, a114
    v_mul_f32 v40, v40, v44
    v_accvgpr_write_b32 a114, v40
    v_accvgpr_read_b32 v41, a115
    v_mul_f32 v41, v41, v44
    v_accvgpr_write_b32 a115, v41
    v_accvgpr_read_b32 v38, a116
    v_mul_f32 v38, v38, v44
    v_accvgpr_write_b32 a116, v38
    v_accvgpr_read_b32 v39, a117
    v_mul_f32 v39, v39, v44
    v_accvgpr_write_b32 a117, v39
    v_accvgpr_read_b32 v40, a118
    v_mul_f32 v40, v40, v44
    v_accvgpr_write_b32 a118, v40
    v_accvgpr_read_b32 v41, a119
    v_mul_f32 v41, v41, v44
    v_accvgpr_write_b32 a119, v41
    v_accvgpr_read_b32 v38, a120
    v_mul_f32 v38, v38, v44
    v_accvgpr_write_b32 a120, v38
    v_accvgpr_read_b32 v39, a121
    v_mul_f32 v39, v39, v44
    v_accvgpr_write_b32 a121, v39
    v_accvgpr_read_b32 v40, a122
    v_mul_f32 v40, v40, v44
    v_accvgpr_write_b32 a122, v40
    v_accvgpr_read_b32 v41, a123
    v_mul_f32 v41, v41, v44
    v_accvgpr_write_b32 a123, v41
    v_accvgpr_read_b32 v38, a124
    v_mul_f32 v38, v38, v44
    v_accvgpr_write_b32 a124, v38
    v_accvgpr_read_b32 v39, a125
    v_mul_f32 v39, v39, v44
    v_accvgpr_write_b32 a125, v39
    v_accvgpr_read_b32 v40, a126
    v_mul_f32 v40, v40, v44
    v_accvgpr_write_b32 a126, v40
    v_accvgpr_read_b32 v41, a127
    v_mul_f32 v41, v41, v44
    v_accvgpr_write_b32 a127, v41
    v_exp_f32 v38, v112
    v_exp_f32 v39, v113
    v_exp_f32 v40, v114
    v_exp_f32 v41, v115
    v_add_f32 v36, v38, v39
    v_cvt_pk_bf16_f32 v48, v38, v39
    v_exp_f32 v38, v116
    v_exp_f32 v39, v117
    v_add_f32 v37, v40, v41
    v_cvt_pk_bf16_f32 v49, v40, v41
    v_exp_f32 v40, v118
    v_exp_f32 v41, v119
    v_add_f32 v36, v36, v38
    v_add_f32 v37, v37, v39
    v_cvt_pk_bf16_f32 v50, v38, v39
    v_exp_f32 v38, v120
    v_exp_f32 v39, v121
    v_add_f32 v36, v36, v40
    v_add_f32 v37, v37, v41
    v_cvt_pk_bf16_f32 v51, v40, v41
    v_exp_f32 v40, v122
    v_exp_f32 v41, v123
    v_add_f32 v36, v36, v38
    v_add_f32 v37, v37, v39
    v_cvt_pk_bf16_f32 v52, v38, v39
    v_exp_f32 v38, v124
    v_exp_f32 v39, v125
    v_add_f32 v36, v36, v40
    v_add_f32 v37, v37, v41
    v_cvt_pk_bf16_f32 v53, v40, v41
    v_exp_f32 v40, v126
    v_exp_f32 v41, v127
    v_add_f32 v36, v36, v38
    v_add_f32 v37, v37, v39
    v_cvt_pk_bf16_f32 v54, v38, v39
    s_nop 0
    v_add_f32 v36, v36, v40
    v_add_f32 v37, v37, v41
    v_cvt_pk_bf16_f32 v55, v40, v41
    v_add_f32 v35, v36, v37
    s_nop 3
    s_branch L_front_back_12
L_front_slow_13:
    s_nop 15
    s_nop 7
    v_max3_f32 v42, v80, v81, v82
    v_max3_f32 v42, v42, v83, v84
    v_max3_f32 v42, v42, v85, v86
    v_max3_f32 v42, v42, v87, v88
    v_max3_f32 v42, v42, v89, v90
    v_max3_f32 v42, v42, v91, v92
    v_max3_f32 v42, v42, v93, v94
    v_max_f32 v42, v42, v95
    v_mov_b32 v43, v42
    s_nop 1
    v_permlane32_swap_b32 v43, v42
    s_nop 1
    v_max_f32 v42, v42, v43
    v_max_f32 v42, 0, v42
    v_sub_f32 v44, 0, v42
    v_exp_f32 v44, v44
    v_sub_f32 v80, v80, v42
    v_sub_f32 v96, v96, v42
    v_sub_f32 v64, v64, v42
    v_sub_f32 v81, v81, v42
    v_sub_f32 v97, v97, v42
    v_sub_f32 v65, v65, v42
    v_sub_f32 v82, v82, v42
    v_sub_f32 v98, v98, v42
    v_sub_f32 v66, v66, v42
    v_sub_f32 v83, v83, v42
    v_sub_f32 v99, v99, v42
    v_sub_f32 v67, v67, v42
    v_sub_f32 v84, v84, v42
    v_sub_f32 v100, v100, v42
    v_sub_f32 v68, v68, v42
    v_sub_f32 v85, v85, v42
    v_sub_f32 v101, v101, v42
    v_sub_f32 v69, v69, v42
    v_sub_f32 v86, v86, v42
    v_sub_f32 v102, v102, v42
    v_sub_f32 v70, v70, v42
    v_sub_f32 v87, v87, v42
    v_sub_f32 v103, v103, v42
    v_sub_f32 v71, v71, v42
    v_sub_f32 v88, v88, v42
    v_sub_f32 v104, v104, v42
    v_sub_f32 v72, v72, v42
    v_sub_f32 v89, v89, v42
    v_sub_f32 v105, v105, v42
    v_sub_f32 v73, v73, v42
    v_sub_f32 v90, v90, v42
    v_sub_f32 v106, v106, v42
    v_sub_f32 v74, v74, v42
    v_sub_f32 v91, v91, v42
    v_sub_f32 v107, v107, v42
    v_sub_f32 v75, v75, v42
    v_sub_f32 v92, v92, v42
    v_sub_f32 v108, v108, v42
    v_sub_f32 v76, v76, v42
    v_sub_f32 v93, v93, v42
    v_sub_f32 v109, v109, v42
    v_sub_f32 v77, v77, v42
    v_sub_f32 v94, v94, v42
    v_sub_f32 v110, v110, v42
    v_sub_f32 v78, v78, v42
    v_sub_f32 v95, v95, v42
    v_sub_f32 v111, v111, v42
    v_sub_f32 v79, v79, v42
    v_mul_f32 v34, v34, v44
    v_accvgpr_read_b32 v38, a0
    v_mul_f32 v38, v38, v44
    v_accvgpr_write_b32 a0, v38
    v_accvgpr_read_b32 v39, a1
    v_mul_f32 v39, v39, v44
    v_accvgpr_write_b32 a1, v39
    v_accvgpr_read_b32 v40, a2
    v_mul_f32 v40, v40, v44
    v_accvgpr_write_b32 a2, v40
    v_accvgpr_read_b32 v41, a3
    v_mul_f32 v41, v41, v44
    v_accvgpr_write_b32 a3, v41
    v_accvgpr_read_b32 v38, a4
    v_mul_f32 v38, v38, v44
    v_accvgpr_write_b32 a4, v38
    v_accvgpr_read_b32 v39, a5
    v_mul_f32 v39, v39, v44
    v_accvgpr_write_b32 a5, v39
    v_accvgpr_read_b32 v40, a6
    v_mul_f32 v40, v40, v44
    v_accvgpr_write_b32 a6, v40
    v_accvgpr_read_b32 v41, a7
    v_mul_f32 v41, v41, v44
    v_accvgpr_write_b32 a7, v41
    v_accvgpr_read_b32 v38, a8
    v_mul_f32 v38, v38, v44
    v_accvgpr_write_b32 a8, v38
    v_accvgpr_read_b32 v39, a9
    v_mul_f32 v39, v39, v44
    v_accvgpr_write_b32 a9, v39
    v_accvgpr_read_b32 v40, a10
    v_mul_f32 v40, v40, v44
    v_accvgpr_write_b32 a10, v40
    v_accvgpr_read_b32 v41, a11
    v_mul_f32 v41, v41, v44
    v_accvgpr_write_b32 a11, v41
    v_accvgpr_read_b32 v38, a12
    v_mul_f32 v38, v38, v44
    v_accvgpr_write_b32 a12, v38
    v_accvgpr_read_b32 v39, a13
    v_mul_f32 v39, v39, v44
    v_accvgpr_write_b32 a13, v39
    v_accvgpr_read_b32 v40, a14
    v_mul_f32 v40, v40, v44
    v_accvgpr_write_b32 a14, v40
    v_accvgpr_read_b32 v41, a15
    v_mul_f32 v41, v41, v44
    v_accvgpr_write_b32 a15, v41
    v_accvgpr_read_b32 v38, a16
    v_mul_f32 v38, v38, v44
    v_accvgpr_write_b32 a16, v38
    v_accvgpr_read_b32 v39, a17
    v_mul_f32 v39, v39, v44
    v_accvgpr_write_b32 a17, v39
    v_accvgpr_read_b32 v40, a18
    v_mul_f32 v40, v40, v44
    v_accvgpr_write_b32 a18, v40
    v_accvgpr_read_b32 v41, a19
    v_mul_f32 v41, v41, v44
    v_accvgpr_write_b32 a19, v41
    v_accvgpr_read_b32 v38, a20
    v_mul_f32 v38, v38, v44
    v_accvgpr_write_b32 a20, v38
    v_accvgpr_read_b32 v39, a21
    v_mul_f32 v39, v39, v44
    v_accvgpr_write_b32 a21, v39
    v_accvgpr_read_b32 v40, a22
    v_mul_f32 v40, v40, v44
    v_accvgpr_write_b32 a22, v40
    v_accvgpr_read_b32 v41, a23
    v_mul_f32 v41, v41, v44
    v_accvgpr_write_b32 a23, v41
    v_accvgpr_read_b32 v38, a24
    v_mul_f32 v38, v38, v44
    v_accvgpr_write_b32 a24, v38
    v_accvgpr_read_b32 v39, a25
    v_mul_f32 v39, v39, v44
    v_accvgpr_write_b32 a25, v39
    v_accvgpr_read_b32 v40, a26
    v_mul_f32 v40, v40, v44
    v_accvgpr_write_b32 a26, v40
    v_accvgpr_read_b32 v41, a27
    v_mul_f32 v41, v41, v44
    v_accvgpr_write_b32 a27, v41
    v_accvgpr_read_b32 v38, a28
    v_mul_f32 v38, v38, v44
    v_accvgpr_write_b32 a28, v38
    v_accvgpr_read_b32 v39, a29
    v_mul_f32 v39, v39, v44
    v_accvgpr_write_b32 a29, v39
    v_accvgpr_read_b32 v40, a30
    v_mul_f32 v40, v40, v44
    v_accvgpr_write_b32 a30, v40
    v_accvgpr_read_b32 v41, a31
    v_mul_f32 v41, v41, v44
    v_accvgpr_write_b32 a31, v41
    v_accvgpr_read_b32 v38, a32
    v_mul_f32 v38, v38, v44
    v_accvgpr_write_b32 a32, v38
    v_accvgpr_read_b32 v39, a33
    v_mul_f32 v39, v39, v44
    v_accvgpr_write_b32 a33, v39
    v_accvgpr_read_b32 v40, a34
    v_mul_f32 v40, v40, v44
    v_accvgpr_write_b32 a34, v40
    v_accvgpr_read_b32 v41, a35
    v_mul_f32 v41, v41, v44
    v_accvgpr_write_b32 a35, v41
    v_accvgpr_read_b32 v38, a36
    v_mul_f32 v38, v38, v44
    v_accvgpr_write_b32 a36, v38
    v_accvgpr_read_b32 v39, a37
    v_mul_f32 v39, v39, v44
    v_accvgpr_write_b32 a37, v39
    v_accvgpr_read_b32 v40, a38
    v_mul_f32 v40, v40, v44
    v_accvgpr_write_b32 a38, v40
    v_accvgpr_read_b32 v41, a39
    v_mul_f32 v41, v41, v44
    v_accvgpr_write_b32 a39, v41
    v_accvgpr_read_b32 v38, a40
    v_mul_f32 v38, v38, v44
    v_accvgpr_write_b32 a40, v38
    v_accvgpr_read_b32 v39, a41
    v_mul_f32 v39, v39, v44
    v_accvgpr_write_b32 a41, v39
    v_accvgpr_read_b32 v40, a42
    v_mul_f32 v40, v40, v44
    v_accvgpr_write_b32 a42, v40
    v_accvgpr_read_b32 v41, a43
    v_mul_f32 v41, v41, v44
    v_accvgpr_write_b32 a43, v41
    v_accvgpr_read_b32 v38, a44
    v_mul_f32 v38, v38, v44
    v_accvgpr_write_b32 a44, v38
    v_accvgpr_read_b32 v39, a45
    v_mul_f32 v39, v39, v44
    v_accvgpr_write_b32 a45, v39
    v_accvgpr_read_b32 v40, a46
    v_mul_f32 v40, v40, v44
    v_accvgpr_write_b32 a46, v40
    v_accvgpr_read_b32 v41, a47
    v_mul_f32 v41, v41, v44
    v_accvgpr_write_b32 a47, v41
    v_accvgpr_read_b32 v38, a48
    v_mul_f32 v38, v38, v44
    v_accvgpr_write_b32 a48, v38
    v_accvgpr_read_b32 v39, a49
    v_mul_f32 v39, v39, v44
    v_accvgpr_write_b32 a49, v39
    v_accvgpr_read_b32 v40, a50
    v_mul_f32 v40, v40, v44
    v_accvgpr_write_b32 a50, v40
    v_accvgpr_read_b32 v41, a51
    v_mul_f32 v41, v41, v44
    v_accvgpr_write_b32 a51, v41
    v_accvgpr_read_b32 v38, a52
    v_mul_f32 v38, v38, v44
    v_accvgpr_write_b32 a52, v38
    v_accvgpr_read_b32 v39, a53
    v_mul_f32 v39, v39, v44
    v_accvgpr_write_b32 a53, v39
    v_accvgpr_read_b32 v40, a54
    v_mul_f32 v40, v40, v44
    v_accvgpr_write_b32 a54, v40
    v_accvgpr_read_b32 v41, a55
    v_mul_f32 v41, v41, v44
    v_accvgpr_write_b32 a55, v41
    v_accvgpr_read_b32 v38, a56
    v_mul_f32 v38, v38, v44
    v_accvgpr_write_b32 a56, v38
    v_accvgpr_read_b32 v39, a57
    v_mul_f32 v39, v39, v44
    v_accvgpr_write_b32 a57, v39
    v_accvgpr_read_b32 v40, a58
    v_mul_f32 v40, v40, v44
    v_accvgpr_write_b32 a58, v40
    v_accvgpr_read_b32 v41, a59
    v_mul_f32 v41, v41, v44
    v_accvgpr_write_b32 a59, v41
    v_accvgpr_read_b32 v38, a60
    v_mul_f32 v38, v38, v44
    v_accvgpr_write_b32 a60, v38
    v_accvgpr_read_b32 v39, a61
    v_mul_f32 v39, v39, v44
    v_accvgpr_write_b32 a61, v39
    v_accvgpr_read_b32 v40, a62
    v_mul_f32 v40, v40, v44
    v_accvgpr_write_b32 a62, v40
    v_accvgpr_read_b32 v41, a63
    v_mul_f32 v41, v41, v44
    v_accvgpr_write_b32 a63, v41
    v_accvgpr_read_b32 v38, a64
    v_mul_f32 v38, v38, v44
    v_accvgpr_write_b32 a64, v38
    v_accvgpr_read_b32 v39, a65
    v_mul_f32 v39, v39, v44
    v_accvgpr_write_b32 a65, v39
    v_accvgpr_read_b32 v40, a66
    v_mul_f32 v40, v40, v44
    v_accvgpr_write_b32 a66, v40
    v_accvgpr_read_b32 v41, a67
    v_mul_f32 v41, v41, v44
    v_accvgpr_write_b32 a67, v41
    v_accvgpr_read_b32 v38, a68
    v_mul_f32 v38, v38, v44
    v_accvgpr_write_b32 a68, v38
    v_accvgpr_read_b32 v39, a69
    v_mul_f32 v39, v39, v44
    v_accvgpr_write_b32 a69, v39
    v_accvgpr_read_b32 v40, a70
    v_mul_f32 v40, v40, v44
    v_accvgpr_write_b32 a70, v40
    v_accvgpr_read_b32 v41, a71
    v_mul_f32 v41, v41, v44
    v_accvgpr_write_b32 a71, v41
    v_accvgpr_read_b32 v38, a72
    v_mul_f32 v38, v38, v44
    v_accvgpr_write_b32 a72, v38
    v_accvgpr_read_b32 v39, a73
    v_mul_f32 v39, v39, v44
    v_accvgpr_write_b32 a73, v39
    v_accvgpr_read_b32 v40, a74
    v_mul_f32 v40, v40, v44
    v_accvgpr_write_b32 a74, v40
    v_accvgpr_read_b32 v41, a75
    v_mul_f32 v41, v41, v44
    v_accvgpr_write_b32 a75, v41
    v_accvgpr_read_b32 v38, a76
    v_mul_f32 v38, v38, v44
    v_accvgpr_write_b32 a76, v38
    v_accvgpr_read_b32 v39, a77
    v_mul_f32 v39, v39, v44
    v_accvgpr_write_b32 a77, v39
    v_accvgpr_read_b32 v40, a78
    v_mul_f32 v40, v40, v44
    v_accvgpr_write_b32 a78, v40
    v_accvgpr_read_b32 v41, a79
    v_mul_f32 v41, v41, v44
    v_accvgpr_write_b32 a79, v41
    v_accvgpr_read_b32 v38, a80
    v_mul_f32 v38, v38, v44
    v_accvgpr_write_b32 a80, v38
    v_accvgpr_read_b32 v39, a81
    v_mul_f32 v39, v39, v44
    v_accvgpr_write_b32 a81, v39
    v_accvgpr_read_b32 v40, a82
    v_mul_f32 v40, v40, v44
    v_accvgpr_write_b32 a82, v40
    v_accvgpr_read_b32 v41, a83
    v_mul_f32 v41, v41, v44
    v_accvgpr_write_b32 a83, v41
    v_accvgpr_read_b32 v38, a84
    v_mul_f32 v38, v38, v44
    v_accvgpr_write_b32 a84, v38
    v_accvgpr_read_b32 v39, a85
    v_mul_f32 v39, v39, v44
    v_accvgpr_write_b32 a85, v39
    v_accvgpr_read_b32 v40, a86
    v_mul_f32 v40, v40, v44
    v_accvgpr_write_b32 a86, v40
    v_accvgpr_read_b32 v41, a87
    v_mul_f32 v41, v41, v44
    v_accvgpr_write_b32 a87, v41
    v_accvgpr_read_b32 v38, a88
    v_mul_f32 v38, v38, v44
    v_accvgpr_write_b32 a88, v38
    v_accvgpr_read_b32 v39, a89
    v_mul_f32 v39, v39, v44
    v_accvgpr_write_b32 a89, v39
    v_accvgpr_read_b32 v40, a90
    v_mul_f32 v40, v40, v44
    v_accvgpr_write_b32 a90, v40
    v_accvgpr_read_b32 v41, a91
    v_mul_f32 v41, v41, v44
    v_accvgpr_write_b32 a91, v41
    v_accvgpr_read_b32 v38, a92
    v_mul_f32 v38, v38, v44
    v_accvgpr_write_b32 a92, v38
    v_accvgpr_read_b32 v39, a93
    v_mul_f32 v39, v39, v44
    v_accvgpr_write_b32 a93, v39
    v_accvgpr_read_b32 v40, a94
    v_mul_f32 v40, v40, v44
    v_accvgpr_write_b32 a94, v40
    v_accvgpr_read_b32 v41, a95
    v_mul_f32 v41, v41, v44
    v_accvgpr_write_b32 a95, v41
    v_accvgpr_read_b32 v38, a96
    v_mul_f32 v38, v38, v44
    v_accvgpr_write_b32 a96, v38
    v_accvgpr_read_b32 v39, a97
    v_mul_f32 v39, v39, v44
    v_accvgpr_write_b32 a97, v39
    v_accvgpr_read_b32 v40, a98
    v_mul_f32 v40, v40, v44
    v_accvgpr_write_b32 a98, v40
    v_accvgpr_read_b32 v41, a99
    v_mul_f32 v41, v41, v44
    v_accvgpr_write_b32 a99, v41
    v_accvgpr_read_b32 v38, a100
    v_mul_f32 v38, v38, v44
    v_accvgpr_write_b32 a100, v38
    v_accvgpr_read_b32 v39, a101
    v_mul_f32 v39, v39, v44
    v_accvgpr_write_b32 a101, v39
    v_accvgpr_read_b32 v40, a102
    v_mul_f32 v40, v40, v44
    v_accvgpr_write_b32 a102, v40
    v_accvgpr_read_b32 v41, a103
    v_mul_f32 v41, v41, v44
    v_accvgpr_write_b32 a103, v41
    v_accvgpr_read_b32 v38, a104
    v_mul_f32 v38, v38, v44
    v_accvgpr_write_b32 a104, v38
    v_accvgpr_read_b32 v39, a105
    v_mul_f32 v39, v39, v44
    v_accvgpr_write_b32 a105, v39
    v_accvgpr_read_b32 v40, a106
    v_mul_f32 v40, v40, v44
    v_accvgpr_write_b32 a106, v40
    v_accvgpr_read_b32 v41, a107
    v_mul_f32 v41, v41, v44
    v_accvgpr_write_b32 a107, v41
    v_accvgpr_read_b32 v38, a108
    v_mul_f32 v38, v38, v44
    v_accvgpr_write_b32 a108, v38
    v_accvgpr_read_b32 v39, a109
    v_mul_f32 v39, v39, v44
    v_accvgpr_write_b32 a109, v39
    v_accvgpr_read_b32 v40, a110
    v_mul_f32 v40, v40, v44
    v_accvgpr_write_b32 a110, v40
    v_accvgpr_read_b32 v41, a111
    v_mul_f32 v41, v41, v44
    v_accvgpr_write_b32 a111, v41
    v_accvgpr_read_b32 v38, a112
    v_mul_f32 v38, v38, v44
    v_accvgpr_write_b32 a112, v38
    v_accvgpr_read_b32 v39, a113
    v_mul_f32 v39, v39, v44
    v_accvgpr_write_b32 a113, v39
    v_accvgpr_read_b32 v40, a114
    v_mul_f32 v40, v40, v44
    v_accvgpr_write_b32 a114, v40
    v_accvgpr_read_b32 v41, a115
    v_mul_f32 v41, v41, v44
    v_accvgpr_write_b32 a115, v41
    v_accvgpr_read_b32 v38, a116
    v_mul_f32 v38, v38, v44
    v_accvgpr_write_b32 a116, v38
    v_accvgpr_read_b32 v39, a117
    v_mul_f32 v39, v39, v44
    v_accvgpr_write_b32 a117, v39
    v_accvgpr_read_b32 v40, a118
    v_mul_f32 v40, v40, v44
    v_accvgpr_write_b32 a118, v40
    v_accvgpr_read_b32 v41, a119
    v_mul_f32 v41, v41, v44
    v_accvgpr_write_b32 a119, v41
    v_accvgpr_read_b32 v38, a120
    v_mul_f32 v38, v38, v44
    v_accvgpr_write_b32 a120, v38
    v_accvgpr_read_b32 v39, a121
    v_mul_f32 v39, v39, v44
    v_accvgpr_write_b32 a121, v39
    v_accvgpr_read_b32 v40, a122
    v_mul_f32 v40, v40, v44
    v_accvgpr_write_b32 a122, v40
    v_accvgpr_read_b32 v41, a123
    v_mul_f32 v41, v41, v44
    v_accvgpr_write_b32 a123, v41
    v_accvgpr_read_b32 v38, a124
    v_mul_f32 v38, v38, v44
    v_accvgpr_write_b32 a124, v38
    v_accvgpr_read_b32 v39, a125
    v_mul_f32 v39, v39, v44
    v_accvgpr_write_b32 a125, v39
    v_accvgpr_read_b32 v40, a126
    v_mul_f32 v40, v40, v44
    v_accvgpr_write_b32 a126, v40
    v_accvgpr_read_b32 v41, a127
    v_mul_f32 v41, v41, v44
    v_accvgpr_write_b32 a127, v41
    v_exp_f32 v38, v80
    v_exp_f32 v39, v81
    v_exp_f32 v40, v82
    v_exp_f32 v41, v83
    v_add_f32 v36, v38, v39
    v_cvt_pk_bf16_f32 v48, v38, v39
    v_exp_f32 v38, v84
    v_exp_f32 v39, v85
    v_add_f32 v37, v40, v41
    v_cvt_pk_bf16_f32 v49, v40, v41
    v_exp_f32 v40, v86
    v_exp_f32 v41, v87
    v_add_f32 v36, v36, v38
    v_add_f32 v37, v37, v39
    v_cvt_pk_bf16_f32 v50, v38, v39
    v_exp_f32 v38, v88
    v_exp_f32 v39, v89
    v_add_f32 v36, v36, v40
    v_add_f32 v37, v37, v41
    v_cvt_pk_bf16_f32 v51, v40, v41
    v_exp_f32 v40, v90
    v_exp_f32 v41, v91
    v_add_f32 v36, v36, v38
    v_add_f32 v37, v37, v39
    v_cvt_pk_bf16_f32 v52, v38, v39
    v_exp_f32 v38, v92
    v_exp_f32 v39, v93
    v_add_f32 v36, v36, v40
    v_add_f32 v37, v37, v41
    v_cvt_pk_bf16_f32 v53, v40, v41
    v_exp_f32 v40, v94
    v_exp_f32 v41, v95
    v_add_f32 v36, v36, v38
    v_add_f32 v37, v37, v39
    v_cvt_pk_bf16_f32 v54, v38, v39
    s_nop 0
    v_add_f32 v36, v36, v40
    v_add_f32 v37, v37, v41
    v_cvt_pk_bf16_f32 v55, v40, v41
    v_add_f32 v35, v36, v37
    s_nop 3
    s_branch L_front_back_14
L_front_slow_15:
    s_nop 15
    s_nop 7
    v_max3_f32 v42, v96, v97, v98
    v_max3_f32 v42, v42, v99, v100
    v_max3_f32 v42, v42, v101, v102
    v_max3_f32 v42, v42, v103, v104
    v_max3_f32 v42, v42, v105, v106
    v_max3_f32 v42, v42, v107, v108
    v_max3_f32 v42, v42, v109, v110
    v_max_f32 v42, v42, v111
    v_mov_b32 v43, v42
    s_nop 1
    v_permlane32_swap_b32 v43, v42
    s_nop 1
    v_max_f32 v42, v42, v43
    v_max_f32 v42, 0, v42
    v_sub_f32 v44, 0, v42
    v_exp_f32 v44, v44
    v_sub_f32 v96, v96, v42
    v_sub_f32 v112, v112, v42
    v_sub_f32 v64, v64, v42
    v_sub_f32 v97, v97, v42
    v_sub_f32 v113, v113, v42
    v_sub_f32 v65, v65, v42
    v_sub_f32 v98, v98, v42
    v_sub_f32 v114, v114, v42
    v_sub_f32 v66, v66, v42
    v_sub_f32 v99, v99, v42
    v_sub_f32 v115, v115, v42
    v_sub_f32 v67, v67, v42
    v_sub_f32 v100, v100, v42
    v_sub_f32 v116, v116, v42
    v_sub_f32 v68, v68, v42
    v_sub_f32 v101, v101, v42
    v_sub_f32 v117, v117, v42
    v_sub_f32 v69, v69, v42
    v_sub_f32 v102, v102, v42
    v_sub_f32 v118, v118, v42
    v_sub_f32 v70, v70, v42
    v_sub_f32 v103, v103, v42
    v_sub_f32 v119, v119, v42
    v_sub_f32 v71, v71, v42
    v_sub_f32 v104, v104, v42
    v_sub_f32 v120, v120, v42
    v_sub_f32 v72, v72, v42
    v_sub_f32 v105, v105, v42
    v_sub_f32 v121, v121, v42
    v_sub_f32 v73, v73, v42
    v_sub_f32 v106, v106, v42
    v_sub_f32 v122, v122, v42
    v_sub_f32 v74, v74, v42
    v_sub_f32 v107, v107, v42
    v_sub_f32 v123, v123, v42
    v_sub_f32 v75, v75, v42
    v_sub_f32 v108, v108, v42
    v_sub_f32 v124, v124, v42
    v_sub_f32 v76, v76, v42
    v_sub_f32 v109, v109, v42
    v_sub_f32 v125, v125, v42
    v_sub_f32 v77, v77, v42
    v_sub_f32 v110, v110, v42
    v_sub_f32 v126, v126, v42
    v_sub_f32 v78, v78, v42
    v_sub_f32 v111, v111, v42
    v_sub_f32 v127, v127, v42
    v_sub_f32 v79, v79, v42
    v_mul_f32 v34, v34, v44
    v_accvgpr_read_b32 v38, a0
    v_mul_f32 v38, v38, v44
    v_accvgpr_write_b32 a0, v38
    v_accvgpr_read_b32 v39, a1
    v_mul_f32 v39, v39, v44
    v_accvgpr_write_b32 a1, v39
    v_accvgpr_read_b32 v40, a2
    v_mul_f32 v40, v40, v44
    v_accvgpr_write_b32 a2, v40
    v_accvgpr_read_b32 v41, a3
    v_mul_f32 v41, v41, v44
    v_accvgpr_write_b32 a3, v41
    v_accvgpr_read_b32 v38, a4
    v_mul_f32 v38, v38, v44
    v_accvgpr_write_b32 a4, v38
    v_accvgpr_read_b32 v39, a5
    v_mul_f32 v39, v39, v44
    v_accvgpr_write_b32 a5, v39
    v_accvgpr_read_b32 v40, a6
    v_mul_f32 v40, v40, v44
    v_accvgpr_write_b32 a6, v40
    v_accvgpr_read_b32 v41, a7
    v_mul_f32 v41, v41, v44
    v_accvgpr_write_b32 a7, v41
    v_accvgpr_read_b32 v38, a8
    v_mul_f32 v38, v38, v44
    v_accvgpr_write_b32 a8, v38
    v_accvgpr_read_b32 v39, a9
    v_mul_f32 v39, v39, v44
    v_accvgpr_write_b32 a9, v39
    v_accvgpr_read_b32 v40, a10
    v_mul_f32 v40, v40, v44
    v_accvgpr_write_b32 a10, v40
    v_accvgpr_read_b32 v41, a11
    v_mul_f32 v41, v41, v44
    v_accvgpr_write_b32 a11, v41
    v_accvgpr_read_b32 v38, a12
    v_mul_f32 v38, v38, v44
    v_accvgpr_write_b32 a12, v38
    v_accvgpr_read_b32 v39, a13
    v_mul_f32 v39, v39, v44
    v_accvgpr_write_b32 a13, v39
    v_accvgpr_read_b32 v40, a14
    v_mul_f32 v40, v40, v44
    v_accvgpr_write_b32 a14, v40
    v_accvgpr_read_b32 v41, a15
    v_mul_f32 v41, v41, v44
    v_accvgpr_write_b32 a15, v41
    v_accvgpr_read_b32 v38, a16
    v_mul_f32 v38, v38, v44
    v_accvgpr_write_b32 a16, v38
    v_accvgpr_read_b32 v39, a17
    v_mul_f32 v39, v39, v44
    v_accvgpr_write_b32 a17, v39
    v_accvgpr_read_b32 v40, a18
    v_mul_f32 v40, v40, v44
    v_accvgpr_write_b32 a18, v40
    v_accvgpr_read_b32 v41, a19
    v_mul_f32 v41, v41, v44
    v_accvgpr_write_b32 a19, v41
    v_accvgpr_read_b32 v38, a20
    v_mul_f32 v38, v38, v44
    v_accvgpr_write_b32 a20, v38
    v_accvgpr_read_b32 v39, a21
    v_mul_f32 v39, v39, v44
    v_accvgpr_write_b32 a21, v39
    v_accvgpr_read_b32 v40, a22
    v_mul_f32 v40, v40, v44
    v_accvgpr_write_b32 a22, v40
    v_accvgpr_read_b32 v41, a23
    v_mul_f32 v41, v41, v44
    v_accvgpr_write_b32 a23, v41
    v_accvgpr_read_b32 v38, a24
    v_mul_f32 v38, v38, v44
    v_accvgpr_write_b32 a24, v38
    v_accvgpr_read_b32 v39, a25
    v_mul_f32 v39, v39, v44
    v_accvgpr_write_b32 a25, v39
    v_accvgpr_read_b32 v40, a26
    v_mul_f32 v40, v40, v44
    v_accvgpr_write_b32 a26, v40
    v_accvgpr_read_b32 v41, a27
    v_mul_f32 v41, v41, v44
    v_accvgpr_write_b32 a27, v41
    v_accvgpr_read_b32 v38, a28
    v_mul_f32 v38, v38, v44
    v_accvgpr_write_b32 a28, v38
    v_accvgpr_read_b32 v39, a29
    v_mul_f32 v39, v39, v44
    v_accvgpr_write_b32 a29, v39
    v_accvgpr_read_b32 v40, a30
    v_mul_f32 v40, v40, v44
    v_accvgpr_write_b32 a30, v40
    v_accvgpr_read_b32 v41, a31
    v_mul_f32 v41, v41, v44
    v_accvgpr_write_b32 a31, v41
    v_accvgpr_read_b32 v38, a32
    v_mul_f32 v38, v38, v44
    v_accvgpr_write_b32 a32, v38
    v_accvgpr_read_b32 v39, a33
    v_mul_f32 v39, v39, v44
    v_accvgpr_write_b32 a33, v39
    v_accvgpr_read_b32 v40, a34
    v_mul_f32 v40, v40, v44
    v_accvgpr_write_b32 a34, v40
    v_accvgpr_read_b32 v41, a35
    v_mul_f32 v41, v41, v44
    v_accvgpr_write_b32 a35, v41
    v_accvgpr_read_b32 v38, a36
    v_mul_f32 v38, v38, v44
    v_accvgpr_write_b32 a36, v38
    v_accvgpr_read_b32 v39, a37
    v_mul_f32 v39, v39, v44
    v_accvgpr_write_b32 a37, v39
    v_accvgpr_read_b32 v40, a38
    v_mul_f32 v40, v40, v44
    v_accvgpr_write_b32 a38, v40
    v_accvgpr_read_b32 v41, a39
    v_mul_f32 v41, v41, v44
    v_accvgpr_write_b32 a39, v41
    v_accvgpr_read_b32 v38, a40
    v_mul_f32 v38, v38, v44
    v_accvgpr_write_b32 a40, v38
    v_accvgpr_read_b32 v39, a41
    v_mul_f32 v39, v39, v44
    v_accvgpr_write_b32 a41, v39
    v_accvgpr_read_b32 v40, a42
    v_mul_f32 v40, v40, v44
    v_accvgpr_write_b32 a42, v40
    v_accvgpr_read_b32 v41, a43
    v_mul_f32 v41, v41, v44
    v_accvgpr_write_b32 a43, v41
    v_accvgpr_read_b32 v38, a44
    v_mul_f32 v38, v38, v44
    v_accvgpr_write_b32 a44, v38
    v_accvgpr_read_b32 v39, a45
    v_mul_f32 v39, v39, v44
    v_accvgpr_write_b32 a45, v39
    v_accvgpr_read_b32 v40, a46
    v_mul_f32 v40, v40, v44
    v_accvgpr_write_b32 a46, v40
    v_accvgpr_read_b32 v41, a47
    v_mul_f32 v41, v41, v44
    v_accvgpr_write_b32 a47, v41
    v_accvgpr_read_b32 v38, a48
    v_mul_f32 v38, v38, v44
    v_accvgpr_write_b32 a48, v38
    v_accvgpr_read_b32 v39, a49
    v_mul_f32 v39, v39, v44
    v_accvgpr_write_b32 a49, v39
    v_accvgpr_read_b32 v40, a50
    v_mul_f32 v40, v40, v44
    v_accvgpr_write_b32 a50, v40
    v_accvgpr_read_b32 v41, a51
    v_mul_f32 v41, v41, v44
    v_accvgpr_write_b32 a51, v41
    v_accvgpr_read_b32 v38, a52
    v_mul_f32 v38, v38, v44
    v_accvgpr_write_b32 a52, v38
    v_accvgpr_read_b32 v39, a53
    v_mul_f32 v39, v39, v44
    v_accvgpr_write_b32 a53, v39
    v_accvgpr_read_b32 v40, a54
    v_mul_f32 v40, v40, v44
    v_accvgpr_write_b32 a54, v40
    v_accvgpr_read_b32 v41, a55
    v_mul_f32 v41, v41, v44
    v_accvgpr_write_b32 a55, v41
    v_accvgpr_read_b32 v38, a56
    v_mul_f32 v38, v38, v44
    v_accvgpr_write_b32 a56, v38
    v_accvgpr_read_b32 v39, a57
    v_mul_f32 v39, v39, v44
    v_accvgpr_write_b32 a57, v39
    v_accvgpr_read_b32 v40, a58
    v_mul_f32 v40, v40, v44
    v_accvgpr_write_b32 a58, v40
    v_accvgpr_read_b32 v41, a59
    v_mul_f32 v41, v41, v44
    v_accvgpr_write_b32 a59, v41
    v_accvgpr_read_b32 v38, a60
    v_mul_f32 v38, v38, v44
    v_accvgpr_write_b32 a60, v38
    v_accvgpr_read_b32 v39, a61
    v_mul_f32 v39, v39, v44
    v_accvgpr_write_b32 a61, v39
    v_accvgpr_read_b32 v40, a62
    v_mul_f32 v40, v40, v44
    v_accvgpr_write_b32 a62, v40
    v_accvgpr_read_b32 v41, a63
    v_mul_f32 v41, v41, v44
    v_accvgpr_write_b32 a63, v41
    v_accvgpr_read_b32 v38, a64
    v_mul_f32 v38, v38, v44
    v_accvgpr_write_b32 a64, v38
    v_accvgpr_read_b32 v39, a65
    v_mul_f32 v39, v39, v44
    v_accvgpr_write_b32 a65, v39
    v_accvgpr_read_b32 v40, a66
    v_mul_f32 v40, v40, v44
    v_accvgpr_write_b32 a66, v40
    v_accvgpr_read_b32 v41, a67
    v_mul_f32 v41, v41, v44
    v_accvgpr_write_b32 a67, v41
    v_accvgpr_read_b32 v38, a68
    v_mul_f32 v38, v38, v44
    v_accvgpr_write_b32 a68, v38
    v_accvgpr_read_b32 v39, a69
    v_mul_f32 v39, v39, v44
    v_accvgpr_write_b32 a69, v39
    v_accvgpr_read_b32 v40, a70
    v_mul_f32 v40, v40, v44
    v_accvgpr_write_b32 a70, v40
    v_accvgpr_read_b32 v41, a71
    v_mul_f32 v41, v41, v44
    v_accvgpr_write_b32 a71, v41
    v_accvgpr_read_b32 v38, a72
    v_mul_f32 v38, v38, v44
    v_accvgpr_write_b32 a72, v38
    v_accvgpr_read_b32 v39, a73
    v_mul_f32 v39, v39, v44
    v_accvgpr_write_b32 a73, v39
    v_accvgpr_read_b32 v40, a74
    v_mul_f32 v40, v40, v44
    v_accvgpr_write_b32 a74, v40
    v_accvgpr_read_b32 v41, a75
    v_mul_f32 v41, v41, v44
    v_accvgpr_write_b32 a75, v41
    v_accvgpr_read_b32 v38, a76
    v_mul_f32 v38, v38, v44
    v_accvgpr_write_b32 a76, v38
    v_accvgpr_read_b32 v39, a77
    v_mul_f32 v39, v39, v44
    v_accvgpr_write_b32 a77, v39
    v_accvgpr_read_b32 v40, a78
    v_mul_f32 v40, v40, v44
    v_accvgpr_write_b32 a78, v40
    v_accvgpr_read_b32 v41, a79
    v_mul_f32 v41, v41, v44
    v_accvgpr_write_b32 a79, v41
    v_accvgpr_read_b32 v38, a80
    v_mul_f32 v38, v38, v44
    v_accvgpr_write_b32 a80, v38
    v_accvgpr_read_b32 v39, a81
    v_mul_f32 v39, v39, v44
    v_accvgpr_write_b32 a81, v39
    v_accvgpr_read_b32 v40, a82
    v_mul_f32 v40, v40, v44
    v_accvgpr_write_b32 a82, v40
    v_accvgpr_read_b32 v41, a83
    v_mul_f32 v41, v41, v44
    v_accvgpr_write_b32 a83, v41
    v_accvgpr_read_b32 v38, a84
    v_mul_f32 v38, v38, v44
    v_accvgpr_write_b32 a84, v38
    v_accvgpr_read_b32 v39, a85
    v_mul_f32 v39, v39, v44
    v_accvgpr_write_b32 a85, v39
    v_accvgpr_read_b32 v40, a86
    v_mul_f32 v40, v40, v44
    v_accvgpr_write_b32 a86, v40
    v_accvgpr_read_b32 v41, a87
    v_mul_f32 v41, v41, v44
    v_accvgpr_write_b32 a87, v41
    v_accvgpr_read_b32 v38, a88
    v_mul_f32 v38, v38, v44
    v_accvgpr_write_b32 a88, v38
    v_accvgpr_read_b32 v39, a89
    v_mul_f32 v39, v39, v44
    v_accvgpr_write_b32 a89, v39
    v_accvgpr_read_b32 v40, a90
    v_mul_f32 v40, v40, v44
    v_accvgpr_write_b32 a90, v40
    v_accvgpr_read_b32 v41, a91
    v_mul_f32 v41, v41, v44
    v_accvgpr_write_b32 a91, v41
    v_accvgpr_read_b32 v38, a92
    v_mul_f32 v38, v38, v44
    v_accvgpr_write_b32 a92, v38
    v_accvgpr_read_b32 v39, a93
    v_mul_f32 v39, v39, v44
    v_accvgpr_write_b32 a93, v39
    v_accvgpr_read_b32 v40, a94
    v_mul_f32 v40, v40, v44
    v_accvgpr_write_b32 a94, v40
    v_accvgpr_read_b32 v41, a95
    v_mul_f32 v41, v41, v44
    v_accvgpr_write_b32 a95, v41
    v_accvgpr_read_b32 v38, a96
    v_mul_f32 v38, v38, v44
    v_accvgpr_write_b32 a96, v38
    v_accvgpr_read_b32 v39, a97
    v_mul_f32 v39, v39, v44
    v_accvgpr_write_b32 a97, v39
    v_accvgpr_read_b32 v40, a98
    v_mul_f32 v40, v40, v44
    v_accvgpr_write_b32 a98, v40
    v_accvgpr_read_b32 v41, a99
    v_mul_f32 v41, v41, v44
    v_accvgpr_write_b32 a99, v41
    v_accvgpr_read_b32 v38, a100
    v_mul_f32 v38, v38, v44
    v_accvgpr_write_b32 a100, v38
    v_accvgpr_read_b32 v39, a101
    v_mul_f32 v39, v39, v44
    v_accvgpr_write_b32 a101, v39
    v_accvgpr_read_b32 v40, a102
    v_mul_f32 v40, v40, v44
    v_accvgpr_write_b32 a102, v40
    v_accvgpr_read_b32 v41, a103
    v_mul_f32 v41, v41, v44
    v_accvgpr_write_b32 a103, v41
    v_accvgpr_read_b32 v38, a104
    v_mul_f32 v38, v38, v44
    v_accvgpr_write_b32 a104, v38
    v_accvgpr_read_b32 v39, a105
    v_mul_f32 v39, v39, v44
    v_accvgpr_write_b32 a105, v39
    v_accvgpr_read_b32 v40, a106
    v_mul_f32 v40, v40, v44
    v_accvgpr_write_b32 a106, v40
    v_accvgpr_read_b32 v41, a107
    v_mul_f32 v41, v41, v44
    v_accvgpr_write_b32 a107, v41
    v_accvgpr_read_b32 v38, a108
    v_mul_f32 v38, v38, v44
    v_accvgpr_write_b32 a108, v38
    v_accvgpr_read_b32 v39, a109
    v_mul_f32 v39, v39, v44
    v_accvgpr_write_b32 a109, v39
    v_accvgpr_read_b32 v40, a110
    v_mul_f32 v40, v40, v44
    v_accvgpr_write_b32 a110, v40
    v_accvgpr_read_b32 v41, a111
    v_mul_f32 v41, v41, v44
    v_accvgpr_write_b32 a111, v41
    v_accvgpr_read_b32 v38, a112
    v_mul_f32 v38, v38, v44
    v_accvgpr_write_b32 a112, v38
    v_accvgpr_read_b32 v39, a113
    v_mul_f32 v39, v39, v44
    v_accvgpr_write_b32 a113, v39
    v_accvgpr_read_b32 v40, a114
    v_mul_f32 v40, v40, v44
    v_accvgpr_write_b32 a114, v40
    v_accvgpr_read_b32 v41, a115
    v_mul_f32 v41, v41, v44
    v_accvgpr_write_b32 a115, v41
    v_accvgpr_read_b32 v38, a116
    v_mul_f32 v38, v38, v44
    v_accvgpr_write_b32 a116, v38
    v_accvgpr_read_b32 v39, a117
    v_mul_f32 v39, v39, v44
    v_accvgpr_write_b32 a117, v39
    v_accvgpr_read_b32 v40, a118
    v_mul_f32 v40, v40, v44
    v_accvgpr_write_b32 a118, v40
    v_accvgpr_read_b32 v41, a119
    v_mul_f32 v41, v41, v44
    v_accvgpr_write_b32 a119, v41
    v_accvgpr_read_b32 v38, a120
    v_mul_f32 v38, v38, v44
    v_accvgpr_write_b32 a120, v38
    v_accvgpr_read_b32 v39, a121
    v_mul_f32 v39, v39, v44
    v_accvgpr_write_b32 a121, v39
    v_accvgpr_read_b32 v40, a122
    v_mul_f32 v40, v40, v44
    v_accvgpr_write_b32 a122, v40
    v_accvgpr_read_b32 v41, a123
    v_mul_f32 v41, v41, v44
    v_accvgpr_write_b32 a123, v41
    v_accvgpr_read_b32 v38, a124
    v_mul_f32 v38, v38, v44
    v_accvgpr_write_b32 a124, v38
    v_accvgpr_read_b32 v39, a125
    v_mul_f32 v39, v39, v44
    v_accvgpr_write_b32 a125, v39
    v_accvgpr_read_b32 v40, a126
    v_mul_f32 v40, v40, v44
    v_accvgpr_write_b32 a126, v40
    v_accvgpr_read_b32 v41, a127
    v_mul_f32 v41, v41, v44
    v_accvgpr_write_b32 a127, v41
    v_exp_f32 v38, v96
    v_exp_f32 v39, v97
    v_exp_f32 v40, v98
    v_exp_f32 v41, v99
    v_add_f32 v36, v38, v39
    v_cvt_pk_bf16_f32 v48, v38, v39
    v_exp_f32 v38, v100
    v_exp_f32 v39, v101
    v_add_f32 v37, v40, v41
    v_cvt_pk_bf16_f32 v49, v40, v41
    v_exp_f32 v40, v102
    v_exp_f32 v41, v103
    v_add_f32 v36, v36, v38
    v_add_f32 v37, v37, v39
    v_cvt_pk_bf16_f32 v50, v38, v39
    v_exp_f32 v38, v104
    v_exp_f32 v39, v105
    v_add_f32 v36, v36, v40
    v_add_f32 v37, v37, v41
    v_cvt_pk_bf16_f32 v51, v40, v41
    v_exp_f32 v40, v106
    v_exp_f32 v41, v107
    v_add_f32 v36, v36, v38
    v_add_f32 v37, v37, v39
    v_cvt_pk_bf16_f32 v52, v38, v39
    v_exp_f32 v38, v108
    v_exp_f32 v39, v109
    v_add_f32 v36, v36, v40
    v_add_f32 v37, v37, v41
    v_cvt_pk_bf16_f32 v53, v40, v41
    v_exp_f32 v40, v110
    v_exp_f32 v41, v111
    v_add_f32 v36, v36, v38
    v_add_f32 v37, v37, v39
    v_cvt_pk_bf16_f32 v54, v38, v39
    s_nop 0
    v_add_f32 v36, v36, v40
    v_add_f32 v37, v37, v41
    v_cvt_pk_bf16_f32 v55, v40, v41
    v_add_f32 v35, v36, v37
    s_nop 3
    s_branch L_front_back_16
L_front_slow_17:
    s_nop 15
    s_nop 7
    v_max3_f32 v42, v112, v113, v114
    v_max3_f32 v42, v42, v115, v116
    v_max3_f32 v42, v42, v117, v118
    v_max3_f32 v42, v42, v119, v120
    v_max3_f32 v42, v42, v121, v122
    v_max3_f32 v42, v42, v123, v124
    v_max3_f32 v42, v42, v125, v126
    v_max_f32 v42, v42, v127
    v_mov_b32 v43, v42
    s_nop 1
    v_permlane32_swap_b32 v43, v42
    s_nop 1
    v_max_f32 v42, v42, v43
    v_max_f32 v42, 0, v42
    v_sub_f32 v44, 0, v42
    v_exp_f32 v44, v44
    v_sub_f32 v112, v112, v42
    v_sub_f32 v80, v80, v42
    v_sub_f32 v64, v64, v42
    v_sub_f32 v113, v113, v42
    v_sub_f32 v81, v81, v42
    v_sub_f32 v65, v65, v42
    v_sub_f32 v114, v114, v42
    v_sub_f32 v82, v82, v42
    v_sub_f32 v66, v66, v42
    v_sub_f32 v115, v115, v42
    v_sub_f32 v83, v83, v42
    v_sub_f32 v67, v67, v42
    v_sub_f32 v116, v116, v42
    v_sub_f32 v84, v84, v42
    v_sub_f32 v68, v68, v42
    v_sub_f32 v117, v117, v42
    v_sub_f32 v85, v85, v42
    v_sub_f32 v69, v69, v42
    v_sub_f32 v118, v118, v42
    v_sub_f32 v86, v86, v42
    v_sub_f32 v70, v70, v42
    v_sub_f32 v119, v119, v42
    v_sub_f32 v87, v87, v42
    v_sub_f32 v71, v71, v42
    v_sub_f32 v120, v120, v42
    v_sub_f32 v88, v88, v42
    v_sub_f32 v72, v72, v42
    v_sub_f32 v121, v121, v42
    v_sub_f32 v89, v89, v42
    v_sub_f32 v73, v73, v42
    v_sub_f32 v122, v122, v42
    v_sub_f32 v90, v90, v42
    v_sub_f32 v74, v74, v42
    v_sub_f32 v123, v123, v42
    v_sub_f32 v91, v91, v42
    v_sub_f32 v75, v75, v42
    v_sub_f32 v124, v124, v42
    v_sub_f32 v92, v92, v42
    v_sub_f32 v76, v76, v42
    v_sub_f32 v125, v125, v42
    v_sub_f32 v93, v93, v42
    v_sub_f32 v77, v77, v42
    v_sub_f32 v126, v126, v42
    v_sub_f32 v94, v94, v42
    v_sub_f32 v78, v78, v42
    v_sub_f32 v127, v127, v42
    v_sub_f32 v95, v95, v42
    v_sub_f32 v79, v79, v42
    v_mul_f32 v34, v34, v44
    v_accvgpr_read_b32 v38, a0
    v_mul_f32 v38, v38, v44
    v_accvgpr_write_b32 a0, v38
    v_accvgpr_read_b32 v39, a1
    v_mul_f32 v39, v39, v44
    v_accvgpr_write_b32 a1, v39
    v_accvgpr_read_b32 v40, a2
    v_mul_f32 v40, v40, v44
    v_accvgpr_write_b32 a2, v40
    v_accvgpr_read_b32 v41, a3
    v_mul_f32 v41, v41, v44
    v_accvgpr_write_b32 a3, v41
    v_accvgpr_read_b32 v38, a4
    v_mul_f32 v38, v38, v44
    v_accvgpr_write_b32 a4, v38
    v_accvgpr_read_b32 v39, a5
    v_mul_f32 v39, v39, v44
    v_accvgpr_write_b32 a5, v39
    v_accvgpr_read_b32 v40, a6
    v_mul_f32 v40, v40, v44
    v_accvgpr_write_b32 a6, v40
    v_accvgpr_read_b32 v41, a7
    v_mul_f32 v41, v41, v44
    v_accvgpr_write_b32 a7, v41
    v_accvgpr_read_b32 v38, a8
    v_mul_f32 v38, v38, v44
    v_accvgpr_write_b32 a8, v38
    v_accvgpr_read_b32 v39, a9
    v_mul_f32 v39, v39, v44
    v_accvgpr_write_b32 a9, v39
    v_accvgpr_read_b32 v40, a10
    v_mul_f32 v40, v40, v44
    v_accvgpr_write_b32 a10, v40
    v_accvgpr_read_b32 v41, a11
    v_mul_f32 v41, v41, v44
    v_accvgpr_write_b32 a11, v41
    v_accvgpr_read_b32 v38, a12
    v_mul_f32 v38, v38, v44
    v_accvgpr_write_b32 a12, v38
    v_accvgpr_read_b32 v39, a13
    v_mul_f32 v39, v39, v44
    v_accvgpr_write_b32 a13, v39
    v_accvgpr_read_b32 v40, a14
    v_mul_f32 v40, v40, v44
    v_accvgpr_write_b32 a14, v40
    v_accvgpr_read_b32 v41, a15
    v_mul_f32 v41, v41, v44
    v_accvgpr_write_b32 a15, v41
    v_accvgpr_read_b32 v38, a16
    v_mul_f32 v38, v38, v44
    v_accvgpr_write_b32 a16, v38
    v_accvgpr_read_b32 v39, a17
    v_mul_f32 v39, v39, v44
    v_accvgpr_write_b32 a17, v39
    v_accvgpr_read_b32 v40, a18
    v_mul_f32 v40, v40, v44
    v_accvgpr_write_b32 a18, v40
    v_accvgpr_read_b32 v41, a19
    v_mul_f32 v41, v41, v44
    v_accvgpr_write_b32 a19, v41
    v_accvgpr_read_b32 v38, a20
    v_mul_f32 v38, v38, v44
    v_accvgpr_write_b32 a20, v38
    v_accvgpr_read_b32 v39, a21
    v_mul_f32 v39, v39, v44
    v_accvgpr_write_b32 a21, v39
    v_accvgpr_read_b32 v40, a22
    v_mul_f32 v40, v40, v44
    v_accvgpr_write_b32 a22, v40
    v_accvgpr_read_b32 v41, a23
    v_mul_f32 v41, v41, v44
    v_accvgpr_write_b32 a23, v41
    v_accvgpr_read_b32 v38, a24
    v_mul_f32 v38, v38, v44
    v_accvgpr_write_b32 a24, v38
    v_accvgpr_read_b32 v39, a25
    v_mul_f32 v39, v39, v44
    v_accvgpr_write_b32 a25, v39
    v_accvgpr_read_b32 v40, a26
    v_mul_f32 v40, v40, v44
    v_accvgpr_write_b32 a26, v40
    v_accvgpr_read_b32 v41, a27
    v_mul_f32 v41, v41, v44
    v_accvgpr_write_b32 a27, v41
    v_accvgpr_read_b32 v38, a28
    v_mul_f32 v38, v38, v44
    v_accvgpr_write_b32 a28, v38
    v_accvgpr_read_b32 v39, a29
    v_mul_f32 v39, v39, v44
    v_accvgpr_write_b32 a29, v39
    v_accvgpr_read_b32 v40, a30
    v_mul_f32 v40, v40, v44
    v_accvgpr_write_b32 a30, v40
    v_accvgpr_read_b32 v41, a31
    v_mul_f32 v41, v41, v44
    v_accvgpr_write_b32 a31, v41
    v_accvgpr_read_b32 v38, a32
    v_mul_f32 v38, v38, v44
    v_accvgpr_write_b32 a32, v38
    v_accvgpr_read_b32 v39, a33
    v_mul_f32 v39, v39, v44
    v_accvgpr_write_b32 a33, v39
    v_accvgpr_read_b32 v40, a34
    v_mul_f32 v40, v40, v44
    v_accvgpr_write_b32 a34, v40
    v_accvgpr_read_b32 v41, a35
    v_mul_f32 v41, v41, v44
    v_accvgpr_write_b32 a35, v41
    v_accvgpr_read_b32 v38, a36
    v_mul_f32 v38, v38, v44
    v_accvgpr_write_b32 a36, v38
    v_accvgpr_read_b32 v39, a37
    v_mul_f32 v39, v39, v44
    v_accvgpr_write_b32 a37, v39
    v_accvgpr_read_b32 v40, a38
    v_mul_f32 v40, v40, v44
    v_accvgpr_write_b32 a38, v40
    v_accvgpr_read_b32 v41, a39
    v_mul_f32 v41, v41, v44
    v_accvgpr_write_b32 a39, v41
    v_accvgpr_read_b32 v38, a40
    v_mul_f32 v38, v38, v44
    v_accvgpr_write_b32 a40, v38
    v_accvgpr_read_b32 v39, a41
    v_mul_f32 v39, v39, v44
    v_accvgpr_write_b32 a41, v39
    v_accvgpr_read_b32 v40, a42
    v_mul_f32 v40, v40, v44
    v_accvgpr_write_b32 a42, v40
    v_accvgpr_read_b32 v41, a43
    v_mul_f32 v41, v41, v44
    v_accvgpr_write_b32 a43, v41
    v_accvgpr_read_b32 v38, a44
    v_mul_f32 v38, v38, v44
    v_accvgpr_write_b32 a44, v38
    v_accvgpr_read_b32 v39, a45
    v_mul_f32 v39, v39, v44
    v_accvgpr_write_b32 a45, v39
    v_accvgpr_read_b32 v40, a46
    v_mul_f32 v40, v40, v44
    v_accvgpr_write_b32 a46, v40
    v_accvgpr_read_b32 v41, a47
    v_mul_f32 v41, v41, v44
    v_accvgpr_write_b32 a47, v41
    v_accvgpr_read_b32 v38, a48
    v_mul_f32 v38, v38, v44
    v_accvgpr_write_b32 a48, v38
    v_accvgpr_read_b32 v39, a49
    v_mul_f32 v39, v39, v44
    v_accvgpr_write_b32 a49, v39
    v_accvgpr_read_b32 v40, a50
    v_mul_f32 v40, v40, v44
    v_accvgpr_write_b32 a50, v40
    v_accvgpr_read_b32 v41, a51
    v_mul_f32 v41, v41, v44
    v_accvgpr_write_b32 a51, v41
    v_accvgpr_read_b32 v38, a52
    v_mul_f32 v38, v38, v44
    v_accvgpr_write_b32 a52, v38
    v_accvgpr_read_b32 v39, a53
    v_mul_f32 v39, v39, v44
    v_accvgpr_write_b32 a53, v39
    v_accvgpr_read_b32 v40, a54
    v_mul_f32 v40, v40, v44
    v_accvgpr_write_b32 a54, v40
    v_accvgpr_read_b32 v41, a55
    v_mul_f32 v41, v41, v44
    v_accvgpr_write_b32 a55, v41
    v_accvgpr_read_b32 v38, a56
    v_mul_f32 v38, v38, v44
    v_accvgpr_write_b32 a56, v38
    v_accvgpr_read_b32 v39, a57
    v_mul_f32 v39, v39, v44
    v_accvgpr_write_b32 a57, v39
    v_accvgpr_read_b32 v40, a58
    v_mul_f32 v40, v40, v44
    v_accvgpr_write_b32 a58, v40
    v_accvgpr_read_b32 v41, a59
    v_mul_f32 v41, v41, v44
    v_accvgpr_write_b32 a59, v41
    v_accvgpr_read_b32 v38, a60
    v_mul_f32 v38, v38, v44
    v_accvgpr_write_b32 a60, v38
    v_accvgpr_read_b32 v39, a61
    v_mul_f32 v39, v39, v44
    v_accvgpr_write_b32 a61, v39
    v_accvgpr_read_b32 v40, a62
    v_mul_f32 v40, v40, v44
    v_accvgpr_write_b32 a62, v40
    v_accvgpr_read_b32 v41, a63
    v_mul_f32 v41, v41, v44
    v_accvgpr_write_b32 a63, v41
    v_accvgpr_read_b32 v38, a64
    v_mul_f32 v38, v38, v44
    v_accvgpr_write_b32 a64, v38
    v_accvgpr_read_b32 v39, a65
    v_mul_f32 v39, v39, v44
    v_accvgpr_write_b32 a65, v39
    v_accvgpr_read_b32 v40, a66
    v_mul_f32 v40, v40, v44
    v_accvgpr_write_b32 a66, v40
    v_accvgpr_read_b32 v41, a67
    v_mul_f32 v41, v41, v44
    v_accvgpr_write_b32 a67, v41
    v_accvgpr_read_b32 v38, a68
    v_mul_f32 v38, v38, v44
    v_accvgpr_write_b32 a68, v38
    v_accvgpr_read_b32 v39, a69
    v_mul_f32 v39, v39, v44
    v_accvgpr_write_b32 a69, v39
    v_accvgpr_read_b32 v40, a70
    v_mul_f32 v40, v40, v44
    v_accvgpr_write_b32 a70, v40
    v_accvgpr_read_b32 v41, a71
    v_mul_f32 v41, v41, v44
    v_accvgpr_write_b32 a71, v41
    v_accvgpr_read_b32 v38, a72
    v_mul_f32 v38, v38, v44
    v_accvgpr_write_b32 a72, v38
    v_accvgpr_read_b32 v39, a73
    v_mul_f32 v39, v39, v44
    v_accvgpr_write_b32 a73, v39
    v_accvgpr_read_b32 v40, a74
    v_mul_f32 v40, v40, v44
    v_accvgpr_write_b32 a74, v40
    v_accvgpr_read_b32 v41, a75
    v_mul_f32 v41, v41, v44
    v_accvgpr_write_b32 a75, v41
    v_accvgpr_read_b32 v38, a76
    v_mul_f32 v38, v38, v44
    v_accvgpr_write_b32 a76, v38
    v_accvgpr_read_b32 v39, a77
    v_mul_f32 v39, v39, v44
    v_accvgpr_write_b32 a77, v39
    v_accvgpr_read_b32 v40, a78
    v_mul_f32 v40, v40, v44
    v_accvgpr_write_b32 a78, v40
    v_accvgpr_read_b32 v41, a79
    v_mul_f32 v41, v41, v44
    v_accvgpr_write_b32 a79, v41
    v_accvgpr_read_b32 v38, a80
    v_mul_f32 v38, v38, v44
    v_accvgpr_write_b32 a80, v38
    v_accvgpr_read_b32 v39, a81
    v_mul_f32 v39, v39, v44
    v_accvgpr_write_b32 a81, v39
    v_accvgpr_read_b32 v40, a82
    v_mul_f32 v40, v40, v44
    v_accvgpr_write_b32 a82, v40
    v_accvgpr_read_b32 v41, a83
    v_mul_f32 v41, v41, v44
    v_accvgpr_write_b32 a83, v41
    v_accvgpr_read_b32 v38, a84
    v_mul_f32 v38, v38, v44
    v_accvgpr_write_b32 a84, v38
    v_accvgpr_read_b32 v39, a85
    v_mul_f32 v39, v39, v44
    v_accvgpr_write_b32 a85, v39
    v_accvgpr_read_b32 v40, a86
    v_mul_f32 v40, v40, v44
    v_accvgpr_write_b32 a86, v40
    v_accvgpr_read_b32 v41, a87
    v_mul_f32 v41, v41, v44
    v_accvgpr_write_b32 a87, v41
    v_accvgpr_read_b32 v38, a88
    v_mul_f32 v38, v38, v44
    v_accvgpr_write_b32 a88, v38
    v_accvgpr_read_b32 v39, a89
    v_mul_f32 v39, v39, v44
    v_accvgpr_write_b32 a89, v39
    v_accvgpr_read_b32 v40, a90
    v_mul_f32 v40, v40, v44
    v_accvgpr_write_b32 a90, v40
    v_accvgpr_read_b32 v41, a91
    v_mul_f32 v41, v41, v44
    v_accvgpr_write_b32 a91, v41
    v_accvgpr_read_b32 v38, a92
    v_mul_f32 v38, v38, v44
    v_accvgpr_write_b32 a92, v38
    v_accvgpr_read_b32 v39, a93
    v_mul_f32 v39, v39, v44
    v_accvgpr_write_b32 a93, v39
    v_accvgpr_read_b32 v40, a94
    v_mul_f32 v40, v40, v44
    v_accvgpr_write_b32 a94, v40
    v_accvgpr_read_b32 v41, a95
    v_mul_f32 v41, v41, v44
    v_accvgpr_write_b32 a95, v41
    v_accvgpr_read_b32 v38, a96
    v_mul_f32 v38, v38, v44
    v_accvgpr_write_b32 a96, v38
    v_accvgpr_read_b32 v39, a97
    v_mul_f32 v39, v39, v44
    v_accvgpr_write_b32 a97, v39
    v_accvgpr_read_b32 v40, a98
    v_mul_f32 v40, v40, v44
    v_accvgpr_write_b32 a98, v40
    v_accvgpr_read_b32 v41, a99
    v_mul_f32 v41, v41, v44
    v_accvgpr_write_b32 a99, v41
    v_accvgpr_read_b32 v38, a100
    v_mul_f32 v38, v38, v44
    v_accvgpr_write_b32 a100, v38
    v_accvgpr_read_b32 v39, a101
    v_mul_f32 v39, v39, v44
    v_accvgpr_write_b32 a101, v39
    v_accvgpr_read_b32 v40, a102
    v_mul_f32 v40, v40, v44
    v_accvgpr_write_b32 a102, v40
    v_accvgpr_read_b32 v41, a103
    v_mul_f32 v41, v41, v44
    v_accvgpr_write_b32 a103, v41
    v_accvgpr_read_b32 v38, a104
    v_mul_f32 v38, v38, v44
    v_accvgpr_write_b32 a104, v38
    v_accvgpr_read_b32 v39, a105
    v_mul_f32 v39, v39, v44
    v_accvgpr_write_b32 a105, v39
    v_accvgpr_read_b32 v40, a106
    v_mul_f32 v40, v40, v44
    v_accvgpr_write_b32 a106, v40
    v_accvgpr_read_b32 v41, a107
    v_mul_f32 v41, v41, v44
    v_accvgpr_write_b32 a107, v41
    v_accvgpr_read_b32 v38, a108
    v_mul_f32 v38, v38, v44
    v_accvgpr_write_b32 a108, v38
    v_accvgpr_read_b32 v39, a109
    v_mul_f32 v39, v39, v44
    v_accvgpr_write_b32 a109, v39
    v_accvgpr_read_b32 v40, a110
    v_mul_f32 v40, v40, v44
    v_accvgpr_write_b32 a110, v40
    v_accvgpr_read_b32 v41, a111
    v_mul_f32 v41, v41, v44
    v_accvgpr_write_b32 a111, v41
    v_accvgpr_read_b32 v38, a112
    v_mul_f32 v38, v38, v44
    v_accvgpr_write_b32 a112, v38
    v_accvgpr_read_b32 v39, a113
    v_mul_f32 v39, v39, v44
    v_accvgpr_write_b32 a113, v39
    v_accvgpr_read_b32 v40, a114
    v_mul_f32 v40, v40, v44
    v_accvgpr_write_b32 a114, v40
    v_accvgpr_read_b32 v41, a115
    v_mul_f32 v41, v41, v44
    v_accvgpr_write_b32 a115, v41
    v_accvgpr_read_b32 v38, a116
    v_mul_f32 v38, v38, v44
    v_accvgpr_write_b32 a116, v38
    v_accvgpr_read_b32 v39, a117
    v_mul_f32 v39, v39, v44
    v_accvgpr_write_b32 a117, v39
    v_accvgpr_read_b32 v40, a118
    v_mul_f32 v40, v40, v44
    v_accvgpr_write_b32 a118, v40
    v_accvgpr_read_b32 v41, a119
    v_mul_f32 v41, v41, v44
    v_accvgpr_write_b32 a119, v41
    v_accvgpr_read_b32 v38, a120
    v_mul_f32 v38, v38, v44
    v_accvgpr_write_b32 a120, v38
    v_accvgpr_read_b32 v39, a121
    v_mul_f32 v39, v39, v44
    v_accvgpr_write_b32 a121, v39
    v_accvgpr_read_b32 v40, a122
    v_mul_f32 v40, v40, v44
    v_accvgpr_write_b32 a122, v40
    v_accvgpr_read_b32 v41, a123
    v_mul_f32 v41, v41, v44
    v_accvgpr_write_b32 a123, v41
    v_accvgpr_read_b32 v38, a124
    v_mul_f32 v38, v38, v44
    v_accvgpr_write_b32 a124, v38
    v_accvgpr_read_b32 v39, a125
    v_mul_f32 v39, v39, v44
    v_accvgpr_write_b32 a125, v39
    v_accvgpr_read_b32 v40, a126
    v_mul_f32 v40, v40, v44
    v_accvgpr_write_b32 a126, v40
    v_accvgpr_read_b32 v41, a127
    v_mul_f32 v41, v41, v44
    v_accvgpr_write_b32 a127, v41
    v_exp_f32 v38, v112
    v_exp_f32 v39, v113
    v_exp_f32 v40, v114
    v_exp_f32 v41, v115
    v_add_f32 v36, v38, v39
    v_cvt_pk_bf16_f32 v48, v38, v39
    v_exp_f32 v38, v116
    v_exp_f32 v39, v117
    v_add_f32 v37, v40, v41
    v_cvt_pk_bf16_f32 v49, v40, v41
    v_exp_f32 v40, v118
    v_exp_f32 v41, v119
    v_add_f32 v36, v36, v38
    v_add_f32 v37, v37, v39
    v_cvt_pk_bf16_f32 v50, v38, v39
    v_exp_f32 v38, v120
    v_exp_f32 v39, v121
    v_add_f32 v36, v36, v40
    v_add_f32 v37, v37, v41
    v_cvt_pk_bf16_f32 v51, v40, v41
    v_exp_f32 v40, v122
    v_exp_f32 v41, v123
    v_add_f32 v36, v36, v38
    v_add_f32 v37, v37, v39
    v_cvt_pk_bf16_f32 v52, v38, v39
    v_exp_f32 v38, v124
    v_exp_f32 v39, v125
    v_add_f32 v36, v36, v40
    v_add_f32 v37, v37, v41
    v_cvt_pk_bf16_f32 v53, v40, v41
    v_exp_f32 v40, v126
    v_exp_f32 v41, v127
    v_add_f32 v36, v36, v38
    v_add_f32 v37, v37, v39
    v_cvt_pk_bf16_f32 v54, v38, v39
    s_nop 0
    v_add_f32 v36, v36, v40
    v_add_f32 v37, v37, v41
    v_cvt_pk_bf16_f32 v55, v40, v41
    v_add_f32 v35, v36, v37
    s_nop 3
    s_branch L_front_back_18
L_front_slow_19:
    s_nop 15
    s_nop 7
    v_max3_f32 v42, v80, v81, v82
    v_max3_f32 v42, v42, v83, v84
    v_max3_f32 v42, v42, v85, v86
    v_max3_f32 v42, v42, v87, v88
    v_max3_f32 v42, v42, v89, v90
    v_max3_f32 v42, v42, v91, v92
    v_max3_f32 v42, v42, v93, v94
    v_max_f32 v42, v42, v95
    v_mov_b32 v43, v42
    s_nop 1
    v_permlane32_swap_b32 v43, v42
    s_nop 1
    v_max_f32 v42, v42, v43
    v_max_f32 v42, 0, v42
    v_sub_f32 v44, 0, v42
    v_exp_f32 v44, v44
    v_sub_f32 v80, v80, v42
    v_sub_f32 v96, v96, v42
    v_sub_f32 v64, v64, v42
    v_sub_f32 v81, v81, v42
    v_sub_f32 v97, v97, v42
    v_sub_f32 v65, v65, v42
    v_sub_f32 v82, v82, v42
    v_sub_f32 v98, v98, v42
    v_sub_f32 v66, v66, v42
    v_sub_f32 v83, v83, v42
    v_sub_f32 v99, v99, v42
    v_sub_f32 v67, v67, v42
    v_sub_f32 v84, v84, v42
    v_sub_f32 v100, v100, v42
    v_sub_f32 v68, v68, v42
    v_sub_f32 v85, v85, v42
    v_sub_f32 v101, v101, v42
    v_sub_f32 v69, v69, v42
    v_sub_f32 v86, v86, v42
    v_sub_f32 v102, v102, v42
    v_sub_f32 v70, v70, v42
    v_sub_f32 v87, v87, v42
    v_sub_f32 v103, v103, v42
    v_sub_f32 v71, v71, v42
    v_sub_f32 v88, v88, v42
    v_sub_f32 v104, v104, v42
    v_sub_f32 v72, v72, v42
    v_sub_f32 v89, v89, v42
    v_sub_f32 v105, v105, v42
    v_sub_f32 v73, v73, v42
    v_sub_f32 v90, v90, v42
    v_sub_f32 v106, v106, v42
    v_sub_f32 v74, v74, v42
    v_sub_f32 v91, v91, v42
    v_sub_f32 v107, v107, v42
    v_sub_f32 v75, v75, v42
    v_sub_f32 v92, v92, v42
    v_sub_f32 v108, v108, v42
    v_sub_f32 v76, v76, v42
    v_sub_f32 v93, v93, v42
    v_sub_f32 v109, v109, v42
    v_sub_f32 v77, v77, v42
    v_sub_f32 v94, v94, v42
    v_sub_f32 v110, v110, v42
    v_sub_f32 v78, v78, v42
    v_sub_f32 v95, v95, v42
    v_sub_f32 v111, v111, v42
    v_sub_f32 v79, v79, v42
    v_mul_f32 v34, v34, v44
    v_accvgpr_read_b32 v38, a0
    v_mul_f32 v38, v38, v44
    v_accvgpr_write_b32 a0, v38
    v_accvgpr_read_b32 v39, a1
    v_mul_f32 v39, v39, v44
    v_accvgpr_write_b32 a1, v39
    v_accvgpr_read_b32 v40, a2
    v_mul_f32 v40, v40, v44
    v_accvgpr_write_b32 a2, v40
    v_accvgpr_read_b32 v41, a3
    v_mul_f32 v41, v41, v44
    v_accvgpr_write_b32 a3, v41
    v_accvgpr_read_b32 v38, a4
    v_mul_f32 v38, v38, v44
    v_accvgpr_write_b32 a4, v38
    v_accvgpr_read_b32 v39, a5
    v_mul_f32 v39, v39, v44
    v_accvgpr_write_b32 a5, v39
    v_accvgpr_read_b32 v40, a6
    v_mul_f32 v40, v40, v44
    v_accvgpr_write_b32 a6, v40
    v_accvgpr_read_b32 v41, a7
    v_mul_f32 v41, v41, v44
    v_accvgpr_write_b32 a7, v41
    v_accvgpr_read_b32 v38, a8
    v_mul_f32 v38, v38, v44
    v_accvgpr_write_b32 a8, v38
    v_accvgpr_read_b32 v39, a9
    v_mul_f32 v39, v39, v44
    v_accvgpr_write_b32 a9, v39
    v_accvgpr_read_b32 v40, a10
    v_mul_f32 v40, v40, v44
    v_accvgpr_write_b32 a10, v40
    v_accvgpr_read_b32 v41, a11
    v_mul_f32 v41, v41, v44
    v_accvgpr_write_b32 a11, v41
    v_accvgpr_read_b32 v38, a12
    v_mul_f32 v38, v38, v44
    v_accvgpr_write_b32 a12, v38
    v_accvgpr_read_b32 v39, a13
    v_mul_f32 v39, v39, v44
    v_accvgpr_write_b32 a13, v39
    v_accvgpr_read_b32 v40, a14
    v_mul_f32 v40, v40, v44
    v_accvgpr_write_b32 a14, v40
    v_accvgpr_read_b32 v41, a15
    v_mul_f32 v41, v41, v44
    v_accvgpr_write_b32 a15, v41
    v_accvgpr_read_b32 v38, a16
    v_mul_f32 v38, v38, v44
    v_accvgpr_write_b32 a16, v38
    v_accvgpr_read_b32 v39, a17
    v_mul_f32 v39, v39, v44
    v_accvgpr_write_b32 a17, v39
    v_accvgpr_read_b32 v40, a18
    v_mul_f32 v40, v40, v44
    v_accvgpr_write_b32 a18, v40
    v_accvgpr_read_b32 v41, a19
    v_mul_f32 v41, v41, v44
    v_accvgpr_write_b32 a19, v41
    v_accvgpr_read_b32 v38, a20
    v_mul_f32 v38, v38, v44
    v_accvgpr_write_b32 a20, v38
    v_accvgpr_read_b32 v39, a21
    v_mul_f32 v39, v39, v44
    v_accvgpr_write_b32 a21, v39
    v_accvgpr_read_b32 v40, a22
    v_mul_f32 v40, v40, v44
    v_accvgpr_write_b32 a22, v40
    v_accvgpr_read_b32 v41, a23
    v_mul_f32 v41, v41, v44
    v_accvgpr_write_b32 a23, v41
    v_accvgpr_read_b32 v38, a24
    v_mul_f32 v38, v38, v44
    v_accvgpr_write_b32 a24, v38
    v_accvgpr_read_b32 v39, a25
    v_mul_f32 v39, v39, v44
    v_accvgpr_write_b32 a25, v39
    v_accvgpr_read_b32 v40, a26
    v_mul_f32 v40, v40, v44
    v_accvgpr_write_b32 a26, v40
    v_accvgpr_read_b32 v41, a27
    v_mul_f32 v41, v41, v44
    v_accvgpr_write_b32 a27, v41
    v_accvgpr_read_b32 v38, a28
    v_mul_f32 v38, v38, v44
    v_accvgpr_write_b32 a28, v38
    v_accvgpr_read_b32 v39, a29
    v_mul_f32 v39, v39, v44
    v_accvgpr_write_b32 a29, v39
    v_accvgpr_read_b32 v40, a30
    v_mul_f32 v40, v40, v44
    v_accvgpr_write_b32 a30, v40
    v_accvgpr_read_b32 v41, a31
    v_mul_f32 v41, v41, v44
    v_accvgpr_write_b32 a31, v41
    v_accvgpr_read_b32 v38, a32
    v_mul_f32 v38, v38, v44
    v_accvgpr_write_b32 a32, v38
    v_accvgpr_read_b32 v39, a33
    v_mul_f32 v39, v39, v44
    v_accvgpr_write_b32 a33, v39
    v_accvgpr_read_b32 v40, a34
    v_mul_f32 v40, v40, v44
    v_accvgpr_write_b32 a34, v40
    v_accvgpr_read_b32 v41, a35
    v_mul_f32 v41, v41, v44
    v_accvgpr_write_b32 a35, v41
    v_accvgpr_read_b32 v38, a36
    v_mul_f32 v38, v38, v44
    v_accvgpr_write_b32 a36, v38
    v_accvgpr_read_b32 v39, a37
    v_mul_f32 v39, v39, v44
    v_accvgpr_write_b32 a37, v39
    v_accvgpr_read_b32 v40, a38
    v_mul_f32 v40, v40, v44
    v_accvgpr_write_b32 a38, v40
    v_accvgpr_read_b32 v41, a39
    v_mul_f32 v41, v41, v44
    v_accvgpr_write_b32 a39, v41
    v_accvgpr_read_b32 v38, a40
    v_mul_f32 v38, v38, v44
    v_accvgpr_write_b32 a40, v38
    v_accvgpr_read_b32 v39, a41
    v_mul_f32 v39, v39, v44
    v_accvgpr_write_b32 a41, v39
    v_accvgpr_read_b32 v40, a42
    v_mul_f32 v40, v40, v44
    v_accvgpr_write_b32 a42, v40
    v_accvgpr_read_b32 v41, a43
    v_mul_f32 v41, v41, v44
    v_accvgpr_write_b32 a43, v41
    v_accvgpr_read_b32 v38, a44
    v_mul_f32 v38, v38, v44
    v_accvgpr_write_b32 a44, v38
    v_accvgpr_read_b32 v39, a45
    v_mul_f32 v39, v39, v44
    v_accvgpr_write_b32 a45, v39
    v_accvgpr_read_b32 v40, a46
    v_mul_f32 v40, v40, v44
    v_accvgpr_write_b32 a46, v40
    v_accvgpr_read_b32 v41, a47
    v_mul_f32 v41, v41, v44
    v_accvgpr_write_b32 a47, v41
    v_accvgpr_read_b32 v38, a48
    v_mul_f32 v38, v38, v44
    v_accvgpr_write_b32 a48, v38
    v_accvgpr_read_b32 v39, a49
    v_mul_f32 v39, v39, v44
    v_accvgpr_write_b32 a49, v39
    v_accvgpr_read_b32 v40, a50
    v_mul_f32 v40, v40, v44
    v_accvgpr_write_b32 a50, v40
    v_accvgpr_read_b32 v41, a51
    v_mul_f32 v41, v41, v44
    v_accvgpr_write_b32 a51, v41
    v_accvgpr_read_b32 v38, a52
    v_mul_f32 v38, v38, v44
    v_accvgpr_write_b32 a52, v38
    v_accvgpr_read_b32 v39, a53
    v_mul_f32 v39, v39, v44
    v_accvgpr_write_b32 a53, v39
    v_accvgpr_read_b32 v40, a54
    v_mul_f32 v40, v40, v44
    v_accvgpr_write_b32 a54, v40
    v_accvgpr_read_b32 v41, a55
    v_mul_f32 v41, v41, v44
    v_accvgpr_write_b32 a55, v41
    v_accvgpr_read_b32 v38, a56
    v_mul_f32 v38, v38, v44
    v_accvgpr_write_b32 a56, v38
    v_accvgpr_read_b32 v39, a57
    v_mul_f32 v39, v39, v44
    v_accvgpr_write_b32 a57, v39
    v_accvgpr_read_b32 v40, a58
    v_mul_f32 v40, v40, v44
    v_accvgpr_write_b32 a58, v40
    v_accvgpr_read_b32 v41, a59
    v_mul_f32 v41, v41, v44
    v_accvgpr_write_b32 a59, v41
    v_accvgpr_read_b32 v38, a60
    v_mul_f32 v38, v38, v44
    v_accvgpr_write_b32 a60, v38
    v_accvgpr_read_b32 v39, a61
    v_mul_f32 v39, v39, v44
    v_accvgpr_write_b32 a61, v39
    v_accvgpr_read_b32 v40, a62
    v_mul_f32 v40, v40, v44
    v_accvgpr_write_b32 a62, v40
    v_accvgpr_read_b32 v41, a63
    v_mul_f32 v41, v41, v44
    v_accvgpr_write_b32 a63, v41
    v_accvgpr_read_b32 v38, a64
    v_mul_f32 v38, v38, v44
    v_accvgpr_write_b32 a64, v38
    v_accvgpr_read_b32 v39, a65
    v_mul_f32 v39, v39, v44
    v_accvgpr_write_b32 a65, v39
    v_accvgpr_read_b32 v40, a66
    v_mul_f32 v40, v40, v44
    v_accvgpr_write_b32 a66, v40
    v_accvgpr_read_b32 v41, a67
    v_mul_f32 v41, v41, v44
    v_accvgpr_write_b32 a67, v41
    v_accvgpr_read_b32 v38, a68
    v_mul_f32 v38, v38, v44
    v_accvgpr_write_b32 a68, v38
    v_accvgpr_read_b32 v39, a69
    v_mul_f32 v39, v39, v44
    v_accvgpr_write_b32 a69, v39
    v_accvgpr_read_b32 v40, a70
    v_mul_f32 v40, v40, v44
    v_accvgpr_write_b32 a70, v40
    v_accvgpr_read_b32 v41, a71
    v_mul_f32 v41, v41, v44
    v_accvgpr_write_b32 a71, v41
    v_accvgpr_read_b32 v38, a72
    v_mul_f32 v38, v38, v44
    v_accvgpr_write_b32 a72, v38
    v_accvgpr_read_b32 v39, a73
    v_mul_f32 v39, v39, v44
    v_accvgpr_write_b32 a73, v39
    v_accvgpr_read_b32 v40, a74
    v_mul_f32 v40, v40, v44
    v_accvgpr_write_b32 a74, v40
    v_accvgpr_read_b32 v41, a75
    v_mul_f32 v41, v41, v44
    v_accvgpr_write_b32 a75, v41
    v_accvgpr_read_b32 v38, a76
    v_mul_f32 v38, v38, v44
    v_accvgpr_write_b32 a76, v38
    v_accvgpr_read_b32 v39, a77
    v_mul_f32 v39, v39, v44
    v_accvgpr_write_b32 a77, v39
    v_accvgpr_read_b32 v40, a78
    v_mul_f32 v40, v40, v44
    v_accvgpr_write_b32 a78, v40
    v_accvgpr_read_b32 v41, a79
    v_mul_f32 v41, v41, v44
    v_accvgpr_write_b32 a79, v41
    v_accvgpr_read_b32 v38, a80
    v_mul_f32 v38, v38, v44
    v_accvgpr_write_b32 a80, v38
    v_accvgpr_read_b32 v39, a81
    v_mul_f32 v39, v39, v44
    v_accvgpr_write_b32 a81, v39
    v_accvgpr_read_b32 v40, a82
    v_mul_f32 v40, v40, v44
    v_accvgpr_write_b32 a82, v40
    v_accvgpr_read_b32 v41, a83
    v_mul_f32 v41, v41, v44
    v_accvgpr_write_b32 a83, v41
    v_accvgpr_read_b32 v38, a84
    v_mul_f32 v38, v38, v44
    v_accvgpr_write_b32 a84, v38
    v_accvgpr_read_b32 v39, a85
    v_mul_f32 v39, v39, v44
    v_accvgpr_write_b32 a85, v39
    v_accvgpr_read_b32 v40, a86
    v_mul_f32 v40, v40, v44
    v_accvgpr_write_b32 a86, v40
    v_accvgpr_read_b32 v41, a87
    v_mul_f32 v41, v41, v44
    v_accvgpr_write_b32 a87, v41
    v_accvgpr_read_b32 v38, a88
    v_mul_f32 v38, v38, v44
    v_accvgpr_write_b32 a88, v38
    v_accvgpr_read_b32 v39, a89
    v_mul_f32 v39, v39, v44
    v_accvgpr_write_b32 a89, v39
    v_accvgpr_read_b32 v40, a90
    v_mul_f32 v40, v40, v44
    v_accvgpr_write_b32 a90, v40
    v_accvgpr_read_b32 v41, a91
    v_mul_f32 v41, v41, v44
    v_accvgpr_write_b32 a91, v41
    v_accvgpr_read_b32 v38, a92
    v_mul_f32 v38, v38, v44
    v_accvgpr_write_b32 a92, v38
    v_accvgpr_read_b32 v39, a93
    v_mul_f32 v39, v39, v44
    v_accvgpr_write_b32 a93, v39
    v_accvgpr_read_b32 v40, a94
    v_mul_f32 v40, v40, v44
    v_accvgpr_write_b32 a94, v40
    v_accvgpr_read_b32 v41, a95
    v_mul_f32 v41, v41, v44
    v_accvgpr_write_b32 a95, v41
    v_accvgpr_read_b32 v38, a96
    v_mul_f32 v38, v38, v44
    v_accvgpr_write_b32 a96, v38
    v_accvgpr_read_b32 v39, a97
    v_mul_f32 v39, v39, v44
    v_accvgpr_write_b32 a97, v39
    v_accvgpr_read_b32 v40, a98
    v_mul_f32 v40, v40, v44
    v_accvgpr_write_b32 a98, v40
    v_accvgpr_read_b32 v41, a99
    v_mul_f32 v41, v41, v44
    v_accvgpr_write_b32 a99, v41
    v_accvgpr_read_b32 v38, a100
    v_mul_f32 v38, v38, v44
    v_accvgpr_write_b32 a100, v38
    v_accvgpr_read_b32 v39, a101
    v_mul_f32 v39, v39, v44
    v_accvgpr_write_b32 a101, v39
    v_accvgpr_read_b32 v40, a102
    v_mul_f32 v40, v40, v44
    v_accvgpr_write_b32 a102, v40
    v_accvgpr_read_b32 v41, a103
    v_mul_f32 v41, v41, v44
    v_accvgpr_write_b32 a103, v41
    v_accvgpr_read_b32 v38, a104
    v_mul_f32 v38, v38, v44
    v_accvgpr_write_b32 a104, v38
    v_accvgpr_read_b32 v39, a105
    v_mul_f32 v39, v39, v44
    v_accvgpr_write_b32 a105, v39
    v_accvgpr_read_b32 v40, a106
    v_mul_f32 v40, v40, v44
    v_accvgpr_write_b32 a106, v40
    v_accvgpr_read_b32 v41, a107
    v_mul_f32 v41, v41, v44
    v_accvgpr_write_b32 a107, v41
    v_accvgpr_read_b32 v38, a108
    v_mul_f32 v38, v38, v44
    v_accvgpr_write_b32 a108, v38
    v_accvgpr_read_b32 v39, a109
    v_mul_f32 v39, v39, v44
    v_accvgpr_write_b32 a109, v39
    v_accvgpr_read_b32 v40, a110
    v_mul_f32 v40, v40, v44
    v_accvgpr_write_b32 a110, v40
    v_accvgpr_read_b32 v41, a111
    v_mul_f32 v41, v41, v44
    v_accvgpr_write_b32 a111, v41
    v_accvgpr_read_b32 v38, a112
    v_mul_f32 v38, v38, v44
    v_accvgpr_write_b32 a112, v38
    v_accvgpr_read_b32 v39, a113
    v_mul_f32 v39, v39, v44
    v_accvgpr_write_b32 a113, v39
    v_accvgpr_read_b32 v40, a114
    v_mul_f32 v40, v40, v44
    v_accvgpr_write_b32 a114, v40
    v_accvgpr_read_b32 v41, a115
    v_mul_f32 v41, v41, v44
    v_accvgpr_write_b32 a115, v41
    v_accvgpr_read_b32 v38, a116
    v_mul_f32 v38, v38, v44
    v_accvgpr_write_b32 a116, v38
    v_accvgpr_read_b32 v39, a117
    v_mul_f32 v39, v39, v44
    v_accvgpr_write_b32 a117, v39
    v_accvgpr_read_b32 v40, a118
    v_mul_f32 v40, v40, v44
    v_accvgpr_write_b32 a118, v40
    v_accvgpr_read_b32 v41, a119
    v_mul_f32 v41, v41, v44
    v_accvgpr_write_b32 a119, v41
    v_accvgpr_read_b32 v38, a120
    v_mul_f32 v38, v38, v44
    v_accvgpr_write_b32 a120, v38
    v_accvgpr_read_b32 v39, a121
    v_mul_f32 v39, v39, v44
    v_accvgpr_write_b32 a121, v39
    v_accvgpr_read_b32 v40, a122
    v_mul_f32 v40, v40, v44
    v_accvgpr_write_b32 a122, v40
    v_accvgpr_read_b32 v41, a123
    v_mul_f32 v41, v41, v44
    v_accvgpr_write_b32 a123, v41
    v_accvgpr_read_b32 v38, a124
    v_mul_f32 v38, v38, v44
    v_accvgpr_write_b32 a124, v38
    v_accvgpr_read_b32 v39, a125
    v_mul_f32 v39, v39, v44
    v_accvgpr_write_b32 a125, v39
    v_accvgpr_read_b32 v40, a126
    v_mul_f32 v40, v40, v44
    v_accvgpr_write_b32 a126, v40
    v_accvgpr_read_b32 v41, a127
    v_mul_f32 v41, v41, v44
    v_accvgpr_write_b32 a127, v41
    v_exp_f32 v38, v80
    v_exp_f32 v39, v81
    v_exp_f32 v40, v82
    v_exp_f32 v41, v83
    v_add_f32 v36, v38, v39
    v_cvt_pk_bf16_f32 v48, v38, v39
    v_exp_f32 v38, v84
    v_exp_f32 v39, v85
    v_add_f32 v37, v40, v41
    v_cvt_pk_bf16_f32 v49, v40, v41
    v_exp_f32 v40, v86
    v_exp_f32 v41, v87
    v_add_f32 v36, v36, v38
    v_add_f32 v37, v37, v39
    v_cvt_pk_bf16_f32 v50, v38, v39
    v_exp_f32 v38, v88
    v_exp_f32 v39, v89
    v_add_f32 v36, v36, v40
    v_add_f32 v37, v37, v41
    v_cvt_pk_bf16_f32 v51, v40, v41
    v_exp_f32 v40, v90
    v_exp_f32 v41, v91
    v_add_f32 v36, v36, v38
    v_add_f32 v37, v37, v39
    v_cvt_pk_bf16_f32 v52, v38, v39
    v_exp_f32 v38, v92
    v_exp_f32 v39, v93
    v_add_f32 v36, v36, v40
    v_add_f32 v37, v37, v41
    v_cvt_pk_bf16_f32 v53, v40, v41
    v_exp_f32 v40, v94
    v_exp_f32 v41, v95
    v_add_f32 v36, v36, v38
    v_add_f32 v37, v37, v39
    v_cvt_pk_bf16_f32 v54, v38, v39
    s_nop 0
    v_add_f32 v36, v36, v40
    v_add_f32 v37, v37, v41
    v_cvt_pk_bf16_f32 v55, v40, v41
    v_add_f32 v35, v36, v37
    s_nop 3
    s_branch L_front_back_20
L_attn_done:
    s_endpgm
L_front_g1:
    s_load_dwordx2 s[10:11], s[0:1], 96
    s_load_dwordx2 s[6:7], s[0:1], 48
    s_load_dwordx2 s[8:9], s[0:1], 88
    s_and_b32 s14, s2, 7
    s_lshr_b32 s15, s2, 3
    s_mov_b32 s12, 306783379
    s_mul_hi_u32 s39, s15, s12
    s_mul_i32 s12, s39, 14
    s_sub_u32 s38, s15, s12
    s_mul_i32 s14, s14, 2
    s_add_u32 s39, s39, s14
    v_and_b32 v1, 63, v0
    v_and_b32 v2, 31, v0
    v_bfe_u32 v3, v0, 5, 1
    v_lshlrev_b32 v9, 4, v1
    v_lshrrev_b32 v5, 6, v0
    s_nop 0
    v_readfirstlane_b32 s3, v5
    s_nop 3
    s_lshl_b32 s41, s3, 10
    v_bfe_u32 v5, v1, 2, 2
    v_and_b32 v6, 3, v1
    v_bfe_u32 v7, v1, 4, 1
    v_lshlrev_b32 v8, 3, v6
    v_lshl_add_u32 v8, v7, 5, v8
    v_lshl_add_u32 v6, v3, 3, v5
    v_mul_u32_u24 v6, 256, v6
    v_add_u32 v8, v8, v6
    v_xor_b32 v7, 0, v5
    v_lshl_add_u32 v12, v7, 6, v8
    v_xor_b32 v7, 1, v5
    v_lshl_add_u32 v13, v7, 6, v8
    v_xor_b32 v7, 2, v5
    v_lshl_add_u32 v14, v7, 6, v8
    v_xor_b32 v7, 3, v5
    v_lshl_add_u32 v15, v7, 6, v8
    v_add_u32 v16, 0x10000, v12
    v_add_u32 v17, 0x10000, v13
    v_add_u32 v18, 0x10000, v14
    v_add_u32 v19, 0x10000, v15
    v_lshrrev_b32 v5, 4, v1
    v_and_b32 v6, 15, v1
    s_mul_i32 s14, s3, 4
    v_add_u32 v5, s14, v5
    v_add_u32 v7, 0, v5
    v_and_b32 v8, 3, v7
    v_lshlrev_b32 v8, 2, v8
    v_xor_b32 v8, v8, v6
    s_mov_b32 s14, 3584
    v_mul_lo_u32 v7, v7, s14
    v_lshl_add_u32 v20, v8, 4, v7
    v_add_u32 v7, 16, v5
    v_and_b32 v8, 3, v7
    v_lshlrev_b32 v8, 2, v8
    v_xor_b32 v8, v8, v6
    s_mov_b32 s14, 3584
    v_mul_lo_u32 v7, v7, s14
    v_lshl_add_u32 v21, v8, 4, v7
    v_add_u32 v7, 32, v5
    v_and_b32 v8, 3, v7
    v_lshlrev_b32 v8, 2, v8
    v_xor_b32 v8, v8, v6
    s_mov_b32 s14, 3584
    v_mul_lo_u32 v7, v7, s14
    v_lshl_add_u32 v22, v8, 4, v7
    v_add_u32 v7, 48, v5
    v_and_b32 v8, 3, v7
    v_lshlrev_b32 v8, 2, v8
    v_xor_b32 v8, v8, v6
    s_mov_b32 s14, 3584
    v_mul_lo_u32 v7, v7, s14
    v_lshl_add_u32 v23, v8, 4, v7
    s_waitcnt lgkmcnt(0)
    s_add_u32 s16, s10, 0
    s_addc_u32 s17, s11, 0
    s_mov_b32 s18, 1835008
    s_mov_b32 s19, 0x00020000
    s_mov_b32 s20, s6
    s_mov_b32 s21, s7
    s_mov_b32 s22, 1605632
    s_mov_b32 s23, 0x00020000
    s_lshl_b32 s36, s38, 8
    s_lshl_b32 s14, s39, 2
    s_add_u32 s44, s14, s3
    s_mul_i32 s15, s44, 28672
    s_add_u32 m0, s41, 0
    s_nop 0
    buffer_load_dwordx4 v20, s[20:23], s36 offen lds
    s_add_u32 m0, s41, 4096
    s_nop 0
    buffer_load_dwordx4 v21, s[20:23], s36 offen lds
    s_add_u32 m0, s41, 8192
    s_nop 0
    buffer_load_dwordx4 v22, s[20:23], s36 offen lds
    s_add_u32 m0, s41, 12288
    s_nop 0
    buffer_load_dwordx4 v23, s[20:23], s36 offen lds
    s_add_u32 s36, s36, 229376
    buffer_load_dwordx4 v[32:35], v9, s[16:19], s15 offen offset:0
    buffer_load_dwordx4 v[36:39], v9, s[16:19], s15 offen offset:1024
    buffer_load_dwordx4 v[40:43], v9, s[16:19], s15 offen offset:2048
    buffer_load_dwordx4 v[44:47], v9, s[16:19], s15 offen offset:3072
    s_add_u32 s15, s15, 4096
    s_add_u32 m0, s41, 16384
    s_nop 0
    buffer_load_dwordx4 v20, s[20:23], s36 offen lds
    s_add_u32 m0, s41, 20480
    s_nop 0
    buffer_load_dwordx4 v21, s[20:23], s36 offen lds
    s_add_u32 m0, s41, 24576
    s_nop 0
    buffer_load_dwordx4 v22, s[20:23], s36 offen lds
    s_add_u32 m0, s41, 28672
    s_nop 0
    buffer_load_dwordx4 v23, s[20:23], s36 offen lds
    s_add_u32 s36, s36, 229376
    buffer_load_dwordx4 v[48:51], v9, s[16:19], s15 offen offset:0
    buffer_load_dwordx4 v[52:55], v9, s[16:19], s15 offen offset:1024
    buffer_load_dwordx4 v[56:59], v9, s[16:19], s15 offen offset:2048
    buffer_load_dwordx4 v[60:63], v9, s[16:19], s15 offen offset:3072
    s_add_u32 s15, s15, 4096
    s_add_u32 m0, s41, 32768
    s_nop 0
    buffer_load_dwordx4 v20, s[20:23], s36 offen lds
    s_add_u32 m0, s41, 36864
    s_nop 0
    buffer_load_dwordx4 v21, s[20:23], s36 offen lds
    s_add_u32 m0, s41, 40960
    s_nop 0
    buffer_load_dwordx4 v22, s[20:23], s36 offen lds
    s_add_u32 m0, s41, 45056
    s_nop 0
    buffer_load_dwordx4 v23, s[20:23], s36 offen lds
    s_add_u32 s36, s36, 229376
    buffer_load_dwordx4 v[64:67], v9, s[16:19], s15 offen offset:0
    buffer_load_dwordx4 v[68:71], v9, s[16:19], s15 offen offset:1024
    buffer_load_dwordx4 v[72:75], v9, s[16:19], s15 offen offset:2048
    buffer_load_dwordx4 v[76:79], v9, s[16:19], s15 offen offset:3072
    s_add_u32 s15, s15, 4096
    s_add_u32 m0, s41, 49152
    s_nop 0
    buffer_load_dwordx4 v20, s[20:23], s36 offen lds
    s_add_u32 m0, s41, 53248
    s_nop 0
    buffer_load_dwordx4 v21, s[20:23], s36 offen lds
    s_add_u32 m0, s41, 57344
    s_nop 0
    buffer_load_dwordx4 v22, s[20:23], s36 offen lds
    s_add_u32 m0, s41, 61440
    s_nop 0
    buffer_load_dwordx4 v23, s[20:23], s36 offen lds
    s_add_u32 s36, s36, 229376
    buffer_load_dwordx4 v[80:83], v9, s[16:19], s15 offen offset:0
    buffer_load_dwordx4 v[84:87], v9, s[16:19], s15 offen offset:1024
    buffer_load_dwordx4 v[88:91], v9, s[16:19], s15 offen offset:2048
    buffer_load_dwordx4 v[92:95], v9, s[16:19], s15 offen offset:3072
    s_add_u32 s15, s15, 4096
    s_add_u32 m0, s41, 65536
    s_nop 0
    buffer_load_dwordx4 v20, s[20:23], s36 offen lds
    s_add_u32 m0, s41, 69632
    s_nop 0
    buffer_load_dwordx4 v21, s[20:23], s36 offen lds
    s_add_u32 m0, s41, 73728
    s_nop 0
    buffer_load_dwordx4 v22, s[20:23], s36 offen lds
    s_add_u32 m0, s41, 77824
    s_nop 0
    buffer_load_dwordx4 v23, s[20:23], s36 offen lds
    s_add_u32 s36, s36, 229376
    buffer_load_dwordx4 v[96:99], v9, s[16:19], s15 offen offset:0
    buffer_load_dwordx4 v[100:103], v9, s[16:19], s15 offen offset:1024
    buffer_load_dwordx4 v[104:107], v9, s[16:19], s15 offen offset:2048
    buffer_load_dwordx4 v[108:111], v9, s[16:19], s15 offen offset:3072
    s_add_u32 s15, s15, 4096
    s_add_u32 m0, s41, 81920
    s_nop 0
    buffer_load_dwordx4 v20, s[20:23], s36 offen lds
    s_add_u32 m0, s41, 86016
    s_nop 0
    buffer_load_dwordx4 v21, s[20:23], s36 offen lds
    s_add_u32 m0, s41, 90112
    s_nop 0
    buffer_load_dwordx4 v22, s[20:23], s36 offen lds
    s_add_u32 m0, s41, 94208
    s_nop 0
    buffer_load_dwordx4 v23, s[20:23], s36 offen lds
    s_add_u32 s36, s36, 229376
    buffer_load_dwordx4 v[112:115], v9, s[16:19], s15 offen offset:0
    buffer_load_dwordx4 v[116:119], v9, s[16:19], s15 offen offset:1024
    buffer_load_dwordx4 v[120:123], v9, s[16:19], s15 offen offset:2048
    buffer_load_dwordx4 v[124:127], v9, s[16:19], s15 offen offset:3072
    s_add_u32 s15, s15, 4096
    s_add_u32 m0, s41, 98304
    s_nop 0
    buffer_load_dwordx4 v20, s[20:23], s36 offen lds
    s_add_u32 m0, s41, 102400
    s_nop 0
    buffer_load_dwordx4 v21, s[20:23], s36 offen lds
    s_add_u32 m0, s41, 106496
    s_nop 0
    buffer_load_dwordx4 v22, s[20:23], s36 offen lds
    s_add_u32 m0, s41, 110592
    s_nop 0
    buffer_load_dwordx4 v23, s[20:23], s36 offen lds
    s_add_u32 s36, s36, 229376
    buffer_load_dwordx4 v[128:131], v9, s[16:19], s15 offen offset:0
    buffer_load_dwordx4 v[132:135], v9, s[16:19], s15 offen offset:1024
    buffer_load_dwordx4 v[136:139], v9, s[16:19], s15 offen offset:2048
    buffer_load_dwordx4 v[140:143], v9, s[16:19], s15 offen offset:3072
    s_add_u32 s15, s15, 4096
    s_waitcnt vmcnt(48)
    s_waitcnt lgkmcnt(0)
    s_barrier
    ds_read_b64_tr_b16 a[0:1], v12 offset:0
    ds_read_b64_tr_b16 a[2:3], v12 offset:1024
    ds_read_b64_tr_b16 a[4:5], v13 offset:0
    ds_read_b64_tr_b16 a[6:7], v13 offset:1024
    ds_read_b64_tr_b16 a[8:9], v14 offset:0
    ds_read_b64_tr_b16 a[10:11], v14 offset:1024
    ds_read_b64_tr_b16 a[12:13], v15 offset:0
    ds_read_b64_tr_b16 a[14:15], v15 offset:1024
    ds_read_b64_tr_b16 a[16:17], v12 offset:4096
    ds_read_b64_tr_b16 a[18:19], v12 offset:5120
    ds_read_b64_tr_b16 a[20:21], v13 offset:4096
    ds_read_b64_tr_b16 a[22:23], v13 offset:5120
    ds_read_b64_tr_b16 a[24:25], v14 offset:4096
    ds_read_b64_tr_b16 a[26:27], v14 offset:5120
    ds_read_b64_tr_b16 a[28:29], v15 offset:4096
    ds_read_b64_tr_b16 a[30:31], v15 offset:5120
    ds_read_b64_tr_b16 a[32:33], v12 offset:8192
    ds_read_b64_tr_b16 a[34:35], v12 offset:9216
    ds_read_b64_tr_b16 a[36:37], v13 offset:8192
    ds_read_b64_tr_b16 a[38:39], v13 offset:9216
    ds_read_b64_tr_b16 a[40:41], v14 offset:8192
    ds_read_b64_tr_b16 a[42:43], v14 offset:9216
    ds_read_b64_tr_b16 a[44:45], v15 offset:8192
    ds_read_b64_tr_b16 a[46:47], v15 offset:9216
    ds_read_b64_tr_b16 a[48:49], v12 offset:12288
    ds_read_b64_tr_b16 a[50:51], v12 offset:13312
    ds_read_b64_tr_b16 a[52:53], v13 offset:12288
    ds_read_b64_tr_b16 a[54:55], v13 offset:13312
    ds_read_b64_tr_b16 a[56:57], v14 offset:12288
    ds_read_b64_tr_b16 a[58:59], v14 offset:13312
    ds_read_b64_tr_b16 a[60:61], v15 offset:12288
    ds_read_b64_tr_b16 a[62:63], v15 offset:13312
    s_waitcnt vmcnt(40)
    s_waitcnt lgkmcnt(0)
    s_barrier
    ds_read_b64_tr_b16 a[64:65], v12 offset:16384
    ds_read_b64_tr_b16 a[66:67], v12 offset:17408
    v_mfma_f32_32x32x16_bf16 v[144:159], a[0:3], v[32:35], 0
    ds_read_b64_tr_b16 a[68:69], v13 offset:16384
    ds_read_b64_tr_b16 a[70:71], v13 offset:17408
    v_mfma_f32_32x32x16_bf16 v[160:175], a[4:7], v[32:35], 0
    ds_read_b64_tr_b16 a[72:73], v14 offset:16384
    ds_read_b64_tr_b16 a[74:75], v14 offset:17408
    v_mfma_f32_32x32x16_bf16 v[176:191], a[8:11], v[32:35], 0
    ds_read_b64_tr_b16 a[76:77], v15 offset:16384
    ds_read_b64_tr_b16 a[78:79], v15 offset:17408
    v_mfma_f32_32x32x16_bf16 v[192:207], a[12:15], v[32:35], 0
    ds_read_b64_tr_b16 a[80:81], v12 offset:20480
    ds_read_b64_tr_b16 a[82:83], v12 offset:21504
    v_mfma_f32_32x32x16_bf16 v[144:159], a[16:19], v[36:39], v[144:159]
    ds_read_b64_tr_b16 a[84:85], v13 offset:20480
    ds_read_b64_tr_b16 a[86:87], v13 offset:21504
    v_mfma_f32_32x32x16_bf16 v[160:175], a[20:23], v[36:39], v[160:175]
    ds_read_b64_tr_b16 a[88:89], v14 offset:20480
    ds_read_b64_tr_b16 a[90:91], v14 offset:21504
    v_mfma_f32_32x32x16_bf16 v[176:191], a[24:27], v[36:39], v[176:191]
    ds_read_b64_tr_b16 a[92:93], v15 offset:20480
    ds_read_b64_tr_b16 a[94:95], v15 offset:21504
    v_mfma_f32_32x32x16_bf16 v[192:207], a[28:31], v[36:39], v[192:207]
    ds_read_b64_tr_b16 a[96:97], v12 offset:24576
    ds_read_b64_tr_b16 a[98:99], v12 offset:25600
    v_mfma_f32_32x32x16_bf16 v[144:159], a[32:35], v[40:43], v[144:159]
    ds_read_b64_tr_b16 a[100:101], v13 offset:24576
    ds_read_b64_tr_b16 a[102:103], v13 offset:25600
    v_mfma_f32_32x32x16_bf16 v[160:175], a[36:39], v[40:43], v[160:175]
    ds_read_b64_tr_b16 a[104:105], v14 offset:24576
    ds_read_b64_tr_b16 a[106:107], v14 offset:25600
    v_mfma_f32_32x32x16_bf16 v[176:191], a[40:43], v[40:43], v[176:191]
    ds_read_b64_tr_b16 a[108:109], v15 offset:24576
    ds_read_b64_tr_b16 a[110:111], v15 offset:25600
    v_mfma_f32_32x32x16_bf16 v[192:207], a[44:47], v[40:43], v[192:207]
    ds_read_b64_tr_b16 a[112:113], v12 offset:28672
    ds_read_b64_tr_b16 a[114:115], v12 offset:29696
    v_mfma_f32_32x32x16_bf16 v[144:159], a[48:51], v[44:47], v[144:159]
    ds_read_b64_tr_b16 a[116:117], v13 offset:28672
    ds_read_b64_tr_b16 a[118:119], v13 offset:29696
    v_mfma_f32_32x32x16_bf16 v[160:175], a[52:55], v[44:47], v[160:175]
    ds_read_b64_tr_b16 a[120:121], v14 offset:28672
    ds_read_b64_tr_b16 a[122:123], v14 offset:29696
    v_mfma_f32_32x32x16_bf16 v[176:191], a[56:59], v[44:47], v[176:191]
    ds_read_b64_tr_b16 a[124:125], v15 offset:28672
    ds_read_b64_tr_b16 a[126:127], v15 offset:29696
    v_mfma_f32_32x32x16_bf16 v[192:207], a[60:63], v[44:47], v[192:207]
    s_waitcnt vmcnt(32)
    s_waitcnt lgkmcnt(0)
    s_barrier
    ds_read_b64_tr_b16 a[0:1], v12 offset:32768
    ds_read_b64_tr_b16 a[2:3], v12 offset:33792
    v_mfma_f32_32x32x16_bf16 v[144:159], a[64:67], v[48:51], v[144:159]
    ds_read_b64_tr_b16 a[4:5], v13 offset:32768
    ds_read_b64_tr_b16 a[6:7], v13 offset:33792
    v_mfma_f32_32x32x16_bf16 v[160:175], a[68:71], v[48:51], v[160:175]
    ds_read_b64_tr_b16 a[8:9], v14 offset:32768
    ds_read_b64_tr_b16 a[10:11], v14 offset:33792
    v_mfma_f32_32x32x16_bf16 v[176:191], a[72:75], v[48:51], v[176:191]
    ds_read_b64_tr_b16 a[12:13], v15 offset:32768
    ds_read_b64_tr_b16 a[14:15], v15 offset:33792
    v_mfma_f32_32x32x16_bf16 v[192:207], a[76:79], v[48:51], v[192:207]
    ds_read_b64_tr_b16 a[16:17], v12 offset:36864
    ds_read_b64_tr_b16 a[18:19], v12 offset:37888
    v_mfma_f32_32x32x16_bf16 v[144:159], a[80:83], v[52:55], v[144:159]
    ds_read_b64_tr_b16 a[20:21], v13 offset:36864
    ds_read_b64_tr_b16 a[22:23], v13 offset:37888
    v_mfma_f32_32x32x16_bf16 v[160:175], a[84:87], v[52:55], v[160:175]
    ds_read_b64_tr_b16 a[24:25], v14 offset:36864
    ds_read_b64_tr_b16 a[26:27], v14 offset:37888
    v_mfma_f32_32x32x16_bf16 v[176:191], a[88:91], v[52:55], v[176:191]
    ds_read_b64_tr_b16 a[28:29], v15 offset:36864
    ds_read_b64_tr_b16 a[30:31], v15 offset:37888
    v_mfma_f32_32x32x16_bf16 v[192:207], a[92:95], v[52:55], v[192:207]
    ds_read_b64_tr_b16 a[32:33], v12 offset:40960
    ds_read_b64_tr_b16 a[34:35], v12 offset:41984
    v_mfma_f32_32x32x16_bf16 v[144:159], a[96:99], v[56:59], v[144:159]
    ds_read_b64_tr_b16 a[36:37], v13 offset:40960
    ds_read_b64_tr_b16 a[38:39], v13 offset:41984
    v_mfma_f32_32x32x16_bf16 v[160:175], a[100:103], v[56:59], v[160:175]
    ds_read_b64_tr_b16 a[40:41], v14 offset:40960
    ds_read_b64_tr_b16 a[42:43], v14 offset:41984
    v_mfma_f32_32x32x16_bf16 v[176:191], a[104:107], v[56:59], v[176:191]
    ds_read_b64_tr_b16 a[44:45], v15 offset:40960
    ds_read_b64_tr_b16 a[46:47], v15 offset:41984
    v_mfma_f32_32x32x16_bf16 v[192:207], a[108:111], v[56:59], v[192:207]
    ds_read_b64_tr_b16 a[48:49], v12 offset:45056
    ds_read_b64_tr_b16 a[50:51], v12 offset:46080
    v_mfma_f32_32x32x16_bf16 v[144:159], a[112:115], v[60:63], v[144:159]
    ds_read_b64_tr_b16 a[52:53], v13 offset:45056
    ds_read_b64_tr_b16 a[54:55], v13 offset:46080
    v_mfma_f32_32x32x16_bf16 v[160:175], a[116:119], v[60:63], v[160:175]
    ds_read_b64_tr_b16 a[56:57], v14 offset:45056
    ds_read_b64_tr_b16 a[58:59], v14 offset:46080
    v_mfma_f32_32x32x16_bf16 v[176:191], a[120:123], v[60:63], v[176:191]
    ds_read_b64_tr_b16 a[60:61], v15 offset:45056
    ds_read_b64_tr_b16 a[62:63], v15 offset:46080
    v_mfma_f32_32x32x16_bf16 v[192:207], a[124:127], v[60:63], v[192:207]
    s_waitcnt vmcnt(24)
    s_waitcnt lgkmcnt(0)
    s_barrier
    ds_read_b64_tr_b16 a[64:65], v12 offset:49152
    ds_read_b64_tr_b16 a[66:67], v12 offset:50176
    v_mfma_f32_32x32x16_bf16 v[144:159], a[0:3], v[64:67], v[144:159]
    ds_read_b64_tr_b16 a[68:69], v13 offset:49152
    ds_read_b64_tr_b16 a[70:71], v13 offset:50176
    v_mfma_f32_32x32x16_bf16 v[160:175], a[4:7], v[64:67], v[160:175]
    ds_read_b64_tr_b16 a[72:73], v14 offset:49152
    ds_read_b64_tr_b16 a[74:75], v14 offset:50176
    v_mfma_f32_32x32x16_bf16 v[176:191], a[8:11], v[64:67], v[176:191]
    ds_read_b64_tr_b16 a[76:77], v15 offset:49152
    ds_read_b64_tr_b16 a[78:79], v15 offset:50176
    v_mfma_f32_32x32x16_bf16 v[192:207], a[12:15], v[64:67], v[192:207]
    ds_read_b64_tr_b16 a[80:81], v12 offset:53248
    ds_read_b64_tr_b16 a[82:83], v12 offset:54272
    v_mfma_f32_32x32x16_bf16 v[144:159], a[16:19], v[68:71], v[144:159]
    ds_read_b64_tr_b16 a[84:85], v13 offset:53248
    ds_read_b64_tr_b16 a[86:87], v13 offset:54272
    v_mfma_f32_32x32x16_bf16 v[160:175], a[20:23], v[68:71], v[160:175]
    ds_read_b64_tr_b16 a[88:89], v14 offset:53248
    ds_read_b64_tr_b16 a[90:91], v14 offset:54272
    v_mfma_f32_32x32x16_bf16 v[176:191], a[24:27], v[68:71], v[176:191]
    ds_read_b64_tr_b16 a[92:93], v15 offset:53248
    ds_read_b64_tr_b16 a[94:95], v15 offset:54272
    v_mfma_f32_32x32x16_bf16 v[192:207], a[28:31], v[68:71], v[192:207]
    ds_read_b64_tr_b16 a[96:97], v12 offset:57344
    ds_read_b64_tr_b16 a[98:99], v12 offset:58368
    v_mfma_f32_32x32x16_bf16 v[144:159], a[32:35], v[72:75], v[144:159]
    ds_read_b64_tr_b16 a[100:101], v13 offset:57344
    ds_read_b64_tr_b16 a[102:103], v13 offset:58368
    v_mfma_f32_32x32x16_bf16 v[160:175], a[36:39], v[72:75], v[160:175]
    ds_read_b64_tr_b16 a[104:105], v14 offset:57344
    ds_read_b64_tr_b16 a[106:107], v14 offset:58368
    v_mfma_f32_32x32x16_bf16 v[176:191], a[40:43], v[72:75], v[176:191]
    ds_read_b64_tr_b16 a[108:109], v15 offset:57344
    ds_read_b64_tr_b16 a[110:111], v15 offset:58368
    v_mfma_f32_32x32x16_bf16 v[192:207], a[44:47], v[72:75], v[192:207]
    ds_read_b64_tr_b16 a[112:113], v12 offset:61440
    ds_read_b64_tr_b16 a[114:115], v12 offset:62464
    v_mfma_f32_32x32x16_bf16 v[144:159], a[48:51], v[76:79], v[144:159]
    ds_read_b64_tr_b16 a[116:117], v13 offset:61440
    ds_read_b64_tr_b16 a[118:119], v13 offset:62464
    v_mfma_f32_32x32x16_bf16 v[160:175], a[52:55], v[76:79], v[160:175]
    ds_read_b64_tr_b16 a[120:121], v14 offset:61440
    ds_read_b64_tr_b16 a[122:123], v14 offset:62464
    v_mfma_f32_32x32x16_bf16 v[176:191], a[56:59], v[76:79], v[176:191]
    ds_read_b64_tr_b16 a[124:125], v15 offset:61440
    ds_read_b64_tr_b16 a[126:127], v15 offset:62464
    v_mfma_f32_32x32x16_bf16 v[192:207], a[60:63], v[76:79], v[192:207]
    s_waitcnt vmcnt(16)
    s_waitcnt lgkmcnt(0)
    s_barrier
    ds_read_b64_tr_b16 a[0:1], v16 offset:0
    ds_read_b64_tr_b16 a[2:3], v16 offset:1024
    v_mfma_f32_32x32x16_bf16 v[144:159], a[64:67], v[80:83], v[144:159]
    ds_read_b64_tr_b16 a[4:5], v17 offset:0
    ds_read_b64_tr_b16 a[6:7], v17 offset:1024
    v_mfma_f32_32x32x16_bf16 v[160:175], a[68:71], v[80:83], v[160:175]
    ds_read_b64_tr_b16 a[8:9], v18 offset:0
    ds_read_b64_tr_b16 a[10:11], v18 offset:1024
    v_mfma_f32_32x32x16_bf16 v[176:191], a[72:75], v[80:83], v[176:191]
    ds_read_b64_tr_b16 a[12:13], v19 offset:0
    ds_read_b64_tr_b16 a[14:15], v19 offset:1024
    v_mfma_f32_32x32x16_bf16 v[192:207], a[76:79], v[80:83], v[192:207]
    ds_read_b64_tr_b16 a[16:17], v16 offset:4096
    ds_read_b64_tr_b16 a[18:19], v16 offset:5120
    v_mfma_f32_32x32x16_bf16 v[144:159], a[80:83], v[84:87], v[144:159]
    ds_read_b64_tr_b16 a[20:21], v17 offset:4096
    ds_read_b64_tr_b16 a[22:23], v17 offset:5120
    v_mfma_f32_32x32x16_bf16 v[160:175], a[84:87], v[84:87], v[160:175]
    ds_read_b64_tr_b16 a[24:25], v18 offset:4096
    ds_read_b64_tr_b16 a[26:27], v18 offset:5120
    v_mfma_f32_32x32x16_bf16 v[176:191], a[88:91], v[84:87], v[176:191]
    ds_read_b64_tr_b16 a[28:29], v19 offset:4096
    ds_read_b64_tr_b16 a[30:31], v19 offset:5120
    v_mfma_f32_32x32x16_bf16 v[192:207], a[92:95], v[84:87], v[192:207]
    ds_read_b64_tr_b16 a[32:33], v16 offset:8192
    ds_read_b64_tr_b16 a[34:35], v16 offset:9216
    v_mfma_f32_32x32x16_bf16 v[144:159], a[96:99], v[88:91], v[144:159]
    ds_read_b64_tr_b16 a[36:37], v17 offset:8192
    ds_read_b64_tr_b16 a[38:39], v17 offset:9216
    v_mfma_f32_32x32x16_bf16 v[160:175], a[100:103], v[88:91], v[160:175]
    ds_read_b64_tr_b16 a[40:41], v18 offset:8192
    ds_read_b64_tr_b16 a[42:43], v18 offset:9216
    v_mfma_f32_32x32x16_bf16 v[176:191], a[104:107], v[88:91], v[176:191]
    ds_read_b64_tr_b16 a[44:45], v19 offset:8192
    ds_read_b64_tr_b16 a[46:47], v19 offset:9216
    v_mfma_f32_32x32x16_bf16 v[192:207], a[108:111], v[88:91], v[192:207]
    ds_read_b64_tr_b16 a[48:49], v16 offset:12288
    ds_read_b64_tr_b16 a[50:51], v16 offset:13312
    v_mfma_f32_32x32x16_bf16 v[144:159], a[112:115], v[92:95], v[144:159]
    ds_read_b64_tr_b16 a[52:53], v17 offset:12288
    ds_read_b64_tr_b16 a[54:55], v17 offset:13312
    v_mfma_f32_32x32x16_bf16 v[160:175], a[116:119], v[92:95], v[160:175]
    ds_read_b64_tr_b16 a[56:57], v18 offset:12288
    ds_read_b64_tr_b16 a[58:59], v18 offset:13312
    v_mfma_f32_32x32x16_bf16 v[176:191], a[120:123], v[92:95], v[176:191]
    ds_read_b64_tr_b16 a[60:61], v19 offset:12288
    ds_read_b64_tr_b16 a[62:63], v19 offset:13312
    v_mfma_f32_32x32x16_bf16 v[192:207], a[124:127], v[92:95], v[192:207]
    s_waitcnt vmcnt(8)
    s_waitcnt lgkmcnt(0)
    s_barrier
    ds_read_b64_tr_b16 a[64:65], v16 offset:16384
    ds_read_b64_tr_b16 a[66:67], v16 offset:17408
    v_mfma_f32_32x32x16_bf16 v[144:159], a[0:3], v[96:99], v[144:159]
    ds_read_b64_tr_b16 a[68:69], v17 offset:16384
    ds_read_b64_tr_b16 a[70:71], v17 offset:17408
    v_mfma_f32_32x32x16_bf16 v[160:175], a[4:7], v[96:99], v[160:175]
    ds_read_b64_tr_b16 a[72:73], v18 offset:16384
    ds_read_b64_tr_b16 a[74:75], v18 offset:17408
    v_mfma_f32_32x32x16_bf16 v[176:191], a[8:11], v[96:99], v[176:191]
    ds_read_b64_tr_b16 a[76:77], v19 offset:16384
    ds_read_b64_tr_b16 a[78:79], v19 offset:17408
    v_mfma_f32_32x32x16_bf16 v[192:207], a[12:15], v[96:99], v[192:207]
    ds_read_b64_tr_b16 a[80:81], v16 offset:20480
    ds_read_b64_tr_b16 a[82:83], v16 offset:21504
    v_mfma_f32_32x32x16_bf16 v[144:159], a[16:19], v[100:103], v[144:159]
    ds_read_b64_tr_b16 a[84:85], v17 offset:20480
    ds_read_b64_tr_b16 a[86:87], v17 offset:21504
    v_mfma_f32_32x32x16_bf16 v[160:175], a[20:23], v[100:103], v[160:175]
    ds_read_b64_tr_b16 a[88:89], v18 offset:20480
    ds_read_b64_tr_b16 a[90:91], v18 offset:21504
    v_mfma_f32_32x32x16_bf16 v[176:191], a[24:27], v[100:103], v[176:191]
    ds_read_b64_tr_b16 a[92:93], v19 offset:20480
    ds_read_b64_tr_b16 a[94:95], v19 offset:21504
    v_mfma_f32_32x32x16_bf16 v[192:207], a[28:31], v[100:103], v[192:207]
    ds_read_b64_tr_b16 a[96:97], v16 offset:24576
    ds_read_b64_tr_b16 a[98:99], v16 offset:25600
    v_mfma_f32_32x32x16_bf16 v[144:159], a[32:35], v[104:107], v[144:159]
    ds_read_b64_tr_b16 a[100:101], v17 offset:24576
    ds_read_b64_tr_b16 a[102:103], v17 offset:25600
    v_mfma_f32_32x32x16_bf16 v[160:175], a[36:39], v[104:107], v[160:175]
    ds_read_b64_tr_b16 a[104:105], v18 offset:24576
    ds_read_b64_tr_b16 a[106:107], v18 offset:25600
    v_mfma_f32_32x32x16_bf16 v[176:191], a[40:43], v[104:107], v[176:191]
    ds_read_b64_tr_b16 a[108:109], v19 offset:24576
    ds_read_b64_tr_b16 a[110:111], v19 offset:25600
    v_mfma_f32_32x32x16_bf16 v[192:207], a[44:47], v[104:107], v[192:207]
    ds_read_b64_tr_b16 a[112:113], v16 offset:28672
    ds_read_b64_tr_b16 a[114:115], v16 offset:29696
    v_mfma_f32_32x32x16_bf16 v[144:159], a[48:51], v[108:111], v[144:159]
    ds_read_b64_tr_b16 a[116:117], v17 offset:28672
    ds_read_b64_tr_b16 a[118:119], v17 offset:29696
    v_mfma_f32_32x32x16_bf16 v[160:175], a[52:55], v[108:111], v[160:175]
    ds_read_b64_tr_b16 a[120:121], v18 offset:28672
    ds_read_b64_tr_b16 a[122:123], v18 offset:29696
    v_mfma_f32_32x32x16_bf16 v[176:191], a[56:59], v[108:111], v[176:191]
    ds_read_b64_tr_b16 a[124:125], v19 offset:28672
    ds_read_b64_tr_b16 a[126:127], v19 offset:29696
    v_mfma_f32_32x32x16_bf16 v[192:207], a[60:63], v[108:111], v[192:207]
    s_waitcnt vmcnt(0)
    s_waitcnt lgkmcnt(0)
    s_barrier
    ds_read_b64_tr_b16 a[0:1], v16 offset:32768
    ds_read_b64_tr_b16 a[2:3], v16 offset:33792
    v_mfma_f32_32x32x16_bf16 v[144:159], a[64:67], v[112:115], v[144:159]
    ds_read_b64_tr_b16 a[4:5], v17 offset:32768
    ds_read_b64_tr_b16 a[6:7], v17 offset:33792
    v_mfma_f32_32x32x16_bf16 v[160:175], a[68:71], v[112:115], v[160:175]
    ds_read_b64_tr_b16 a[8:9], v18 offset:32768
    ds_read_b64_tr_b16 a[10:11], v18 offset:33792
    v_mfma_f32_32x32x16_bf16 v[176:191], a[72:75], v[112:115], v[176:191]
    ds_read_b64_tr_b16 a[12:13], v19 offset:32768
    ds_read_b64_tr_b16 a[14:15], v19 offset:33792
    v_mfma_f32_32x32x16_bf16 v[192:207], a[76:79], v[112:115], v[192:207]
    ds_read_b64_tr_b16 a[16:17], v16 offset:36864
    ds_read_b64_tr_b16 a[18:19], v16 offset:37888
    v_mfma_f32_32x32x16_bf16 v[144:159], a[80:83], v[116:119], v[144:159]
    ds_read_b64_tr_b16 a[20:21], v17 offset:36864
    ds_read_b64_tr_b16 a[22:23], v17 offset:37888
    v_mfma_f32_32x32x16_bf16 v[160:175], a[84:87], v[116:119], v[160:175]
    ds_read_b64_tr_b16 a[24:25], v18 offset:36864
    ds_read_b64_tr_b16 a[26:27], v18 offset:37888
    v_mfma_f32_32x32x16_bf16 v[176:191], a[88:91], v[116:119], v[176:191]
    ds_read_b64_tr_b16 a[28:29], v19 offset:36864
    ds_read_b64_tr_b16 a[30:31], v19 offset:37888
    v_mfma_f32_32x32x16_bf16 v[192:207], a[92:95], v[116:119], v[192:207]
    ds_read_b64_tr_b16 a[32:33], v16 offset:40960
    ds_read_b64_tr_b16 a[34:35], v16 offset:41984
    v_mfma_f32_32x32x16_bf16 v[144:159], a[96:99], v[120:123], v[144:159]
    ds_read_b64_tr_b16 a[36:37], v17 offset:40960
    ds_read_b64_tr_b16 a[38:39], v17 offset:41984
    v_mfma_f32_32x32x16_bf16 v[160:175], a[100:103], v[120:123], v[160:175]
    ds_read_b64_tr_b16 a[40:41], v18 offset:40960
    ds_read_b64_tr_b16 a[42:43], v18 offset:41984
    v_mfma_f32_32x32x16_bf16 v[176:191], a[104:107], v[120:123], v[176:191]
    ds_read_b64_tr_b16 a[44:45], v19 offset:40960
    ds_read_b64_tr_b16 a[46:47], v19 offset:41984
    v_mfma_f32_32x32x16_bf16 v[192:207], a[108:111], v[120:123], v[192:207]
    ds_read_b64_tr_b16 a[48:49], v16 offset:45056
    ds_read_b64_tr_b16 a[50:51], v16 offset:46080
    v_mfma_f32_32x32x16_bf16 v[144:159], a[112:115], v[124:127], v[144:159]
    ds_read_b64_tr_b16 a[52:53], v17 offset:45056
    ds_read_b64_tr_b16 a[54:55], v17 offset:46080
    v_mfma_f32_32x32x16_bf16 v[160:175], a[116:119], v[124:127], v[160:175]
    ds_read_b64_tr_b16 a[56:57], v18 offset:45056
    ds_read_b64_tr_b16 a[58:59], v18 offset:46080
    v_mfma_f32_32x32x16_bf16 v[176:191], a[120:123], v[124:127], v[176:191]
    ds_read_b64_tr_b16 a[60:61], v19 offset:45056
    ds_read_b64_tr_b16 a[62:63], v19 offset:46080
    v_mfma_f32_32x32x16_bf16 v[192:207], a[124:127], v[124:127], v[192:207]
    s_waitcnt lgkmcnt(0)
    s_nop 1
    v_mfma_f32_32x32x16_bf16 v[144:159], a[0:3], v[128:131], v[144:159]
    v_mfma_f32_32x32x16_bf16 v[160:175], a[4:7], v[128:131], v[160:175]
    v_mfma_f32_32x32x16_bf16 v[176:191], a[8:11], v[128:131], v[176:191]
    v_mfma_f32_32x32x16_bf16 v[192:207], a[12:15], v[128:131], v[192:207]
    v_mfma_f32_32x32x16_bf16 v[144:159], a[16:19], v[132:135], v[144:159]
    v_mfma_f32_32x32x16_bf16 v[160:175], a[20:23], v[132:135], v[160:175]
    v_mfma_f32_32x32x16_bf16 v[176:191], a[24:27], v[132:135], v[176:191]
    v_mfma_f32_32x32x16_bf16 v[192:207], a[28:31], v[132:135], v[192:207]
    v_mfma_f32_32x32x16_bf16 v[144:159], a[32:35], v[136:139], v[144:159]
    v_mfma_f32_32x32x16_bf16 v[160:175], a[36:39], v[136:139], v[160:175]
    v_mfma_f32_32x32x16_bf16 v[176:191], a[40:43], v[136:139], v[176:191]
    v_mfma_f32_32x32x16_bf16 v[192:207], a[44:47], v[136:139], v[192:207]
    v_mfma_f32_32x32x16_bf16 v[144:159], a[48:51], v[140:143], v[144:159]
    v_mfma_f32_32x32x16_bf16 v[160:175], a[52:55], v[140:143], v[160:175]
    v_mfma_f32_32x32x16_bf16 v[176:191], a[56:59], v[140:143], v[176:191]
    v_mfma_f32_32x32x16_bf16 v[192:207], a[60:63], v[140:143], v[192:207]
    s_nop 15
    s_nop 3
    v_cvt_pk_bf16_f32 v144, v144, v144
    v_and_b32 v144, 0xffff0000, v144
    v_cvt_pk_bf16_f32 v145, v145, v145
    v_and_b32 v145, 0xffff0000, v145
    v_mul_f32 v208, v144, v144
    v_mov_b32 v209, 1.0
    v_mul_f32 v210, v145, v145
    v_mov_b32 v211, 1.0
    v_fmac_f32 v209, 0x3d372713, v208
    v_fmac_f32 v211, 0x3d372713, v210
    v_mul_f32 v208, v209, v144
    v_mul_f32 v210, v211, v145
    v_mul_f32 v208, 0xc0135761, v208
    v_mul_f32 v210, 0xc0135761, v210
    v_exp_f32 v208, v208
    v_exp_f32 v210, v210
    v_add_f32 v208, 1.0, v208
    v_add_f32 v210, 1.0, v210
    v_rcp_f32 v208, v208
    v_rcp_f32 v210, v210
    v_mul_f32 v144, v144, v208
    v_mul_f32 v145, v145, v210
    v_cvt_pk_bf16_f32 v146, v146, v146
    v_and_b32 v146, 0xffff0000, v146
    v_cvt_pk_bf16_f32 v147, v147, v147
    v_and_b32 v147, 0xffff0000, v147
    v_mul_f32 v208, v146, v146
    v_mov_b32 v209, 1.0
    v_mul_f32 v210, v147, v147
    v_mov_b32 v211, 1.0
    v_fmac_f32 v209, 0x3d372713, v208
    v_fmac_f32 v211, 0x3d372713, v210
    v_mul_f32 v208, v209, v146
    v_mul_f32 v210, v211, v147
    v_mul_f32 v208, 0xc0135761, v208
    v_mul_f32 v210, 0xc0135761, v210
    v_exp_f32 v208, v208
    v_exp_f32 v210, v210
    v_add_f32 v208, 1.0, v208
    v_add_f32 v210, 1.0, v210
    v_rcp_f32 v208, v208
    v_rcp_f32 v210, v210
    v_mul_f32 v146, v146, v208
    v_mul_f32 v147, v147, v210
    v_cvt_pk_bf16_f32 v148, v148, v148
    v_and_b32 v148, 0xffff0000, v148
    v_cvt_pk_bf16_f32 v149, v149, v149
    v_and_b32 v149, 0xffff0000, v149
    v_mul_f32 v208, v148, v148
    v_mov_b32 v209, 1.0
    v_mul_f32 v210, v149, v149
    v_mov_b32 v211, 1.0
    v_fmac_f32 v209, 0x3d372713, v208
    v_fmac_f32 v211, 0x3d372713, v210
    v_mul_f32 v208, v209, v148
    v_mul_f32 v210, v211, v149
    v_mul_f32 v208, 0xc0135761, v208
    v_mul_f32 v210, 0xc0135761, v210
    v_exp_f32 v208, v208
    v_exp_f32 v210, v210
    v_add_f32 v208, 1.0, v208
    v_add_f32 v210, 1.0, v210
    v_rcp_f32 v208, v208
    v_rcp_f32 v210, v210
    v_mul_f32 v148, v148, v208
    v_mul_f32 v149, v149, v210
    v_cvt_pk_bf16_f32 v150, v150, v150
    v_and_b32 v150, 0xffff0000, v150
    v_cvt_pk_bf16_f32 v151, v151, v151
    v_and_b32 v151, 0xffff0000, v151
    v_mul_f32 v208, v150, v150
    v_mov_b32 v209, 1.0
    v_mul_f32 v210, v151, v151
    v_mov_b32 v211, 1.0
    v_fmac_f32 v209, 0x3d372713, v208
    v_fmac_f32 v211, 0x3d372713, v210
    v_mul_f32 v208, v209, v150
    v_mul_f32 v210, v211, v151
    v_mul_f32 v208, 0xc0135761, v208
    v_mul_f32 v210, 0xc0135761, v210
    v_exp_f32 v208, v208
    v_exp_f32 v210, v210
    v_add_f32 v208, 1.0, v208
    v_add_f32 v210, 1.0, v210
    v_rcp_f32 v208, v208
    v_rcp_f32 v210, v210
    v_mul_f32 v150, v150, v208
    v_mul_f32 v151, v151, v210
    v_cvt_pk_bf16_f32 v152, v152, v152
    v_and_b32 v152, 0xffff0000, v152
    v_cvt_pk_bf16_f32 v153, v153, v153
    v_and_b32 v153, 0xffff0000, v153
    v_mul_f32 v208, v152, v152
    v_mov_b32 v209, 1.0
    v_mul_f32 v210, v153, v153
    v_mov_b32 v211, 1.0
    v_fmac_f32 v209, 0x3d372713, v208
    v_fmac_f32 v211, 0x3d372713, v210
    v_mul_f32 v208, v209, v152
    v_mul_f32 v210, v211, v153
    v_mul_f32 v208, 0xc0135761, v208
    v_mul_f32 v210, 0xc0135761, v210
    v_exp_f32 v208, v208
    v_exp_f32 v210, v210
    v_add_f32 v208, 1.0, v208
    v_add_f32 v210, 1.0, v210
    v_rcp_f32 v208, v208
    v_rcp_f32 v210, v210
    v_mul_f32 v152, v152, v208
    v_mul_f32 v153, v153, v210
    v_cvt_pk_bf16_f32 v154, v154, v154
    v_and_b32 v154, 0xffff0000, v154
    v_cvt_pk_bf16_f32 v155, v155, v155
    v_and_b32 v155, 0xffff0000, v155
    v_mul_f32 v208, v154, v154
    v_mov_b32 v209, 1.0
    v_mul_f32 v210, v155, v155
    v_mov_b32 v211, 1.0
    v_fmac_f32 v209, 0x3d372713, v208
    v_fmac_f32 v211, 0x3d372713, v210
    v_mul_f32 v208, v209, v154
    v_mul_f32 v210, v211, v155
    v_mul_f32 v208, 0xc0135761, v208
    v_mul_f32 v210, 0xc0135761, v210
    v_exp_f32 v208, v208
    v_exp_f32 v210, v210
    v_add_f32 v208, 1.0, v208
    v_add_f32 v210, 1.0, v210
    v_rcp_f32 v208, v208
    v_rcp_f32 v210, v210
    v_mul_f32 v154, v154, v208
    v_mul_f32 v155, v155, v210
    v_cvt_pk_bf16_f32 v156, v156, v156
    v_and_b32 v156, 0xffff0000, v156
    v_cvt_pk_bf16_f32 v157, v157, v157
    v_and_b32 v157, 0xffff0000, v157
    v_mul_f32 v208, v156, v156
    v_mov_b32 v209, 1.0
    v_mul_f32 v210, v157, v157
    v_mov_b32 v211, 1.0
    v_fmac_f32 v209, 0x3d372713, v208
    v_fmac_f32 v211, 0x3d372713, v210
    v_mul_f32 v208, v209, v156
    v_mul_f32 v210, v211, v157
    v_mul_f32 v208, 0xc0135761, v208
    v_mul_f32 v210, 0xc0135761, v210
    v_exp_f32 v208, v208
    v_exp_f32 v210, v210
    v_add_f32 v208, 1.0, v208
    v_add_f32 v210, 1.0, v210
    v_rcp_f32 v208, v208
    v_rcp_f32 v210, v210
    v_mul_f32 v156, v156, v208
    v_mul_f32 v157, v157, v210
    v_cvt_pk_bf16_f32 v158, v158, v158
    v_and_b32 v158, 0xffff0000, v158
    v_cvt_pk_bf16_f32 v159, v159, v159
    v_and_b32 v159, 0xffff0000, v159
    v_mul_f32 v208, v158, v158
    v_mov_b32 v209, 1.0
    v_mul_f32 v210, v159, v159
    v_mov_b32 v211, 1.0
    v_fmac_f32 v209, 0x3d372713, v208
    v_fmac_f32 v211, 0x3d372713, v210
    v_mul_f32 v208, v209, v158
    v_mul_f32 v210, v211, v159
    v_mul_f32 v208, 0xc0135761, v208
    v_mul_f32 v210, 0xc0135761, v210
    v_exp_f32 v208, v208
    v_exp_f32 v210, v210
    v_add_f32 v208, 1.0, v208
    v_add_f32 v210, 1.0, v210
    v_rcp_f32 v208, v208
    v_rcp_f32 v210, v210
    v_mul_f32 v158, v158, v208
    v_mul_f32 v159, v159, v210
    v_cvt_pk_bf16_f32 v160, v160, v160
    v_and_b32 v160, 0xffff0000, v160
    v_cvt_pk_bf16_f32 v161, v161, v161
    v_and_b32 v161, 0xffff0000, v161
    v_mul_f32 v208, v160, v160
    v_mov_b32 v209, 1.0
    v_mul_f32 v210, v161, v161
    v_mov_b32 v211, 1.0
    v_fmac_f32 v209, 0x3d372713, v208
    v_fmac_f32 v211, 0x3d372713, v210
    v_mul_f32 v208, v209, v160
    v_mul_f32 v210, v211, v161
    v_mul_f32 v208, 0xc0135761, v208
    v_mul_f32 v210, 0xc0135761, v210
    v_exp_f32 v208, v208
    v_exp_f32 v210, v210
    v_add_f32 v208, 1.0, v208
    v_add_f32 v210, 1.0, v210
    v_rcp_f32 v208, v208
    v_rcp_f32 v210, v210
    v_mul_f32 v160, v160, v208
    v_mul_f32 v161, v161, v210
    v_cvt_pk_bf16_f32 v162, v162, v162
    v_and_b32 v162, 0xffff0000, v162
    v_cvt_pk_bf16_f32 v163, v163, v163
    v_and_b32 v163, 0xffff0000, v163
    v_mul_f32 v208, v162, v162
    v_mov_b32 v209, 1.0
    v_mul_f32 v210, v163, v163
    v_mov_b32 v211, 1.0
    v_fmac_f32 v209, 0x3d372713, v208
    v_fmac_f32 v211, 0x3d372713, v210
    v_mul_f32 v208, v209, v162
    v_mul_f32 v210, v211, v163
    v_mul_f32 v208, 0xc0135761, v208
    v_mul_f32 v210, 0xc0135761, v210
    v_exp_f32 v208, v208
    v_exp_f32 v210, v210
    v_add_f32 v208, 1.0, v208
    v_add_f32 v210, 1.0, v210
    v_rcp_f32 v208, v208
    v_rcp_f32 v210, v210
    v_mul_f32 v162, v162, v208
    v_mul_f32 v163, v163, v210
    v_cvt_pk_bf16_f32 v164, v164, v164
    v_and_b32 v164, 0xffff0000, v164
    v_cvt_pk_bf16_f32 v165, v165, v165
    v_and_b32 v165, 0xffff0000, v165
    v_mul_f32 v208, v164, v164
    v_mov_b32 v209, 1.0
    v_mul_f32 v210, v165, v165
    v_mov_b32 v211, 1.0
    v_fmac_f32 v209, 0x3d372713, v208
    v_fmac_f32 v211, 0x3d372713, v210
    v_mul_f32 v208, v209, v164
    v_mul_f32 v210, v211, v165
    v_mul_f32 v208, 0xc0135761, v208
    v_mul_f32 v210, 0xc0135761, v210
    v_exp_f32 v208, v208
    v_exp_f32 v210, v210
    v_add_f32 v208, 1.0, v208
    v_add_f32 v210, 1.0, v210
    v_rcp_f32 v208, v208
    v_rcp_f32 v210, v210
    v_mul_f32 v164, v164, v208
    v_mul_f32 v165, v165, v210
    v_cvt_pk_bf16_f32 v166, v166, v166
    v_and_b32 v166, 0xffff0000, v166
    v_cvt_pk_bf16_f32 v167, v167, v167
    v_and_b32 v167, 0xffff0000, v167
    v_mul_f32 v208, v166, v166
    v_mov_b32 v209, 1.0
    v_mul_f32 v210, v167, v167
    v_mov_b32 v211, 1.0
    v_fmac_f32 v209, 0x3d372713, v208
    v_fmac_f32 v211, 0x3d372713, v210
    v_mul_f32 v208, v209, v166
    v_mul_f32 v210, v211, v167
    v_mul_f32 v208, 0xc0135761, v208
    v_mul_f32 v210, 0xc0135761, v210
    v_exp_f32 v208, v208
    v_exp_f32 v210, v210
    v_add_f32 v208, 1.0, v208
    v_add_f32 v210, 1.0, v210
    v_rcp_f32 v208, v208
    v_rcp_f32 v210, v210
    v_mul_f32 v166, v166, v208
    v_mul_f32 v167, v167, v210
    v_cvt_pk_bf16_f32 v168, v168, v168
    v_and_b32 v168, 0xffff0000, v168
    v_cvt_pk_bf16_f32 v169, v169, v169
    v_and_b32 v169, 0xffff0000, v169
    v_mul_f32 v208, v168, v168
    v_mov_b32 v209, 1.0
    v_mul_f32 v210, v169, v169
    v_mov_b32 v211, 1.0
    v_fmac_f32 v209, 0x3d372713, v208
    v_fmac_f32 v211, 0x3d372713, v210
    v_mul_f32 v208, v209, v168
    v_mul_f32 v210, v211, v169
    v_mul_f32 v208, 0xc0135761, v208
    v_mul_f32 v210, 0xc0135761, v210
    v_exp_f32 v208, v208
    v_exp_f32 v210, v210
    v_add_f32 v208, 1.0, v208
    v_add_f32 v210, 1.0, v210
    v_rcp_f32 v208, v208
    v_rcp_f32 v210, v210
    v_mul_f32 v168, v168, v208
    v_mul_f32 v169, v169, v210
    v_cvt_pk_bf16_f32 v170, v170, v170
    v_and_b32 v170, 0xffff0000, v170
    v_cvt_pk_bf16_f32 v171, v171, v171
    v_and_b32 v171, 0xffff0000, v171
    v_mul_f32 v208, v170, v170
    v_mov_b32 v209, 1.0
    v_mul_f32 v210, v171, v171
    v_mov_b32 v211, 1.0
    v_fmac_f32 v209, 0x3d372713, v208
    v_fmac_f32 v211, 0x3d372713, v210
    v_mul_f32 v208, v209, v170
    v_mul_f32 v210, v211, v171
    v_mul_f32 v208, 0xc0135761, v208
    v_mul_f32 v210, 0xc0135761, v210
    v_exp_f32 v208, v208
    v_exp_f32 v210, v210
    v_add_f32 v208, 1.0, v208
    v_add_f32 v210, 1.0, v210
    v_rcp_f32 v208, v208
    v_rcp_f32 v210, v210
    v_mul_f32 v170, v170, v208
    v_mul_f32 v171, v171, v210
    v_cvt_pk_bf16_f32 v172, v172, v172
    v_and_b32 v172, 0xffff0000, v172
    v_cvt_pk_bf16_f32 v173, v173, v173
    v_and_b32 v173, 0xffff0000, v173
    v_mul_f32 v208, v172, v172
    v_mov_b32 v209, 1.0
    v_mul_f32 v210, v173, v173
    v_mov_b32 v211, 1.0
    v_fmac_f32 v209, 0x3d372713, v208
    v_fmac_f32 v211, 0x3d372713, v210
    v_mul_f32 v208, v209, v172
    v_mul_f32 v210, v211, v173
    v_mul_f32 v208, 0xc0135761, v208
    v_mul_f32 v210, 0xc0135761, v210
    v_exp_f32 v208, v208
    v_exp_f32 v210, v210
    v_add_f32 v208, 1.0, v208
    v_add_f32 v210, 1.0, v210
    v_rcp_f32 v208, v208
    v_rcp_f32 v210, v210
    v_mul_f32 v172, v172, v208
    v_mul_f32 v173, v173, v210
    v_cvt_pk_bf16_f32 v174, v174, v174
    v_and_b32 v174, 0xffff0000, v174
    v_cvt_pk_bf16_f32 v175, v175, v175
    v_and_b32 v175, 0xffff0000, v175
    v_mul_f32 v208, v174, v174
    v_mov_b32 v209, 1.0
    v_mul_f32 v210, v175, v175
    v_mov_b32 v211, 1.0
    v_fmac_f32 v209, 0x3d372713, v208
    v_fmac_f32 v211, 0x3d372713, v210
    v_mul_f32 v208, v209, v174
    v_mul_f32 v210, v211, v175
    v_mul_f32 v208, 0xc0135761, v208
    v_mul_f32 v210, 0xc0135761, v210
    v_exp_f32 v208, v208
    v_exp_f32 v210, v210
    v_add_f32 v208, 1.0, v208
    v_add_f32 v210, 1.0, v210
    v_rcp_f32 v208, v208
    v_rcp_f32 v210, v210
    v_mul_f32 v174, v174, v208
    v_mul_f32 v175, v175, v210
    v_cvt_pk_bf16_f32 v176, v176, v176
    v_and_b32 v176, 0xffff0000, v176
    v_cvt_pk_bf16_f32 v177, v177, v177
    v_and_b32 v177, 0xffff0000, v177
    v_mul_f32 v208, v176, v176
    v_mov_b32 v209, 1.0
    v_mul_f32 v210, v177, v177
    v_mov_b32 v211, 1.0
    v_fmac_f32 v209, 0x3d372713, v208
    v_fmac_f32 v211, 0x3d372713, v210
    v_mul_f32 v208, v209, v176
    v_mul_f32 v210, v211, v177
    v_mul_f32 v208, 0xc0135761, v208
    v_mul_f32 v210, 0xc0135761, v210
    v_exp_f32 v208, v208
    v_exp_f32 v210, v210
    v_add_f32 v208, 1.0, v208
    v_add_f32 v210, 1.0, v210
    v_rcp_f32 v208, v208
    v_rcp_f32 v210, v210
    v_mul_f32 v176, v176, v208
    v_mul_f32 v177, v177, v210
    v_cvt_pk_bf16_f32 v178, v178, v178
    v_and_b32 v178, 0xffff0000, v178
    v_cvt_pk_bf16_f32 v179, v179, v179
    v_and_b32 v179, 0xffff0000, v179
    v_mul_f32 v208, v178, v178
    v_mov_b32 v209, 1.0
    v_mul_f32 v210, v179, v179
    v_mov_b32 v211, 1.0
    v_fmac_f32 v209, 0x3d372713, v208
    v_fmac_f32 v211, 0x3d372713, v210
    v_mul_f32 v208, v209, v178
    v_mul_f32 v210, v211, v179
    v_mul_f32 v208, 0xc0135761, v208
    v_mul_f32 v210, 0xc0135761, v210
    v_exp_f32 v208, v208
    v_exp_f32 v210, v210
    v_add_f32 v208, 1.0, v208
    v_add_f32 v210, 1.0, v210
    v_rcp_f32 v208, v208
    v_rcp_f32 v210, v210
    v_mul_f32 v178, v178, v208
    v_mul_f32 v179, v179, v210
    v_cvt_pk_bf16_f32 v180, v180, v180
    v_and_b32 v180, 0xffff0000, v180
    v_cvt_pk_bf16_f32 v181, v181, v181
    v_and_b32 v181, 0xffff0000, v181
    v_mul_f32 v208, v180, v180
    v_mov_b32 v209, 1.0
    v_mul_f32 v210, v181, v181
    v_mov_b32 v211, 1.0
    v_fmac_f32 v209, 0x3d372713, v208
    v_fmac_f32 v211, 0x3d372713, v210
    v_mul_f32 v208, v209, v180
    v_mul_f32 v210, v211, v181
    v_mul_f32 v208, 0xc0135761, v208
    v_mul_f32 v210, 0xc0135761, v210
    v_exp_f32 v208, v208
    v_exp_f32 v210, v210
    v_add_f32 v208, 1.0, v208
    v_add_f32 v210, 1.0, v210
    v_rcp_f32 v208, v208
    v_rcp_f32 v210, v210
    v_mul_f32 v180, v180, v208
    v_mul_f32 v181, v181, v210
    v_cvt_pk_bf16_f32 v182, v182, v182
    v_and_b32 v182, 0xffff0000, v182
    v_cvt_pk_bf16_f32 v183, v183, v183
    v_and_b32 v183, 0xffff0000, v183
    v_mul_f32 v208, v182, v182
    v_mov_b32 v209, 1.0
    v_mul_f32 v210, v183, v183
    v_mov_b32 v211, 1.0
    v_fmac_f32 v209, 0x3d372713, v208
    v_fmac_f32 v211, 0x3d372713, v210
    v_mul_f32 v208, v209, v182
    v_mul_f32 v210, v211, v183
    v_mul_f32 v208, 0xc0135761, v208
    v_mul_f32 v210, 0xc0135761, v210
    v_exp_f32 v208, v208
    v_exp_f32 v210, v210
    v_add_f32 v208, 1.0, v208
    v_add_f32 v210, 1.0, v210
    v_rcp_f32 v208, v208
    v_rcp_f32 v210, v210
    v_mul_f32 v182, v182, v208
    v_mul_f32 v183, v183, v210
    v_cvt_pk_bf16_f32 v184, v184, v184
    v_and_b32 v184, 0xffff0000, v184
    v_cvt_pk_bf16_f32 v185, v185, v185
    v_and_b32 v185, 0xffff0000, v185
    v_mul_f32 v208, v184, v184
    v_mov_b32 v209, 1.0
    v_mul_f32 v210, v185, v185
    v_mov_b32 v211, 1.0
    v_fmac_f32 v209, 0x3d372713, v208
    v_fmac_f32 v211, 0x3d372713, v210
    v_mul_f32 v208, v209, v184
    v_mul_f32 v210, v211, v185
    v_mul_f32 v208, 0xc0135761, v208
    v_mul_f32 v210, 0xc0135761, v210
    v_exp_f32 v208, v208
    v_exp_f32 v210, v210
    v_add_f32 v208, 1.0, v208
    v_add_f32 v210, 1.0, v210
    v_rcp_f32 v208, v208
    v_rcp_f32 v210, v210
    v_mul_f32 v184, v184, v208
    v_mul_f32 v185, v185, v210
    v_cvt_pk_bf16_f32 v186, v186, v186
    v_and_b32 v186, 0xffff0000, v186
    v_cvt_pk_bf16_f32 v187, v187, v187
    v_and_b32 v187, 0xffff0000, v187
    v_mul_f32 v208, v186, v186
    v_mov_b32 v209, 1.0
    v_mul_f32 v210, v187, v187
    v_mov_b32 v211, 1.0
    v_fmac_f32 v209, 0x3d372713, v208
    v_fmac_f32 v211, 0x3d372713, v210
    v_mul_f32 v208, v209, v186
    v_mul_f32 v210, v211, v187
    v_mul_f32 v208, 0xc0135761, v208
    v_mul_f32 v210, 0xc0135761, v210
    v_exp_f32 v208, v208
    v_exp_f32 v210, v210
    v_add_f32 v208, 1.0, v208
    v_add_f32 v210, 1.0, v210
    v_rcp_f32 v208, v208
    v_rcp_f32 v210, v210
    v_mul_f32 v186, v186, v208
    v_mul_f32 v187, v187, v210
    v_cvt_pk_bf16_f32 v188, v188, v188
    v_and_b32 v188, 0xffff0000, v188
    v_cvt_pk_bf16_f32 v189, v189, v189
    v_and_b32 v189, 0xffff0000, v189
    v_mul_f32 v208, v188, v188
    v_mov_b32 v209, 1.0
    v_mul_f32 v210, v189, v189
    v_mov_b32 v211, 1.0
    v_fmac_f32 v209, 0x3d372713, v208
    v_fmac_f32 v211, 0x3d372713, v210
    v_mul_f32 v208, v209, v188
    v_mul_f32 v210, v211, v189
    v_mul_f32 v208, 0xc0135761, v208
    v_mul_f32 v210, 0xc0135761, v210
    v_exp_f32 v208, v208
    v_exp_f32 v210, v210
    v_add_f32 v208, 1.0, v208
    v_add_f32 v210, 1.0, v210
    v_rcp_f32 v208, v208
    v_rcp_f32 v210, v210
    v_mul_f32 v188, v188, v208
    v_mul_f32 v189, v189, v210
    v_cvt_pk_bf16_f32 v190, v190, v190
    v_and_b32 v190, 0xffff0000, v190
    v_cvt_pk_bf16_f32 v191, v191, v191
    v_and_b32 v191, 0xffff0000, v191
    v_mul_f32 v208, v190, v190
    v_mov_b32 v209, 1.0
    v_mul_f32 v210, v191, v191
    v_mov_b32 v211, 1.0
    v_fmac_f32 v209, 0x3d372713, v208
    v_fmac_f32 v211, 0x3d372713, v210
    v_mul_f32 v208, v209, v190
    v_mul_f32 v210, v211, v191
    v_mul_f32 v208, 0xc0135761, v208
    v_mul_f32 v210, 0xc0135761, v210
    v_exp_f32 v208, v208
    v_exp_f32 v210, v210
    v_add_f32 v208, 1.0, v208
    v_add_f32 v210, 1.0, v210
    v_rcp_f32 v208, v208
    v_rcp_f32 v210, v210
    v_mul_f32 v190, v190, v208
    v_mul_f32 v191, v191, v210
    v_cvt_pk_bf16_f32 v192, v192, v192
    v_and_b32 v192, 0xffff0000, v192
    v_cvt_pk_bf16_f32 v193, v193, v193
    v_and_b32 v193, 0xffff0000, v193
    v_mul_f32 v208, v192, v192
    v_mov_b32 v209, 1.0
    v_mul_f32 v210, v193, v193
    v_mov_b32 v211, 1.0
    v_fmac_f32 v209, 0x3d372713, v208
    v_fmac_f32 v211, 0x3d372713, v210
    v_mul_f32 v208, v209, v192
    v_mul_f32 v210, v211, v193
    v_mul_f32 v208, 0xc0135761, v208
    v_mul_f32 v210, 0xc0135761, v210
    v_exp_f32 v208, v208
    v_exp_f32 v210, v210
    v_add_f32 v208, 1.0, v208
    v_add_f32 v210, 1.0, v210
    v_rcp_f32 v208, v208
    v_rcp_f32 v210, v210
    v_mul_f32 v192, v192, v208
    v_mul_f32 v193, v193, v210
    v_cvt_pk_bf16_f32 v194, v194, v194
    v_and_b32 v194, 0xffff0000, v194
    v_cvt_pk_bf16_f32 v195, v195, v195
    v_and_b32 v195, 0xffff0000, v195
    v_mul_f32 v208, v194, v194
    v_mov_b32 v209, 1.0
    v_mul_f32 v210, v195, v195
    v_mov_b32 v211, 1.0
    v_fmac_f32 v209, 0x3d372713, v208
    v_fmac_f32 v211, 0x3d372713, v210
    v_mul_f32 v208, v209, v194
    v_mul_f32 v210, v211, v195
    v_mul_f32 v208, 0xc0135761, v208
    v_mul_f32 v210, 0xc0135761, v210
    v_exp_f32 v208, v208
    v_exp_f32 v210, v210
    v_add_f32 v208, 1.0, v208
    v_add_f32 v210, 1.0, v210
    v_rcp_f32 v208, v208
    v_rcp_f32 v210, v210
    v_mul_f32 v194, v194, v208
    v_mul_f32 v195, v195, v210
    v_cvt_pk_bf16_f32 v196, v196, v196
    v_and_b32 v196, 0xffff0000, v196
    v_cvt_pk_bf16_f32 v197, v197, v197
    v_and_b32 v197, 0xffff0000, v197
    v_mul_f32 v208, v196, v196
    v_mov_b32 v209, 1.0
    v_mul_f32 v210, v197, v197
    v_mov_b32 v211, 1.0
    v_fmac_f32 v209, 0x3d372713, v208
    v_fmac_f32 v211, 0x3d372713, v210
    v_mul_f32 v208, v209, v196
    v_mul_f32 v210, v211, v197
    v_mul_f32 v208, 0xc0135761, v208
    v_mul_f32 v210, 0xc0135761, v210
    v_exp_f32 v208, v208
    v_exp_f32 v210, v210
    v_add_f32 v208, 1.0, v208
    v_add_f32 v210, 1.0, v210
    v_rcp_f32 v208, v208
    v_rcp_f32 v210, v210
    v_mul_f32 v196, v196, v208
    v_mul_f32 v197, v197, v210
    v_cvt_pk_bf16_f32 v198, v198, v198
    v_and_b32 v198, 0xffff0000, v198
    v_cvt_pk_bf16_f32 v199, v199, v199
    v_and_b32 v199, 0xffff0000, v199
    v_mul_f32 v208, v198, v198
    v_mov_b32 v209, 1.0
    v_mul_f32 v210, v199, v199
    v_mov_b32 v211, 1.0
    v_fmac_f32 v209, 0x3d372713, v208
    v_fmac_f32 v211, 0x3d372713, v210
    v_mul_f32 v208, v209, v198
    v_mul_f32 v210, v211, v199
    v_mul_f32 v208, 0xc0135761, v208
    v_mul_f32 v210, 0xc0135761, v210
    v_exp_f32 v208, v208
    v_exp_f32 v210, v210
    v_add_f32 v208, 1.0, v208
    v_add_f32 v210, 1.0, v210
    v_rcp_f32 v208, v208
    v_rcp_f32 v210, v210
    v_mul_f32 v198, v198, v208
    v_mul_f32 v199, v199, v210
    v_cvt_pk_bf16_f32 v200, v200, v200
    v_and_b32 v200, 0xffff0000, v200
    v_cvt_pk_bf16_f32 v201, v201, v201
    v_and_b32 v201, 0xffff0000, v201
    v_mul_f32 v208, v200, v200
    v_mov_b32 v209, 1.0
    v_mul_f32 v210, v201, v201
    v_mov_b32 v211, 1.0
    v_fmac_f32 v209, 0x3d372713, v208
    v_fmac_f32 v211, 0x3d372713, v210
    v_mul_f32 v208, v209, v200
    v_mul_f32 v210, v211, v201
    v_mul_f32 v208, 0xc0135761, v208
    v_mul_f32 v210, 0xc0135761, v210
    v_exp_f32 v208, v208
    v_exp_f32 v210, v210
    v_add_f32 v208, 1.0, v208
    v_add_f32 v210, 1.0, v210
    v_rcp_f32 v208, v208
    v_rcp_f32 v210, v210
    v_mul_f32 v200, v200, v208
    v_mul_f32 v201, v201, v210
    v_cvt_pk_bf16_f32 v202, v202, v202
    v_and_b32 v202, 0xffff0000, v202
    v_cvt_pk_bf16_f32 v203, v203, v203
    v_and_b32 v203, 0xffff0000, v203
    v_mul_f32 v208, v202, v202
    v_mov_b32 v209, 1.0
    v_mul_f32 v210, v203, v203
    v_mov_b32 v211, 1.0
    v_fmac_f32 v209, 0x3d372713, v208
    v_fmac_f32 v211, 0x3d372713, v210
    v_mul_f32 v208, v209, v202
    v_mul_f32 v210, v211, v203
    v_mul_f32 v208, 0xc0135761, v208
    v_mul_f32 v210, 0xc0135761, v210
    v_exp_f32 v208, v208
    v_exp_f32 v210, v210
    v_add_f32 v208, 1.0, v208
    v_add_f32 v210, 1.0, v210
    v_rcp_f32 v208, v208
    v_rcp_f32 v210, v210
    v_mul_f32 v202, v202, v208
    v_mul_f32 v203, v203, v210
    v_cvt_pk_bf16_f32 v204, v204, v204
    v_and_b32 v204, 0xffff0000, v204
    v_cvt_pk_bf16_f32 v205, v205, v205
    v_and_b32 v205, 0xffff0000, v205
    v_mul_f32 v208, v204, v204
    v_mov_b32 v209, 1.0
    v_mul_f32 v210, v205, v205
    v_mov_b32 v211, 1.0
    v_fmac_f32 v209, 0x3d372713, v208
    v_fmac_f32 v211, 0x3d372713, v210
    v_mul_f32 v208, v209, v204
    v_mul_f32 v210, v211, v205
    v_mul_f32 v208, 0xc0135761, v208
    v_mul_f32 v210, 0xc0135761, v210
    v_exp_f32 v208, v208
    v_exp_f32 v210, v210
    v_add_f32 v208, 1.0, v208
    v_add_f32 v210, 1.0, v210
    v_rcp_f32 v208, v208
    v_rcp_f32 v210, v210
    v_mul_f32 v204, v204, v208
    v_mul_f32 v205, v205, v210
    v_cvt_pk_bf16_f32 v206, v206, v206
    v_and_b32 v206, 0xffff0000, v206
    v_cvt_pk_bf16_f32 v207, v207, v207
    v_and_b32 v207, 0xffff0000, v207
    v_mul_f32 v208, v206, v206
    v_mov_b32 v209, 1.0
    v_mul_f32 v210, v207, v207
    v_mov_b32 v211, 1.0
    v_fmac_f32 v209, 0x3d372713, v208
    v_fmac_f32 v211, 0x3d372713, v210
    v_mul_f32 v208, v209, v206
    v_mul_f32 v210, v211, v207
    v_mul_f32 v208, 0xc0135761, v208
    v_mul_f32 v210, 0xc0135761, v210
    v_exp_f32 v208, v208
    v_exp_f32 v210, v210
    v_add_f32 v208, 1.0, v208
    v_add_f32 v210, 1.0, v210
    v_rcp_f32 v208, v208
    v_rcp_f32 v210, v210
    v_mul_f32 v206, v206, v208
    v_mul_f32 v207, v207, v210
    s_cmp_ge_u32 s38, 7
    s_cbranch_scc1 L_g1_z2
    s_add_u32 s24, s10, 18874368
    s_addc_u32 s25, s11, 0
    s_mov_b32 s26, 3670016
    s_mov_b32 s27, 0x00020000
    s_mul_i32 s14, s44, 57344
    s_lshl_b32 s15, s38, 13
    s_add_u32 s14, s14, s15
    v_lshlrev_b32 v5, 3, v1
    v_cvt_pk_bf16_f32 v32, v144, v145
    v_cvt_pk_bf16_f32 v33, v146, v147
    buffer_store_dwordx2 v[32:33], v5, s[24:27], s14 offen offset:0
    v_cvt_pk_bf16_f32 v34, v148, v149
    v_cvt_pk_bf16_f32 v35, v150, v151
    buffer_store_dwordx2 v[34:35], v5, s[24:27], s14 offen offset:512
    v_cvt_pk_bf16_f32 v36, v152, v153
    v_cvt_pk_bf16_f32 v37, v154, v155
    buffer_store_dwordx2 v[36:37], v5, s[24:27], s14 offen offset:1024
    v_cvt_pk_bf16_f32 v38, v156, v157
    v_cvt_pk_bf16_f32 v39, v158, v159
    buffer_store_dwordx2 v[38:39], v5, s[24:27], s14 offen offset:1536
    v_cvt_pk_bf16_f32 v40, v160, v161
    v_cvt_pk_bf16_f32 v41, v162, v163
    buffer_store_dwordx2 v[40:41], v5, s[24:27], s14 offen offset:2048
    v_cvt_pk_bf16_f32 v42, v164, v165
    v_cvt_pk_bf16_f32 v43, v166, v167
    buffer_store_dwordx2 v[42:43], v5, s[24:27], s14 offen offset:2560
    v_cvt_pk_bf16_f32 v44, v168, v169
    v_cvt_pk_bf16_f32 v45, v170, v171
    buffer_store_dwordx2 v[44:45], v5, s[24:27], s14 offen offset:3072
    v_cvt_pk_bf16_f32 v46, v172, v173
    v_cvt_pk_bf16_f32 v47, v174, v175
    buffer_store_dwordx2 v[46:47], v5, s[24:27], s14 offen offset:3584
    s_add_u32 s14, s14, 4096
    v_cvt_pk_bf16_f32 v48, v176, v177
    v_cvt_pk_bf16_f32 v49, v178, v179
    buffer_store_dwordx2 v[48:49], v5, s[24:27], s14 offen offset:0
    v_cvt_pk_bf16_f32 v50, v180, v181
    v_cvt_pk_bf16_f32 v51, v182, v183
    buffer_store_dwordx2 v[50:51], v5, s[24:27], s14 offen offset:512
    v_cvt_pk_bf16_f32 v52, v184, v185
    v_cvt_pk_bf16_f32 v53, v186, v187
    buffer_store_dwordx2 v[52:53], v5, s[24:27], s14 offen offset:1024
    v_cvt_pk_bf16_f32 v54, v188, v189
    v_cvt_pk_bf16_f32 v55, v190, v191
    buffer_store_dwordx2 v[54:55], v5, s[24:27], s14 offen offset:1536
    v_cvt_pk_bf16_f32 v56, v192, v193
    v_cvt_pk_bf16_f32 v57, v194, v195
    buffer_store_dwordx2 v[56:57], v5, s[24:27], s14 offen offset:2048
    v_cvt_pk_bf16_f32 v58, v196, v197
    v_cvt_pk_bf16_f32 v59, v198, v199
    buffer_store_dwordx2 v[58:59], v5, s[24:27], s14 offen offset:2560
    v_cvt_pk_bf16_f32 v60, v200, v201
    v_cvt_pk_bf16_f32 v61, v202, v203
    buffer_store_dwordx2 v[60:61], v5, s[24:27], s14 offen offset:3072
    v_cvt_pk_bf16_f32 v62, v204, v205
    v_cvt_pk_bf16_f32 v63, v206, v207
    buffer_store_dwordx2 v[62:63], v5, s[24:27], s14 offen offset:3584
    s_add_u32 s14, s14, 4096
    s_endpgm
L_g1_z2:
    s_add_u32 s24, s10, 23068672
    s_addc_u32 s25, s11, 0
    s_mov_b32 s26, 3670016
    s_mov_b32 s27, 0x00020000
    s_sub_u32 s15, s38, 7
    s_lshl_b32 s15, s15, 8
    s_lshl_b32 s14, s44, 5
    v_add_u32 v4, s14, v2
    v_mul_u32_u24 v5, 1792, v4
    v_add_u32 v5, s15, v5
    v_lshl_add_u32 v5, v3, 4, v5
    v_cvt_pk_bf16_f32 v32, v144, v145
    v_cvt_pk_bf16_f32 v33, v146, v147
    v_cvt_pk_bf16_f32 v34, v148, v149
    v_cvt_pk_bf16_f32 v35, v150, v151
    v_cvt_pk_bf16_f32 v36, v152, v153
    v_cvt_pk_bf16_f32 v37, v154, v155
    v_cvt_pk_bf16_f32 v38, v156, v157
    v_cvt_pk_bf16_f32 v39, v158, v159
    s_nop 1
    v_permlane32_swap_b32 v32, v34
    v_permlane32_swap_b32 v33, v35
    v_permlane32_swap_b32 v36, v38
    v_permlane32_swap_b32 v37, v39
    s_nop 1
    buffer_store_dwordx4 v[32:35], v5, s[24:27], 0 offen offset:0
    buffer_store_dwordx4 v[36:39], v5, s[24:27], 0 offen offset:32
    v_cvt_pk_bf16_f32 v40, v160, v161
    v_cvt_pk_bf16_f32 v41, v162, v163
    v_cvt_pk_bf16_f32 v42, v164, v165
    v_cvt_pk_bf16_f32 v43, v166, v167
    v_cvt_pk_bf16_f32 v44, v168, v169
    v_cvt_pk_bf16_f32 v45, v170, v171
    v_cvt_pk_bf16_f32 v46, v172, v173
    v_cvt_pk_bf16_f32 v47, v174, v175
    s_nop 1
    v_permlane32_swap_b32 v40, v42
    v_permlane32_swap_b32 v41, v43
    v_permlane32_swap_b32 v44, v46
    v_permlane32_swap_b32 v45, v47
    s_nop 1
    buffer_store_dwordx4 v[40:43], v5, s[24:27], 0 offen offset:64
    buffer_store_dwordx4 v[44:47], v5, s[24:27], 0 offen offset:96
    v_cvt_pk_bf16_f32 v48, v176, v177
    v_cvt_pk_bf16_f32 v49, v178, v179
    v_cvt_pk_bf16_f32 v50, v180, v181
    v_cvt_pk_bf16_f32 v51, v182, v183
    v_cvt_pk_bf16_f32 v52, v184, v185
    v_cvt_pk_bf16_f32 v53, v186, v187
    v_cvt_pk_bf16_f32 v54, v188, v189
    v_cvt_pk_bf16_f32 v55, v190, v191
    s_nop 1
    v_permlane32_swap_b32 v48, v50
    v_permlane32_swap_b32 v49, v51
    v_permlane32_swap_b32 v52, v54
    v_permlane32_swap_b32 v53, v55
    s_nop 1
    buffer_store_dwordx4 v[48:51], v5, s[24:27], 0 offen offset:128
    buffer_store_dwordx4 v[52:55], v5, s[24:27], 0 offen offset:160
    v_cvt_pk_bf16_f32 v56, v192, v193
    v_cvt_pk_bf16_f32 v57, v194, v195
    v_cvt_pk_bf16_f32 v58, v196, v197
    v_cvt_pk_bf16_f32 v59, v198, v199
    v_cvt_pk_bf16_f32 v60, v200, v201
    v_cvt_pk_bf16_f32 v61, v202, v203
    v_cvt_pk_bf16_f32 v62, v204, v205
    v_cvt_pk_bf16_f32 v63, v206, v207
    s_nop 1
    v_permlane32_swap_b32 v56, v58
    v_permlane32_swap_b32 v57, v59
    v_permlane32_swap_b32 v60, v62
    v_permlane32_swap_b32 v61, v63
    s_nop 1
    buffer_store_dwordx4 v[56:59], v5, s[24:27], 0 offen offset:192
    buffer_store_dwordx4 v[60:63], v5, s[24:27], 0 offen offset:224
L_g1_done:
    s_endpgm
.globl ln2_kernel
.p2align 8
.type ln2_kernel,@function
ln2_kernel:
    s_cmp_ge_u32 s2, 512
    s_cbranch_scc1 L_ln2_done
    s_load_dwordx2 s[6:7], s[0:1], 96
    v_lshrrev_b32 v1, 6, v0
    v_and_b32 v2, 63, v0
    s_lshl_b32 s3, s2, 2
    v_add_u32 v1, s3, v1
    v_mul_u32_u24 v3, 1792, v1
    v_lshl_add_u32 v3, v2, 4, v3
    v_cmp_gt_u32 vcc, 56, v2
    v_mov_b32 v4, 0x7ffffff0
    s_nop 1
    v_cndmask_b32 v3, v4, v3, vcc
    s_waitcnt lgkmcnt(0)
    s_add_u32 s12, s6, 23068672
    s_addc_u32 s13, s7, 0
    s_mov_b32 s14, 3670016
    s_mov_b32 s15, 0x00020000
    buffer_load_dwordx4 v[8:11], v3, s[12:15], 0 offen
    buffer_load_dwordx4 v[12:15], v3, s[12:15], 0 offen offset:896
    s_waitcnt vmcnt(0)
    v_lshlrev_b32 v16, 16, v8
    v_and_b32 v17, 0xffff0000, v8
    v_lshlrev_b32 v18, 16, v9
    v_and_b32 v19, 0xffff0000, v9
    v_lshlrev_b32 v20, 16, v10
    v_and_b32 v21, 0xffff0000, v10
    v_lshlrev_b32 v22, 16, v11
    v_and_b32 v23, 0xffff0000, v11
    v_lshlrev_b32 v24, 16, v12
    v_and_b32 v25, 0xffff0000, v12
    v_lshlrev_b32 v26, 16, v13
    v_and_b32 v27, 0xffff0000, v13
    v_lshlrev_b32 v28, 16, v14
    v_and_b32 v29, 0xffff0000, v14
    v_lshlrev_b32 v30, 16, v15
    v_and_b32 v31, 0xffff0000, v15
    v_add_f32 v5, v16, v17
    v_add_f32 v5, v5, v18
    v_add_f32 v5, v5, v19
    v_add_f32 v5, v5, v20
    v_add_f32 v5, v5, v21
    v_add_f32 v5, v5, v22
    v_add_f32 v5, v5, v23
    v_add_f32 v5, v5, v24
    v_add_f32 v5, v5, v25
    v_add_f32 v5, v5, v26
    v_add_f32 v5, v5, v27
    v_add_f32 v5, v5, v28
    v_add_f32 v5, v5, v29
    v_add_f32 v5, v5, v30
    v_add_f32 v5, v5, v31
    s_nop 1
    v_add_f32_dpp v5, v5, v5 row_shr:1 row_mask:0xf bank_mask:0xf bound_ctrl:0
    s_nop 1
    v_add_f32_dpp v5, v5, v5 row_shr:2 row_mask:0xf bank_mask:0xf bound_ctrl:0
    s_nop 1
    v_add_f32_dpp v5, v5, v5 row_shr:4 row_mask:0xf bank_mask:0xf bound_ctrl:0
    s_nop 1
    v_add_f32_dpp v5, v5, v5 row_shr:8 row_mask:0xf bank_mask:0xf bound_ctrl:0
    s_nop 1
    v_add_f32_dpp v5, v5, v5 row_bcast:15 row_mask:0xa bank_mask:0xf
    s_nop 1
    v_add_f32_dpp v5, v5, v5 row_bcast:31 row_mask:0xc bank_mask:0xf
    s_nop 1
    v_readlane_b32 s26, v5, 63
    s_nop 1
    v_mov_b32 v5, s26
    v_mul_f32 v5, 0x3a924925, v5
    v_mov_b32 v7, 0
    v_sub_f32 v34, v16, v5
    v_fmac_f32 v7, v34, v34
    v_sub_f32 v34, v17, v5
    v_fmac_f32 v7, v34, v34
    v_sub_f32 v34, v18, v5
    v_fmac_f32 v7, v34, v34
    v_sub_f32 v34, v19, v5
    v_fmac_f32 v7, v34, v34
    v_sub_f32 v34, v20, v5
    v_fmac_f32 v7, v34, v34
    v_sub_f32 v34, v21, v5
    v_fmac_f32 v7, v34, v34
    v_sub_f32 v34, v22, v5
    v_fmac_f32 v7, v34, v34
    v_sub_f32 v34, v23, v5
    v_fmac_f32 v7, v34, v34
    v_sub_f32 v34, v24, v5
    v_fmac_f32 v7, v34, v34
    v_sub_f32 v34, v25, v5
    v_fmac_f32 v7, v34, v34
    v_sub_f32 v34, v26, v5
    v_fmac_f32 v7, v34, v34
    v_sub_f32 v34, v27, v5
    v_fmac_f32 v7, v34, v34
    v_sub_f32 v34, v28, v5
    v_fmac_f32 v7, v34, v34
    v_sub_f32 v34, v29, v5
    v_fmac_f32 v7, v34, v34
    v_sub_f32 v34, v30, v5
    v_fmac_f32 v7, v34, v34
    v_sub_f32 v34, v31, v5
    v_fmac_f32 v7, v34, v34
    v_cndmask_b32 v7, 0, v7, vcc
    s_nop 1
    v_add_f32_dpp v7, v7, v7 row_shr:1 row_mask:0xf bank_mask:0xf bound_ctrl:0
    s_nop 1
    v_add_f32_dpp v7, v7, v7 row_shr:2 row_mask:0xf bank_mask:0xf bound_ctrl:0
    s_nop 1
    v_add_f32_dpp v7, v7, v7 row_shr:4 row_mask:0xf bank_mask:0xf bound_ctrl:0
    s_nop 1
    v_add_f32_dpp v7, v7, v7 row_shr:8 row_mask:0xf bank_mask:0xf bound_ctrl:0
    s_nop 1
    v_add_f32_dpp v7, v7, v7 row_bcast:15 row_mask:0xa bank_mask:0xf
    s_nop 1
    v_add_f32_dpp v7, v7, v7 row_bcast:31 row_mask:0xc bank_mask:0xf
    s_nop 1
    v_readlane_b32 s26, v7, 63
    s_nop 1
    v_mov_b32 v7, s26
    v_mul_f32 v7, 0x3a924925, v7
    v_cvt_pk_bf16_f32 v5, v5, v5
    v_and_b32 v5, 0xffff0000, v5
    v_cvt_pk_bf16_f32 v7, v7, v7
    v_and_b32 v7, 0xffff0000, v7
    v_add_f32 v7, 0x3727c5ac, v7
    v_cvt_pk_bf16_f32 v7, v7, v7
    v_and_b32 v7, 0xffff0000, v7
    v_sqrt_f32 v7, v7
    s_nop 0
    v_cvt_pk_bf16_f32 v7, v7, v7
    v_and_b32 v7, 0xffff0000, v7
    v_rcp_f32 v7, v7
    s_nop 0
    v_sub_f32 v34, v16, v5
    v_sub_f32 v35, v17, v5
    v_cvt_pk_bf16_f32 v36, v34, v35
    v_lshlrev_b32 v34, 16, v36
    v_and_b32 v35, 0xffff0000, v36
    v_mul_f32 v34, v34, v7
    v_mul_f32 v35, v35, v7
    v_cvt_pk_bf16_f32 v8, v34, v35
    v_sub_f32 v34, v18, v5
    v_sub_f32 v35, v19, v5
    v_cvt_pk_bf16_f32 v36, v34, v35
    v_lshlrev_b32 v34, 16, v36
    v_and_b32 v35, 0xffff0000, v36
    v_mul_f32 v34, v34, v7
    v_mul_f32 v35, v35, v7
    v_cvt_pk_bf16_f32 v9, v34, v35
    v_sub_f32 v34, v20, v5
    v_sub_f32 v35, v21, v5
    v_cvt_pk_bf16_f32 v36, v34, v35
    v_lshlrev_b32 v34, 16, v36
    v_and_b32 v35, 0xffff0000, v36
    v_mul_f32 v34, v34, v7
    v_mul_f32 v35, v35, v7
    v_cvt_pk_bf16_f32 v10, v34, v35
    v_sub_f32 v34, v22, v5
    v_sub_f32 v35, v23, v5
    v_cvt_pk_bf16_f32 v36, v34, v35
    v_lshlrev_b32 v34, 16, v36
    v_and_b32 v35, 0xffff0000, v36
    v_mul_f32 v34, v34, v7
    v_mul_f32 v35, v35, v7
    v_cvt_pk_bf16_f32 v11, v34, v35
    v_sub_f32 v34, v24, v5
    v_sub_f32 v35, v25, v5
    v_cvt_pk_bf16_f32 v36, v34, v35
    v_lshlrev_b32 v34, 16, v36
    v_and_b32 v35, 0xffff0000, v36
    v_mul_f32 v34, v34, v7
    v_mul_f32 v35, v35, v7
    v_cvt_pk_bf16_f32 v12, v34, v35
    v_sub_f32 v34, v26, v5
    v_sub_f32 v35, v27, v5
    v_cvt_pk_bf16_f32 v36, v34, v35
    v_lshlrev_b32 v34, 16, v36
    v_and_b32 v35, 0xffff0000, v36
    v_mul_f32 v34, v34, v7
    v_mul_f32 v35, v35, v7
    v_cvt_pk_bf16_f32 v13, v34, v35
    v_sub_f32 v34, v28, v5
    v_sub_f32 v35, v29, v5
    v_cvt_pk_bf16_f32 v36, v34, v35
    v_lshlrev_b32 v34, 16, v36
    v_and_b32 v35, 0xffff0000, v36
    v_mul_f32 v34, v34, v7
    v_mul_f32 v35, v35, v7
    v_cvt_pk_bf16_f32 v14, v34, v35
    v_sub_f32 v34, v30, v5
    v_sub_f32 v35, v31, v5
    v_cvt_pk_bf16_f32 v36, v34, v35
    v_lshlrev_b32 v34, 16, v36
    v_and_b32 v35, 0xffff0000, v36
    v_mul_f32 v34, v34, v7
    v_mul_f32 v35, v35, v7
    v_cvt_pk_bf16_f32 v15, v34, v35
    buffer_store_dwordx4 v[8:11], v3, s[12:15], 0 offen
    buffer_store_dwordx4 v[12:15], v3, s[12:15], 0 offen offset:896
L_ln2_done:
    s_endpgm
.globl g2_kernel
.p2align 8
.type g2_kernel,@function
g2_kernel:
    s_cmp_ge_u32 s2, 224
    s_cbranch_scc1 L_g2_done
    s_load_dwordx2 s[10:11], s[0:1], 96
    s_load_dwordx2 s[4:5], s[0:1], 56
    s_load_dwordx2 s[8:9], s[0:1], 64
    s_and_b32 s14, s2, 7
    s_lshr_b32 s15, s2, 3
    s_mov_b32 s12, 306783379
    s_mul_hi_u32 s39, s15, s12
    s_mul_i32 s12, s39, 14
    s_sub_u32 s38, s15, s12
    s_mul_i32 s14, s14, 2
    s_add_u32 s39, s39, s14
    v_and_b32 v1, 63, v0
    v_and_b32 v2, 31, v0
    v_bfe_u32 v3, v0, 5, 1
    v_lshlrev_b32 v9, 4, v1
    v_lshrrev_b32 v5, 6, v0
    s_nop 0
    v_readfirstlane_b32 s3, v5
    s_nop 3
    s_lshl_b32 s41, s3, 10
    s_and_b32 s46, s3, 3
    s_lshr_b32 s47, s3, 2
    v_bfe_u32 v5, v1, 2, 2
    v_and_b32 v6, 3, v1
    v_bfe_u32 v7, v1, 4, 1
    v_lshlrev_b32 v8, 3, v6
    v_lshl_add_u32 v8, v7, 5, v8
    v_lshl_add_u32 v6, v3, 3, v5
    v_mul_u32_u24 v6, 128, v6
    v_add_u32 v8, v8, v6
    v_add_u32 v8, 16384, v8
    v_lshrrev_b32 v5, 1, v5
    v_xor_b32 v7, 0, v5
    v_lshl_add_u32 v12, v7, 6, v8
    v_xor_b32 v7, 1, v5
    v_lshl_add_u32 v13, v7, 6, v8
    s_lshl_b32 s14, s47, 12
    v_add_u32 v12, s14, v12
    v_add_u32 v13, s14, v13
    s_lshl_b32 s14, s46, 5
    v_add_u32 v5, s14, v2
    v_lshlrev_b32 v6, 7, v5
    v_bfe_u32 v7, v5, 1, 3
    s_lshl_b32 s14, s47, 2
    v_add_u32 v8, s14, v3
    v_xor_b32 v8, v8, v7
    v_lshl_add_u32 v14, v8, 4, v6
    v_add_u32 v8, s14, v3
    v_add_u32 v8, 2, v8
    v_xor_b32 v8, v8, v7
    v_lshl_add_u32 v15, v8, 4, v6
    v_lshrrev_b32 v5, 3, v1
    v_and_b32 v6, 7, v1
    s_mul_i32 s14, s3, 8
    v_add_u32 v5, s14, v5
    v_add_u32 v7, 0, v5
    v_bfe_u32 v8, v7, 1, 3
    v_xor_b32 v8, v8, v6
    s_mov_b32 s14, 4096
    v_mul_lo_u32 v7, v7, s14
    v_lshl_add_u32 v18, v8, 4, v7
    v_add_u32 v7, 64, v5
    v_bfe_u32 v8, v7, 1, 3
    v_xor_b32 v8, v8, v6
    s_mov_b32 s14, 4096
    v_mul_lo_u32 v7, v7, s14
    v_lshl_add_u32 v19, v8, 4, v7
    v_lshrrev_b32 v5, 3, v1
    v_and_b32 v6, 7, v1
    s_mul_i32 s14, s3, 8
    v_add_u32 v5, s14, v5
    v_add_u32 v7, 0, v5
    v_bfe_u32 v8, v7, 1, 1
    v_lshlrev_b32 v8, 2, v8
    v_xor_b32 v8, v8, v6
    s_mov_b32 s14, 1792
    v_mul_lo_u32 v7, v7, s14
    v_lshl_add_u32 v16, v8, 4, v7
    s_waitcnt lgkmcnt(0)
    s_mov_b32 s16, s4
    s_mov_b32 s17, s5
    s_mov_b32 s18, 8388608
    s_mov_b32 s19, 0x00020000
    s_add_u32 s20, s10, 23068672
    s_addc_u32 s21, s11, 0
    s_mov_b32 s22, 3670016
    s_mov_b32 s23, 0x00020000
    s_lshl_b32 s37, s39, 19
    s_lshl_b32 s36, s38, 7
    s_add_u32 m0, s41, 0
    s_nop 0
    buffer_load_dwordx4 v18, s[16:19], s37 offen lds
    s_add_u32 m0, s41, 8192
    s_nop 0
    buffer_load_dwordx4 v19, s[16:19], s37 offen lds
    s_add_u32 s37, s37, 128
    s_add_u32 m0, s41, 16384
    s_nop 0
    buffer_load_dwordx4 v16, s[20:23], s36 offen lds
    s_add_u32 s36, s36, 114688
    s_add_u32 m0, s41, 24576
    s_nop 0
    buffer_load_dwordx4 v18, s[16:19], s37 offen lds
    s_add_u32 m0, s41, 32768
    s_nop 0
    buffer_load_dwordx4 v19, s[16:19], s37 offen lds
    s_add_u32 s37, s37, 128
    s_add_u32 m0, s41, 40960
    s_nop 0
    buffer_load_dwordx4 v16, s[20:23], s36 offen lds
    s_add_u32 s36, s36, 114688
    s_add_u32 m0, s41, 49152
    s_nop 0
    buffer_load_dwordx4 v18, s[16:19], s37 offen lds
    s_add_u32 m0, s41, 57344
    s_nop 0
    buffer_load_dwordx4 v19, s[16:19], s37 offen lds
    s_add_u32 s37, s37, 128
    s_add_u32 m0, s41, 65536
    s_nop 0
    buffer_load_dwordx4 v16, s[20:23], s36 offen lds
    s_add_u32 s36, s36, 114688
    s_add_u32 m0, s41, 73728
    s_nop 0
    buffer_load_dwordx4 v18, s[16:19], s37 offen lds
    s_add_u32 m0, s41, 81920
    s_nop 0
    buffer_load_dwordx4 v19, s[16:19], s37 offen lds
    s_add_u32 s37, s37, 128
    s_add_u32 m0, s41, 90112
    s_nop 0
    buffer_load_dwordx4 v16, s[20:23], s36 offen lds
    s_add_u32 s36, s36, 114688
    s_add_u32 m0, s41, 98304
    s_nop 0
    buffer_load_dwordx4 v18, s[16:19], s37 offen lds
    s_add_u32 m0, s41, 106496
    s_nop 0
    buffer_load_dwordx4 v19, s[16:19], s37 offen lds
    s_add_u32 s37, s37, 128
    s_add_u32 m0, s41, 114688
    s_nop 0
    buffer_load_dwordx4 v16, s[20:23], s36 offen lds
    s_add_u32 s36, s36, 114688
    s_waitcnt vmcnt(12) lgkmcnt(0)
    s_barrier
    ds_read_b128 v[32:35], v14 offset:0
    ds_read_b64_tr_b16 v[48:49], v12 offset:0
    ds_read_b64_tr_b16 v[50:51], v12 offset:512
    ds_read_b64_tr_b16 v[52:53], v13 offset:0
    ds_read_b64_tr_b16 v[54:55], v13 offset:512
    ds_read_b128 v[36:39], v15 offset:0
    ds_read_b64_tr_b16 v[56:57], v12 offset:2048
    ds_read_b64_tr_b16 v[58:59], v12 offset:2560
    ds_read_b64_tr_b16 v[60:61], v13 offset:2048
    ds_read_b64_tr_b16 v[62:63], v13 offset:2560
    s_add_u32 m0, s41, 122880
    s_nop 0
    buffer_load_dwordx4 v18, s[16:19], s37 offen lds
    s_add_u32 m0, s41, 131072
    s_nop 0
    buffer_load_dwordx4 v19, s[16:19], s37 offen lds
    s_add_u32 s37, s37, 128
    s_add_u32 m0, s41, 139264
    s_nop 0
    buffer_load_dwordx4 v16, s[20:23], s36 offen lds
    s_add_u32 s36, s36, 114688
    s_waitcnt vmcnt(12) lgkmcnt(0)
    s_barrier
    ds_read_b128 v[40:43], v14 offset:24576
    ds_read_b64_tr_b16 v[64:65], v12 offset:24576
    ds_read_b64_tr_b16 v[66:67], v12 offset:25088
    v_mfma_f32_32x32x16_bf16 v[80:95], v[48:51], v[32:35], 0
    ds_read_b64_tr_b16 v[68:69], v13 offset:24576
    ds_read_b64_tr_b16 v[70:71], v13 offset:25088
    v_mfma_f32_32x32x16_bf16 v[96:111], v[52:55], v[32:35], 0
    ds_read_b128 v[44:47], v15 offset:24576
    ds_read_b64_tr_b16 v[72:73], v12 offset:26624
    ds_read_b64_tr_b16 v[74:75], v12 offset:27136
    v_mfma_f32_32x32x16_bf16 v[80:95], v[56:59], v[36:39], v[80:95]
    ds_read_b64_tr_b16 v[76:77], v13 offset:26624
    ds_read_b64_tr_b16 v[78:79], v13 offset:27136
    v_mfma_f32_32x32x16_bf16 v[96:111], v[60:63], v[36:39], v[96:111]
    s_add_u32 m0, s41, 0
    s_nop 0
    buffer_load_dwordx4 v18, s[16:19], s37 offen lds
    s_add_u32 m0, s41, 8192
    s_nop 0
    buffer_load_dwordx4 v19, s[16:19], s37 offen lds
    s_add_u32 s37, s37, 128
    s_add_u32 m0, s41, 16384
    s_nop 0
    buffer_load_dwordx4 v16, s[20:23], s36 offen lds
    s_add_u32 s36, s36, 114688
    s_mov_b32 s40, 4
L_g2_loop:
    s_waitcnt vmcnt(12) lgkmcnt(0)
    s_barrier
    v_add_u32 v20, 49152, v14
    v_add_u32 v21, 49152, v15
    v_add_u32 v22, 49152, v12
    v_add_u32 v23, 49152, v13
    ds_read_b128 v[32:35], v20 offset:0
    ds_read_b64_tr_b16 v[48:49], v22 offset:0
    ds_read_b64_tr_b16 v[50:51], v22 offset:512
    v_mfma_f32_32x32x16_bf16 v[80:95], v[64:67], v[40:43], v[80:95]
    ds_read_b64_tr_b16 v[52:53], v23 offset:0
    ds_read_b64_tr_b16 v[54:55], v23 offset:512
    v_mfma_f32_32x32x16_bf16 v[96:111], v[68:71], v[40:43], v[96:111]
    ds_read_b128 v[36:39], v21 offset:0
    ds_read_b64_tr_b16 v[56:57], v22 offset:2048
    ds_read_b64_tr_b16 v[58:59], v22 offset:2560
    v_mfma_f32_32x32x16_bf16 v[80:95], v[72:75], v[44:47], v[80:95]
    ds_read_b64_tr_b16 v[60:61], v23 offset:2048
    ds_read_b64_tr_b16 v[62:63], v23 offset:2560
    v_mfma_f32_32x32x16_bf16 v[96:111], v[76:79], v[44:47], v[96:111]
    s_add_u32 m0, s41, 24576
    s_nop 0
    buffer_load_dwordx4 v18, s[16:19], s37 offen lds
    s_add_u32 m0, s41, 32768
    s_nop 0
    buffer_load_dwordx4 v19, s[16:19], s37 offen lds
    s_add_u32 s37, s37, 128
    s_add_u32 m0, s41, 40960
    s_nop 0
    buffer_load_dwordx4 v16, s[20:23], s36 offen lds
    s_add_u32 s36, s36, 114688
    s_waitcnt vmcnt(12) lgkmcnt(0)
    s_barrier
    v_add_u32 v20, 73728, v14
    v_add_u32 v21, 73728, v15
    v_add_u32 v22, 73728, v12
    v_add_u32 v23, 73728, v13
    ds_read_b128 v[40:43], v20 offset:0
    ds_read_b64_tr_b16 v[64:65], v22 offset:0
    ds_read_b64_tr_b16 v[66:67], v22 offset:512
    v_mfma_f32_32x32x16_bf16 v[80:95], v[48:51], v[32:35], v[80:95]
    ds_read_b64_tr_b16 v[68:69], v23 offset:0
    ds_read_b64_tr_b16 v[70:71], v23 offset:512
    v_mfma_f32_32x32x16_bf16 v[96:111], v[52:55], v[32:35], v[96:111]
    ds_read_b128 v[44:47], v21 offset:0
    ds_read_b64_tr_b16 v[72:73], v22 offset:2048
    ds_read_b64_tr_b16 v[74:75], v22 offset:2560
    v_mfma_f32_32x32x16_bf16 v[80:95], v[56:59], v[36:39], v[80:95]
    ds_read_b64_tr_b16 v[76:77], v23 offset:2048
    ds_read_b64_tr_b16 v[78:79], v23 offset:2560
    v_mfma_f32_32x32x16_bf16 v[96:111], v[60:63], v[36:39], v[96:111]
    s_add_u32 m0, s41, 49152
    s_nop 0
    buffer_load_dwordx4 v18, s[16:19], s37 offen lds
    s_add_u32 m0, s41, 57344
    s_nop 0
    buffer_load_dwordx4 v19, s[16:19], s37 offen lds
    s_add_u32 s37, s37, 128
    s_add_u32 m0, s41, 65536
    s_nop 0
    buffer_load_dwordx4 v16, s[20:23], s36 offen lds
    s_add_u32 s36, s36, 114688
    s_waitcnt vmcnt(12) lgkmcnt(0)
    s_barrier
    v_add_u32 v20, 98304, v14
    v_add_u32 v21, 98304, v15
    v_add_u32 v22, 98304, v12
    v_add_u32 v23, 98304, v13
    ds_read_b128 v[32:35], v20 offset:0
    ds_read_b64_tr_b16 v[48:49], v22 offset:0
    ds_read_b64_tr_b16 v[50:51], v22 offset:512
    v_mfma_f32_32x32x16_bf16 v[80:95], v[64:67], v[40:43], v[80:95]
    ds_read_b64_tr_b16 v[52:53], v23 offset:0
    ds_read_b64_tr_b16 v[54:55], v23 offset:512
    v_mfma_f32_32x32x16_bf16 v[96:111], v[68:71], v[40:43], v[96:111]
    ds_read_b128 v[36:39], v21 offset:0
    ds_read_b64_tr_b16 v[56:57], v22 offset:2048
    ds_read_b64_tr_b16 v[58:59], v22 offset:2560
    v_mfma_f32_32x32x16_bf16 v[80:95], v[72:75], v[44:47], v[80:95]
    ds_read_b64_tr_b16 v[60:61], v23 offset:2048
    ds_read_b64_tr_b16 v[62:63], v23 offset:2560
    v_mfma_f32_32x32x16_bf16 v[96:111], v[76:79], v[44:47], v[96:111]
    s_add_u32 m0, s41, 73728
    s_nop 0
    buffer_load_dwordx4 v18, s[16:19], s37 offen lds
    s_add_u32 m0, s41, 81920
    s_nop 0
    buffer_load_dwordx4 v19, s[16:19], s37 offen lds
    s_add_u32 s37, s37, 128
    s_add_u32 m0, s41, 90112
    s_nop 0
    buffer_load_dwordx4 v16, s[20:23], s36 offen lds
    s_add_u32 s36, s36, 114688
    s_waitcnt vmcnt(12) lgkmcnt(0)
    s_barrier
    v_add_u32 v20, 122880, v14
    v_add_u32 v21, 122880, v15
    v_add_u32 v22, 122880, v12
    v_add_u32 v23, 122880, v13
    ds_read_b128 v[40:43], v20 offset:0
    ds_read_b64_tr_b16 v[64:65], v22 offset:0
    ds_read_b64_tr_b16 v[66:67], v22 offset:512
    v_mfma_f32_32x32x16_bf16 v[80:95], v[48:51], v[32:35], v[80:95]
    ds_read_b64_tr_b16 v[68:69], v23 offset:0
    ds_read_b64_tr_b16 v[70:71], v23 offset:512
    v_mfma_f32_32x32x16_bf16 v[96:111], v[52:55], v[32:35], v[96:111]
    ds_read_b128 v[44:47], v21 offset:0
    ds_read_b64_tr_b16 v[72:73], v22 offset:2048
    ds_read_b64_tr_b16 v[74:75], v22 offset:2560
    v_mfma_f32_32x32x16_bf16 v[80:95], v[56:59], v[36:39], v[80:95]
    ds_read_b64_tr_b16 v[76:77], v23 offset:2048
    ds_read_b64_tr_b16 v[78:79], v23 offset:2560
    v_mfma_f32_32x32x16_bf16 v[96:111], v[60:63], v[36:39], v[96:111]
    s_add_u32 m0, s41, 98304
    s_nop 0
    buffer_load_dwordx4 v18, s[16:19], s37 offen lds
    s_add_u32 m0, s41, 106496
    s_nop 0
    buffer_load_dwordx4 v19, s[16:19], s37 offen lds
    s_add_u32 s37, s37, 128
    s_add_u32 m0, s41, 114688
    s_nop 0
    buffer_load_dwordx4 v16, s[20:23], s36 offen lds
    s_add_u32 s36, s36, 114688
    s_waitcnt vmcnt(12) lgkmcnt(0)
    s_barrier
    ds_read_b128 v[32:35], v14 offset:0
    ds_read_b64_tr_b16 v[48:49], v12 offset:0
    ds_read_b64_tr_b16 v[50:51], v12 offset:512
    v_mfma_f32_32x32x16_bf16 v[80:95], v[64:67], v[40:43], v[80:95]
    ds_read_b64_tr_b16 v[52:53], v13 offset:0
    ds_read_b64_tr_b16 v[54:55], v13 offset:512
    v_mfma_f32_32x32x16_bf16 v[96:111], v[68:71], v[40:43], v[96:111]
    ds_read_b128 v[36:39], v15 offset:0
    ds_read_b64_tr_b16 v[56:57], v12 offset:2048
    ds_read_b64_tr_b16 v[58:59], v12 offset:2560
    v_mfma_f32_32x32x16_bf16 v[80:95], v[72:75], v[44:47], v[80:95]
    ds_read_b64_tr_b16 v[60:61], v13 offset:2048
    ds_read_b64_tr_b16 v[62:63], v13 offset:2560
    v_mfma_f32_32x32x16_bf16 v[96:111], v[76:79], v[44:47], v[96:111]
    s_add_u32 m0, s41, 122880
    s_nop 0
    buffer_load_dwordx4 v18, s[16:19], s37 offen lds
    s_add_u32 m0, s41, 131072
    s_nop 0
    buffer_load_dwordx4 v19, s[16:19], s37 offen lds
    s_add_u32 s37, s37, 128
    s_add_u32 m0, s41, 139264
    s_nop 0
    buffer_load_dwordx4 v16, s[20:23], s36 offen lds
    s_add_u32 s36, s36, 114688
    s_waitcnt vmcnt(12) lgkmcnt(0)
    s_barrier
    ds_read_b128 v[40:43], v14 offset:24576
    ds_read_b64_tr_b16 v[64:65], v12 offset:24576
    ds_read_b64_tr_b16 v[66:67], v12 offset:25088
    v_mfma_f32_32x32x16_bf16 v[80:95], v[48:51], v[32:35], v[80:95]
    ds_read_b64_tr_b16 v[68:69], v13 offset:24576
    ds_read_b64_tr_b16 v[70:71], v13 offset:25088
    v_mfma_f32_32x32x16_bf16 v[96:111], v[52:55], v[32:35], v[96:111]
    ds_read_b128 v[44:47], v15 offset:24576
    ds_read_b64_tr_b16 v[72:73], v12 offset:26624
    ds_read_b64_tr_b16 v[74:75], v12 offset:27136
    v_mfma_f32_32x32x16_bf16 v[80:95], v[56:59], v[36:39], v[80:95]
    ds_read_b64_tr_b16 v[76:77], v13 offset:26624
    ds_read_b64_tr_b16 v[78:79], v13 offset:27136
    v_mfma_f32_32x32x16_bf16 v[96:111], v[60:63], v[36:39], v[96:111]
    s_add_u32 m0, s41, 0
    s_nop 0
    buffer_load_dwordx4 v18, s[16:19], s37 offen lds
    s_add_u32 m0, s41, 8192
    s_nop 0
    buffer_load_dwordx4 v19, s[16:19], s37 offen lds
    s_add_u32 s37, s37, 128
    s_add_u32 m0, s41, 16384
    s_nop 0
    buffer_load_dwordx4 v16, s[20:23], s36 offen lds
    s_add_u32 s36, s36, 114688
    s_sub_u32 s40, s40, 1
    s_cmp_lg_u32 s40, 0
    s_cbranch_scc1 L_g2_loop
    s_waitcnt vmcnt(12) lgkmcnt(0)
    s_barrier
    v_add_u32 v20, 49152, v14
    v_add_u32 v21, 49152, v15
    v_add_u32 v22, 49152, v12
    v_add_u32 v23, 49152, v13
    ds_read_b128 v[32:35], v20 offset:0
    ds_read_b64_tr_b16 v[48:49], v22 offset:0
    ds_read_b64_tr_b16 v[50:51], v22 offset:512
    v_mfma_f32_32x32x16_bf16 v[80:95], v[64:67], v[40:43], v[80:95]
    ds_read_b64_tr_b16 v[52:53], v23 offset:0
    ds_read_b64_tr_b16 v[54:55], v23 offset:512
    v_mfma_f32_32x32x16_bf16 v[96:111], v[68:71], v[40:43], v[96:111]
    ds_read_b128 v[36:39], v21 offset:0
    ds_read_b64_tr_b16 v[56:57], v22 offset:2048
    ds_read_b64_tr_b16 v[58:59], v22 offset:2560
    v_mfma_f32_32x32x16_bf16 v[80:95], v[72:75], v[44:47], v[80:95]
    ds_read_b64_tr_b16 v[60:61], v23 offset:2048
    ds_read_b64_tr_b16 v[62:63], v23 offset:2560
    v_mfma_f32_32x32x16_bf16 v[96:111], v[76:79], v[44:47], v[96:111]
    s_add_u32 m0, s41, 24576
    s_nop 0
    buffer_load_dwordx4 v18, s[16:19], s37 offen lds
    s_add_u32 m0, s41, 32768
    s_nop 0
    buffer_load_dwordx4 v19, s[16:19], s37 offen lds
    s_add_u32 s37, s37, 128
    s_add_u32 m0, s41, 40960
    s_nop 0
    buffer_load_dwordx4 v16, s[20:23], s36 offen lds
    s_add_u32 s36, s36, 114688
    s_waitcnt vmcnt(12) lgkmcnt(0)
    s_barrier
    v_add_u32 v20, 73728, v14
    v_add_u32 v21, 73728, v15
    v_add_u32 v22, 73728, v12
    v_add_u32 v23, 73728, v13
    ds_read_b128 v[40:43], v20 offset:0
    ds_read_b64_tr_b16 v[64:65], v22 offset:0
    ds_read_b64_tr_b16 v[66:67], v22 offset:512
    v_mfma_f32_32x32x16_bf16 v[80:95], v[48:51], v[32:35], v[80:95]
    ds_read_b64_tr_b16 v[68:69], v23 offset:0
    ds_read_b64_tr_b16 v[70:71], v23 offset:512
    v_mfma_f32_32x32x16_bf16 v[96:111], v[52:55], v[32:35], v[96:111]
    ds_read_b128 v[44:47], v21 offset:0
    ds_read_b64_tr_b16 v[72:73], v22 offset:2048
    ds_read_b64_tr_b16 v[74:75], v22 offset:2560
    v_mfma_f32_32x32x16_bf16 v[80:95], v[56:59], v[36:39], v[80:95]
    ds_read_b64_tr_b16 v[76:77], v23 offset:2048
    ds_read_b64_tr_b16 v[78:79], v23 offset:2560
    v_mfma_f32_32x32x16_bf16 v[96:111], v[60:63], v[36:39], v[96:111]
    s_waitcnt vmcnt(9) lgkmcnt(0)
    s_barrier
    v_add_u32 v20, 98304, v14
    v_add_u32 v21, 98304, v15
    v_add_u32 v22, 98304, v12
    v_add_u32 v23, 98304, v13
    ds_read_b128 v[32:35], v20 offset:0
    ds_read_b64_tr_b16 v[48:49], v22 offset:0
    ds_read_b64_tr_b16 v[50:51], v22 offset:512
    v_mfma_f32_32x32x16_bf16 v[80:95], v[64:67], v[40:43], v[80:95]
    ds_read_b64_tr_b16 v[52:53], v23 offset:0
    ds_read_b64_tr_b16 v[54:55], v23 offset:512
    v_mfma_f32_32x32x16_bf16 v[96:111], v[68:71], v[40:43], v[96:111]
    ds_read_b128 v[36:39], v21 offset:0
    ds_read_b64_tr_b16 v[56:57], v22 offset:2048
    ds_read_b64_tr_b16 v[58:59], v22 offset:2560
    v_mfma_f32_32x32x16_bf16 v[80:95], v[72:75], v[44:47], v[80:95]
    ds_read_b64_tr_b16 v[60:61], v23 offset:2048
    ds_read_b64_tr_b16 v[62:63], v23 offset:2560
    v_mfma_f32_32x32x16_bf16 v[96:111], v[76:79], v[44:47], v[96:111]
    s_waitcnt vmcnt(6) lgkmcnt(0)
    s_barrier
    v_add_u32 v20, 122880, v14
    v_add_u32 v21, 122880, v15
    v_add_u32 v22, 122880, v12
    v_add_u32 v23, 122880, v13
    ds_read_b128 v[40:43], v20 offset:0
    ds_read_b64_tr_b16 v[64:65], v22 offset:0
    ds_read_b64_tr_b16 v[66:67], v22 offset:512
    v_mfma_f32_32x32x16_bf16 v[80:95], v[48:51], v[32:35], v[80:95]
    ds_read_b64_tr_b16 v[68:69], v23 offset:0
    ds_read_b64_tr_b16 v[70:71], v23 offset:512
    v_mfma_f32_32x32x16_bf16 v[96:111], v[52:55], v[32:35], v[96:111]
    ds_read_b128 v[44:47], v21 offset:0
    ds_read_b64_tr_b16 v[72:73], v22 offset:2048
    ds_read_b64_tr_b16 v[74:75], v22 offset:2560
    v_mfma_f32_32x32x16_bf16 v[80:95], v[56:59], v[36:39], v[80:95]
    ds_read_b64_tr_b16 v[76:77], v23 offset:2048
    ds_read_b64_tr_b16 v[78:79], v23 offset:2560
    v_mfma_f32_32x32x16_bf16 v[96:111], v[60:63], v[36:39], v[96:111]
    s_waitcnt vmcnt(3) lgkmcnt(0)
    s_barrier
    ds_read_b128 v[32:35], v14 offset:0
    ds_read_b64_tr_b16 v[48:49], v12 offset:0
    ds_read_b64_tr_b16 v[50:51], v12 offset:512
    v_mfma_f32_32x32x16_bf16 v[80:95], v[64:67], v[40:43], v[80:95]
    ds_read_b64_tr_b16 v[52:53], v13 offset:0
    ds_read_b64_tr_b16 v[54:55], v13 offset:512
    v_mfma_f32_32x32x16_bf16 v[96:111], v[68:71], v[40:43], v[96:111]
    ds_read_b128 v[36:39], v15 offset:0
    ds_read_b64_tr_b16 v[56:57], v12 offset:2048
    ds_read_b64_tr_b16 v[58:59], v12 offset:2560
    v_mfma_f32_32x32x16_bf16 v[80:95], v[72:75], v[44:47], v[80:95]
    ds_read_b64_tr_b16 v[60:61], v13 offset:2048
    ds_read_b64_tr_b16 v[62:63], v13 offset:2560
    v_mfma_f32_32x32x16_bf16 v[96:111], v[76:79], v[44:47], v[96:111]
    s_waitcnt vmcnt(0) lgkmcnt(0)
    s_barrier
    ds_read_b128 v[40:43], v14 offset:24576
    ds_read_b64_tr_b16 v[64:65], v12 offset:24576
    ds_read_b64_tr_b16 v[66:67], v12 offset:25088
    v_mfma_f32_32x32x16_bf16 v[80:95], v[48:51], v[32:35], v[80:95]
    ds_read_b64_tr_b16 v[68:69], v13 offset:24576
    ds_read_b64_tr_b16 v[70:71], v13 offset:25088
    v_mfma_f32_32x32x16_bf16 v[96:111], v[52:55], v[32:35], v[96:111]
    ds_read_b128 v[44:47], v15 offset:24576
    ds_read_b64_tr_b16 v[72:73], v12 offset:26624
    ds_read_b64_tr_b16 v[74:75], v12 offset:27136
    v_mfma_f32_32x32x16_bf16 v[80:95], v[56:59], v[36:39], v[80:95]
    ds_read_b64_tr_b16 v[76:77], v13 offset:26624
    ds_read_b64_tr_b16 v[78:79], v13 offset:27136
    v_mfma_f32_32x32x16_bf16 v[96:111], v[60:63], v[36:39], v[96:111]
    s_waitcnt lgkmcnt(0)
    v_mfma_f32_32x32x16_bf16 v[80:95], v[64:67], v[40:43], v[80:95]
    v_mfma_f32_32x32x16_bf16 v[96:111], v[68:71], v[40:43], v[96:111]
    v_mfma_f32_32x32x16_bf16 v[80:95], v[72:75], v[44:47], v[80:95]
    v_mfma_f32_32x32x16_bf16 v[96:111], v[76:79], v[44:47], v[96:111]
    s_waitcnt vmcnt(0)
    s_barrier
    s_add_u32 s24, s10, 18874368
    s_addc_u32 s25, s11, 0
    s_mov_b32 s26, 3670016
    s_mov_b32 s27, 0x00020000
    s_add_u32 s28, s10, 27262976
    s_addc_u32 s29, s11, 0
    s_mov_b32 s30, 3670016
    s_mov_b32 s31, 0x00020000
    s_mov_b32 s32, s8
    s_mov_b32 s33, s9
    s_mov_b32 s34, 4096
    s_mov_b32 s35, 0x00020000
    s_lshl_b32 s14, s39, 2
    s_add_u32 s44, s14, s46
    s_lshl_b32 s14, s44, 5
    v_add_u32 v4, s14, v2
    v_lshlrev_b32 v6, 1, v4
    buffer_load_ushort v24, v6, s[32:35], 0 offen
    s_mul_i32 s14, s44, 57344
    s_lshl_b32 s15, s38, 12
    s_add_u32 s14, s14, s15
    s_lshl_b32 s15, s47, 11
    s_add_u32 s14, s14, s15
    v_lshlrev_b32 v5, 3, v1
    buffer_load_dwordx2 v[48:49], v5, s[24:27], s14 offen offset:0
    buffer_load_dwordx2 v[50:51], v5, s[24:27], s14 offen offset:512
    buffer_load_dwordx2 v[52:53], v5, s[24:27], s14 offen offset:1024
    buffer_load_dwordx2 v[54:55], v5, s[24:27], s14 offen offset:1536
    s_lshl_b32 s15, s3, 12
    v_add_u32 v6, s15, v9
    s_xor_b32 s15, s3, 4
    s_lshl_b32 s15, s15, 12
    v_add_u32 v8, s15, v9
    s_nop 7
    s_cmp_eq_u32 s47, 0
    s_cbranch_scc1 L_g2_kh0
    ds_write_b128 v6, v[80:83] offset:0
    ds_write_b128 v6, v[84:87] offset:1024
    ds_write_b128 v6, v[88:91] offset:2048
    ds_write_b128 v6, v[92:95] offset:3072
    v_mov_b32 v80, v96
    v_mov_b32 v81, v97
    v_mov_b32 v82, v98
    v_mov_b32 v83, v99
    v_mov_b32 v84, v100
    v_mov_b32 v85, v101
    v_mov_b32 v86, v102
    v_mov_b32 v87, v103
    v_mov_b32 v88, v104
    v_mov_b32 v89, v105
    v_mov_b32 v90, v106
    v_mov_b32 v91, v107
    v_mov_b32 v92, v108
    v_mov_b32 v93, v109
    v_mov_b32 v94, v110
    v_mov_b32 v95, v111
    s_branch L_g2_join
L_g2_kh0:
    ds_write_b128 v6, v[96:99] offset:0
    ds_write_b128 v6, v[100:103] offset:1024
    ds_write_b128 v6, v[104:107] offset:2048
    ds_write_b128 v6, v[108:111] offset:3072
L_g2_join:
    s_waitcnt lgkmcnt(0)
    s_barrier
    ds_read_b128 v[96:99], v8 offset:0
    ds_read_b128 v[100:103], v8 offset:1024
    ds_read_b128 v[104:107], v8 offset:2048
    ds_read_b128 v[108:111], v8 offset:3072
    s_waitcnt vmcnt(0) lgkmcnt(0)
    v_lshlrev_b32 v7, 16, v24
    v_add_f32 v80, v80, v96
    v_cvt_pk_bf16_f32 v80, v80, v80
    v_and_b32 v80, 0xffff0000, v80
    v_add_f32 v80, v80, v7
    v_cvt_pk_bf16_f32 v80, v80, v80
    v_and_b32 v80, 0xffff0000, v80
    v_lshlrev_b32 v112, 16, v48
    v_mul_f32 v80, v80, v112
    v_add_f32 v81, v81, v97
    v_cvt_pk_bf16_f32 v81, v81, v81
    v_and_b32 v81, 0xffff0000, v81
    v_add_f32 v81, v81, v7
    v_cvt_pk_bf16_f32 v81, v81, v81
    v_and_b32 v81, 0xffff0000, v81
    v_and_b32 v112, 0xffff0000, v48
    v_mul_f32 v81, v81, v112
    v_add_f32 v82, v82, v98
    v_cvt_pk_bf16_f32 v82, v82, v82
    v_and_b32 v82, 0xffff0000, v82
    v_add_f32 v82, v82, v7
    v_cvt_pk_bf16_f32 v82, v82, v82
    v_and_b32 v82, 0xffff0000, v82
    v_lshlrev_b32 v112, 16, v49
    v_mul_f32 v82, v82, v112
    v_add_f32 v83, v83, v99
    v_cvt_pk_bf16_f32 v83, v83, v83
    v_and_b32 v83, 0xffff0000, v83
    v_add_f32 v83, v83, v7
    v_cvt_pk_bf16_f32 v83, v83, v83
    v_and_b32 v83, 0xffff0000, v83
    v_and_b32 v112, 0xffff0000, v49
    v_mul_f32 v83, v83, v112
    v_cvt_pk_bf16_f32 v32, v80, v81
    v_cvt_pk_bf16_f32 v33, v82, v83
    v_add_f32 v84, v84, v100
    v_cvt_pk_bf16_f32 v84, v84, v84
    v_and_b32 v84, 0xffff0000, v84
    v_add_f32 v84, v84, v7
    v_cvt_pk_bf16_f32 v84, v84, v84
    v_and_b32 v84, 0xffff0000, v84
    v_lshlrev_b32 v112, 16, v50
    v_mul_f32 v84, v84, v112
    v_add_f32 v85, v85, v101
    v_cvt_pk_bf16_f32 v85, v85, v85
    v_and_b32 v85, 0xffff0000, v85
    v_add_f32 v85, v85, v7
    v_cvt_pk_bf16_f32 v85, v85, v85
    v_and_b32 v85, 0xffff0000, v85
    v_and_b32 v112, 0xffff0000, v50
    v_mul_f32 v85, v85, v112
    v_add_f32 v86, v86, v102
    v_cvt_pk_bf16_f32 v86, v86, v86
    v_and_b32 v86, 0xffff0000, v86
    v_add_f32 v86, v86, v7
    v_cvt_pk_bf16_f32 v86, v86, v86
    v_and_b32 v86, 0xffff0000, v86
    v_lshlrev_b32 v112, 16, v51
    v_mul_f32 v86, v86, v112
    v_add_f32 v87, v87, v103
    v_cvt_pk_bf16_f32 v87, v87, v87
    v_and_b32 v87, 0xffff0000, v87
    v_add_f32 v87, v87, v7
    v_cvt_pk_bf16_f32 v87, v87, v87
    v_and_b32 v87, 0xffff0000, v87
    v_and_b32 v112, 0xffff0000, v51
    v_mul_f32 v87, v87, v112
    v_cvt_pk_bf16_f32 v34, v84, v85
    v_cvt_pk_bf16_f32 v35, v86, v87
    v_add_f32 v88, v88, v104
    v_cvt_pk_bf16_f32 v88, v88, v88
    v_and_b32 v88, 0xffff0000, v88
    v_add_f32 v88, v88, v7
    v_cvt_pk_bf16_f32 v88, v88, v88
    v_and_b32 v88, 0xffff0000, v88
    v_lshlrev_b32 v112, 16, v52
    v_mul_f32 v88, v88, v112
    v_add_f32 v89, v89, v105
    v_cvt_pk_bf16_f32 v89, v89, v89
    v_and_b32 v89, 0xffff0000, v89
    v_add_f32 v89, v89, v7
    v_cvt_pk_bf16_f32 v89, v89, v89
    v_and_b32 v89, 0xffff0000, v89
    v_and_b32 v112, 0xffff0000, v52
    v_mul_f32 v89, v89, v112
    v_add_f32 v90, v90, v106
    v_cvt_pk_bf16_f32 v90, v90, v90
    v_and_b32 v90, 0xffff0000, v90
    v_add_f32 v90, v90, v7
    v_cvt_pk_bf16_f32 v90, v90, v90
    v_and_b32 v90, 0xffff0000, v90
    v_lshlrev_b32 v112, 16, v53
    v_mul_f32 v90, v90, v112
    v_add_f32 v91, v91, v107
    v_cvt_pk_bf16_f32 v91, v91, v91
    v_and_b32 v91, 0xffff0000, v91
    v_add_f32 v91, v91, v7
    v_cvt_pk_bf16_f32 v91, v91, v91
    v_and_b32 v91, 0xffff0000, v91
    v_and_b32 v112, 0xffff0000, v53
    v_mul_f32 v91, v91, v112
    v_cvt_pk_bf16_f32 v36, v88, v89
    v_cvt_pk_bf16_f32 v37, v90, v91
    v_add_f32 v92, v92, v108
    v_cvt_pk_bf16_f32 v92, v92, v92
    v_and_b32 v92, 0xffff0000, v92
    v_add_f32 v92, v92, v7
    v_cvt_pk_bf16_f32 v92, v92, v92
    v_and_b32 v92, 0xffff0000, v92
    v_lshlrev_b32 v112, 16, v54
    v_mul_f32 v92, v92, v112
    v_add_f32 v93, v93, v109
    v_cvt_pk_bf16_f32 v93, v93, v93
    v_and_b32 v93, 0xffff0000, v93
    v_add_f32 v93, v93, v7
    v_cvt_pk_bf16_f32 v93, v93, v93
    v_and_b32 v93, 0xffff0000, v93
    v_and_b32 v112, 0xffff0000, v54
    v_mul_f32 v93, v93, v112
    v_add_f32 v94, v94, v110
    v_cvt_pk_bf16_f32 v94, v94, v94
    v_and_b32 v94, 0xffff0000, v94
    v_add_f32 v94, v94, v7
    v_cvt_pk_bf16_f32 v94, v94, v94
    v_and_b32 v94, 0xffff0000, v94
    v_lshlrev_b32 v112, 16, v55
    v_mul_f32 v94, v94, v112
    v_add_f32 v95, v95, v111
    v_cvt_pk_bf16_f32 v95, v95, v95
    v_and_b32 v95, 0xffff0000, v95
    v_add_f32 v95, v95, v7
    v_cvt_pk_bf16_f32 v95, v95, v95
    v_and_b32 v95, 0xffff0000, v95
    v_and_b32 v112, 0xffff0000, v55
    v_mul_f32 v95, v95, v112
    v_cvt_pk_bf16_f32 v38, v92, v93
    v_cvt_pk_bf16_f32 v39, v94, v95
    s_nop 1
    v_permlane32_swap_b32 v32, v34
    v_permlane32_swap_b32 v33, v35
    v_permlane32_swap_b32 v36, v38
    v_permlane32_swap_b32 v37, v39
    s_nop 1
    buffer_store_dwordx4 v[32:35], v9, s[28:31], s14 offen
    buffer_store_dwordx4 v[36:39], v9, s[28:31], s14 offen offset:1024
L_g2_done:
    s_endpgm
.globl fin_kernel
.p2align 8
.type fin_kernel,@function
fin_kernel:
    s_cmp_ge_u32 s2, 224
    s_cbranch_scc1 L_fin_done
    s_load_dwordx2 s[10:11], s[0:1], 96
    s_load_dwordx2 s[4:5], s[0:1], 32
    s_load_dwordx2 s[6:7], s[0:1], 72
    s_load_dwordx2 s[8:9], s[0:1], 0
    s_load_dwordx2 s[50:51], s[0:1], 80
    s_and_b32 s14, s2, 7
    s_lshr_b32 s15, s2, 3
    s_mov_b32 s12, 613566757
    s_mul_hi_u32 s39, s15, s12
    s_mul_i32 s12, s39, 7
    s_sub_u32 s38, s15, s12
    s_mul_i32 s14, s14, 4
    s_add_u32 s39, s39, s14
    v_and_b32 v1, 63, v0
    v_and_b32 v2, 31, v0
    v_bfe_u32 v3, v0, 5, 1
    v_lshlrev_b32 v9, 4, v1
    v_lshrrev_b32 v5, 6, v0
    s_nop 0
    v_readfirstlane_b32 s3, v5
    s_nop 3
    s_lshl_b32 s41, s3, 10
    s_and_b32 s46, s3, 1
    s_lshr_b32 s47, s3, 1
    s_lshl_b32 s14, s47, 12
    v_bfe_u32 v5, v1, 2, 2
    v_and_b32 v6, 3, v1
    v_bfe_u32 v7, v1, 4, 1
    v_lshlrev_b32 v8, 3, v6
    v_lshl_add_u32 v8, v7, 5, v8
    v_lshl_add_u32 v6, v3, 3, v5
    v_mul_u32_u24 v6, 128, v6
    v_add_u32 v8, v8, v6
    v_lshrrev_b32 v5, 1, v5
    v_xor_b32 v7, 0, v5
    v_lshl_add_u32 v12, v7, 6, v8
    v_xor_b32 v7, 1, v5
    v_lshl_add_u32 v13, v7, 6, v8
    v_add_u32 v12, s14, v12
    v_add_u32 v16, 0x10000, v12
    v_add_u32 v13, s14, v13
    v_add_u32 v17, 0x10000, v13
    v_lshrrev_b32 v5, 3, v1
    v_and_b32 v6, 7, v1
    s_mul_i32 s14, s3, 8
    v_add_u32 v5, s14, v5
    v_add_u32 v7, 0, v5
    v_bfe_u32 v8, v7, 1, 1
    v_lshlrev_b32 v8, 2, v8
    v_xor_b32 v8, v8, v6
    s_mov_b32 s14, 896
    v_mul_lo_u32 v7, v7, s14
    v_lshl_add_u32 v14, v8, 4, v7
    v_add_u32 v7, 64, v5
    v_bfe_u32 v8, v7, 1, 1
    v_lshlrev_b32 v8, 2, v8
    v_xor_b32 v8, v8, v6
    s_mov_b32 s14, 896
    v_mul_lo_u32 v7, v7, s14
    v_lshl_add_u32 v15, v8, 4, v7
    s_lshl_b32 s14, s39, 1
    s_add_u32 s44, s14, s46
    s_waitcnt lgkmcnt(0)
    s_add_u32 s16, s10, 27262976
    s_addc_u32 s17, s11, 0
    s_mov_b32 s18, 3670016
    s_mov_b32 s19, 0x00020000
    s_mov_b32 s20, s6
    s_mov_b32 s21, s7
    s_mov_b32 s22, 802816
    s_mov_b32 s23, 0x00020000
    s_add_u32 s24, s10, 2097152
    s_addc_u32 s25, s11, 0
    s_mov_b32 s26, 16777216
    s_mov_b32 s27, 0x00020000
    s_mov_b32 s28, s4
    s_mov_b32 s29, s5
    s_mov_b32 s30, 3670016
    s_mov_b32 s31, 0x00020000
    s_lshl_b32 s14, s47, 11
    s_mul_i32 s37, s44, 57344
    s_add_u32 s37, s37, s14
    s_lshl_b32 s52, s44, 18
    s_add_u32 s52, s52, s14
    s_lshl_b32 s36, s38, 7
    s_lshl_b32 s53, s38, 7
    buffer_load_dwordx4 v[24:27], v9, s[16:19], s37 offen offset:0
    buffer_load_dwordx4 v[28:31], v9, s[16:19], s37 offen offset:1024
    s_add_u32 s37, s37, 8192
    s_add_u32 m0, s41, 0
    s_nop 0
    buffer_load_dwordx4 v14, s[20:23], s36 offen lds
    s_add_u32 m0, s41, 8192
    s_nop 0
    buffer_load_dwordx4 v15, s[20:23], s36 offen lds
    s_add_u32 s36, s36, 114688
    buffer_load_dwordx4 v[32:35], v9, s[16:19], s37 offen offset:0
    buffer_load_dwordx4 v[36:39], v9, s[16:19], s37 offen offset:1024
    s_add_u32 s37, s37, 8192
    s_add_u32 m0, s41, 16384
    s_nop 0
    buffer_load_dwordx4 v14, s[20:23], s36 offen lds
    s_add_u32 m0, s41, 24576
    s_nop 0
    buffer_load_dwordx4 v15, s[20:23], s36 offen lds
    s_add_u32 s36, s36, 114688
    buffer_load_dwordx4 v[40:43], v9, s[16:19], s37 offen offset:0
    buffer_load_dwordx4 v[44:47], v9, s[16:19], s37 offen offset:1024
    s_add_u32 s37, s37, 8192
    s_add_u32 m0, s41, 32768
    s_nop 0
    buffer_load_dwordx4 v14, s[20:23], s36 offen lds
    s_add_u32 m0, s41, 40960
    s_nop 0
    buffer_load_dwordx4 v15, s[20:23], s36 offen lds
    s_add_u32 s36, s36, 114688
    buffer_load_dwordx4 v[48:51], v9, s[16:19], s37 offen offset:0
    buffer_load_dwordx4 v[52:55], v9, s[16:19], s37 offen offset:1024
    s_add_u32 s37, s37, 8192
    s_add_u32 m0, s41, 49152
    s_nop 0
    buffer_load_dwordx4 v14, s[20:23], s36 offen lds
    s_add_u32 m0, s41, 57344
    s_nop 0
    buffer_load_dwordx4 v15, s[20:23], s36 offen lds
    s_add_u32 s36, s36, 114688
    buffer_load_dwordx4 v[56:59], v9, s[16:19], s37 offen offset:0
    buffer_load_dwordx4 v[60:63], v9, s[16:19], s37 offen offset:1024
    s_add_u32 s37, s37, 8192
    s_add_u32 m0, s41, 65536
    s_nop 0
    buffer_load_dwordx4 v14, s[20:23], s36 offen lds
    s_add_u32 m0, s41, 73728
    s_nop 0
    buffer_load_dwordx4 v15, s[20:23], s36 offen lds
    s_add_u32 s36, s36, 114688
    s_waitcnt vmcnt(16) lgkmcnt(0)
    s_barrier
    ds_read_b64_tr_b16 v[72:73], v12 offset:0
    ds_read_b64_tr_b16 v[74:75], v12 offset:512
    ds_read_b64_tr_b16 v[76:77], v13 offset:0
    ds_read_b64_tr_b16 v[78:79], v13 offset:512
    ds_read_b64_tr_b16 v[80:81], v12 offset:2048
    ds_read_b64_tr_b16 v[82:83], v12 offset:2560
    ds_read_b64_tr_b16 v[84:85], v13 offset:2048
    ds_read_b64_tr_b16 v[86:87], v13 offset:2560
    buffer_load_dwordx4 v[64:67], v9, s[16:19], s37 offen offset:0
    buffer_load_dwordx4 v[68:71], v9, s[16:19], s37 offen offset:1024
    s_add_u32 s37, s37, 8192
    s_add_u32 m0, s41, 81920
    s_nop 0
    buffer_load_dwordx4 v14, s[20:23], s36 offen lds
    s_add_u32 m0, s41, 90112
    s_nop 0
    buffer_load_dwordx4 v15, s[20:23], s36 offen lds
    s_add_u32 s36, s36, 114688
    s_waitcnt vmcnt(16) lgkmcnt(0)
    s_barrier
    ds_read_b64_tr_b16 v[88:89], v12 offset:16384
    ds_read_b64_tr_b16 v[90:91], v12 offset:16896
    v_mfma_f32_32x32x16_bf16 v[136:151], v[72:75], v[24:27], 0
    ds_read_b64_tr_b16 v[92:93], v13 offset:16384
    ds_read_b64_tr_b16 v[94:95], v13 offset:16896
    v_mfma_f32_32x32x16_bf16 v[152:167], v[76:79], v[24:27], 0
    ds_read_b64_tr_b16 v[96:97], v12 offset:18432
    ds_read_b64_tr_b16 v[98:99], v12 offset:18944
    v_mfma_f32_32x32x16_bf16 v[136:151], v[80:83], v[28:31], v[136:151]
    ds_read_b64_tr_b16 v[100:101], v13 offset:18432
    ds_read_b64_tr_b16 v[102:103], v13 offset:18944
    v_mfma_f32_32x32x16_bf16 v[152:167], v[84:87], v[28:31], v[152:167]
    buffer_load_dwordx4 v[24:27], v9, s[16:19], s37 offen offset:0
    buffer_load_dwordx4 v[28:31], v9, s[16:19], s37 offen offset:1024
    s_add_u32 s37, s37, 8192
    s_add_u32 m0, s41, 0
    s_nop 0
    buffer_load_dwordx4 v14, s[20:23], s36 offen lds
    s_add_u32 m0, s41, 8192
    s_nop 0
    buffer_load_dwordx4 v15, s[20:23], s36 offen lds
    s_add_u32 s36, s36, 114688
    s_waitcnt vmcnt(16) lgkmcnt(0)
    s_barrier
    ds_read_b64_tr_b16 v[72:73], v12 offset:32768
    ds_read_b64_tr_b16 v[74:75], v12 offset:33280
    v_mfma_f32_32x32x16_bf16 v[136:151], v[88:91], v[32:35], v[136:151]
    ds_read_b64_tr_b16 v[76:77], v13 offset:32768
    ds_read_b64_tr_b16 v[78:79], v13 offset:33280
    v_mfma_f32_32x32x16_bf16 v[152:167], v[92:95], v[32:35], v[152:167]
    ds_read_b64_tr_b16 v[80:81], v12 offset:34816
    ds_read_b64_tr_b16 v[82:83], v12 offset:35328
    v_mfma_f32_32x32x16_bf16 v[136:151], v[96:99], v[36:39], v[136:151]
    ds_read_b64_tr_b16 v[84:85], v13 offset:34816
    ds_read_b64_tr_b16 v[86:87], v13 offset:35328
    v_mfma_f32_32x32x16_bf16 v[152:167], v[100:103], v[36:39], v[152:167]
    buffer_load_dwordx4 v[32:35], v9, s[24:27], s52 offen offset:0
    buffer_load_dwordx4 v[36:39], v9, s[24:27], s52 offen offset:1024
    s_add_u32 s52, s52, 8192
    s_add_u32 m0, s41, 16384
    s_nop 0
    buffer_load_dwordx4 v14, s[28:31], s53 offen lds
    s_add_u32 m0, s41, 24576
    s_nop 0
    buffer_load_dwordx4 v15, s[28:31], s53 offen lds
    s_add_u32 s53, s53, 114688
    s_waitcnt vmcnt(16) lgkmcnt(0)
    s_barrier
    ds_read_b64_tr_b16 v[88:89], v12 offset:49152
    ds_read_b64_tr_b16 v[90:91], v12 offset:49664
    v_mfma_f32_32x32x16_bf16 v[136:151], v[72:75], v[40:43], v[136:151]
    ds_read_b64_tr_b16 v[92:93], v13 offset:49152
    ds_read_b64_tr_b16 v[94:95], v13 offset:49664
    v_mfma_f32_32x32x16_bf16 v[152:167], v[76:79], v[40:43], v[152:167]
    ds_read_b64_tr_b16 v[96:97], v12 offset:51200
    ds_read_b64_tr_b16 v[98:99], v12 offset:51712
    v_mfma_f32_32x32x16_bf16 v[136:151], v[80:83], v[44:47], v[136:151]
    ds_read_b64_tr_b16 v[100:101], v13 offset:51200
    ds_read_b64_tr_b16 v[102:103], v13 offset:51712
    v_mfma_f32_32x32x16_bf16 v[152:167], v[84:87], v[44:47], v[152:167]
    buffer_load_dwordx4 v[40:43], v9, s[24:27], s52 offen offset:0
    buffer_load_dwordx4 v[44:47], v9, s[24:27], s52 offen offset:1024
    s_add_u32 s52, s52, 8192
    s_add_u32 m0, s41, 32768
    s_nop 0
    buffer_load_dwordx4 v14, s[28:31], s53 offen lds
    s_add_u32 m0, s41, 40960
    s_nop 0
    buffer_load_dwordx4 v15, s[28:31], s53 offen lds
    s_add_u32 s53, s53, 114688
    s_waitcnt vmcnt(16) lgkmcnt(0)
    s_barrier
    ds_read_b64_tr_b16 v[72:73], v16 offset:0
    ds_read_b64_tr_b16 v[74:75], v16 offset:512
    v_mfma_f32_32x32x16_bf16 v[136:151], v[88:91], v[48:51], v[136:151]
    ds_read_b64_tr_b16 v[76:77], v17 offset:0
    ds_read_b64_tr_b16 v[78:79], v17 offset:512
    v_mfma_f32_32x32x16_bf16 v[152:167], v[92:95], v[48:51], v[152:167]
    ds_read_b64_tr_b16 v[80:81], v16 offset:2048
    ds_read_b64_tr_b16 v[82:83], v16 offset:2560
    v_mfma_f32_32x32x16_bf16 v[136:151], v[96:99], v[52:55], v[136:151]
    ds_read_b64_tr_b16 v[84:85], v17 offset:2048
    ds_read_b64_tr_b16 v[86:87], v17 offset:2560
    v_mfma_f32_32x32x16_bf16 v[152:167], v[100:103], v[52:55], v[152:167]
    buffer_load_dwordx4 v[48:51], v9, s[24:27], s52 offen offset:0
    buffer_load_dwordx4 v[52:55], v9, s[24:27], s52 offen offset:1024
    s_add_u32 s52, s52, 8192
    s_add_u32 m0, s41, 49152
    s_nop 0
    buffer_load_dwordx4 v14, s[28:31], s53 offen lds
    s_add_u32 m0, s41, 57344
    s_nop 0
    buffer_load_dwordx4 v15, s[28:31], s53 offen lds
    s_add_u32 s53, s53, 114688
    s_waitcnt vmcnt(16) lgkmcnt(0)
    s_barrier
    ds_read_b64_tr_b16 v[88:89], v16 offset:16384
    ds_read_b64_tr_b16 v[90:91], v16 offset:16896
    v_mfma_f32_32x32x16_bf16 v[136:151], v[72:75], v[56:59], v[136:151]
    ds_read_b64_tr_b16 v[92:93], v17 offset:16384
    ds_read_b64_tr_b16 v[94:95], v17 offset:16896
    v_mfma_f32_32x32x16_bf16 v[152:167], v[76:79], v[56:59], v[152:167]
    ds_read_b64_tr_b16 v[96:97], v16 offset:18432
    ds_read_b64_tr_b16 v[98:99], v16 offset:18944
    v_mfma_f32_32x32x16_bf16 v[136:151], v[80:83], v[60:63], v[136:151]
    ds_read_b64_tr_b16 v[100:101], v17 offset:18432
    ds_read_b64_tr_b16 v[102:103], v17 offset:18944
    v_mfma_f32_32x32x16_bf16 v[152:167], v[84:87], v[60:63], v[152:167]
    buffer_load_dwordx4 v[56:59], v9, s[24:27], s52 offen offset:0
    buffer_load_dwordx4 v[60:63], v9, s[24:27], s52 offen offset:1024
    s_add_u32 s52, s52, 8192
    s_add_u32 m0, s41, 65536
    s_nop 0
    buffer_load_dwordx4 v14, s[28:31], s53 offen lds
    s_add_u32 m0, s41, 73728
    s_nop 0
    buffer_load_dwordx4 v15, s[28:31], s53 offen lds
    s_add_u32 s53, s53, 114688
    s_waitcnt vmcnt(16) lgkmcnt(0)
    s_barrier
    ds_read_b64_tr_b16 v[72:73], v12 offset:0
    ds_read_b64_tr_b16 v[74:75], v12 offset:512
    v_mfma_f32_32x32x16_bf16 v[136:151], v[88:91], v[64:67], v[136:151]
    ds_read_b64_tr_b16 v[76:77], v13 offset:0
    ds_read_b64_tr_b16 v[78:79], v13 offset:512
    v_mfma_f32_32x32x16_bf16 v[152:167], v[92:95], v[64:67], v[152:167]
    ds_read_b64_tr_b16 v[80:81], v12 offset:2048
    ds_read_b64_tr_b16 v[82:83], v12 offset:2560
    v_mfma_f32_32x32x16_bf16 v[136:151], v[96:99], v[68:71], v[136:151]
    ds_read_b64_tr_b16 v[84:85], v13 offset:2048
    ds_read_b64_tr_b16 v[86:87], v13 offset:2560
    v_mfma_f32_32x32x16_bf16 v[152:167], v[100:103], v[68:71], v[152:167]
    buffer_load_dwordx4 v[64:67], v9, s[24:27], s52 offen offset:0
    buffer_load_dwordx4 v[68:71], v9, s[24:27], s52 offen offset:1024
    s_add_u32 s52, s52, 8192
    s_add_u32 m0, s41, 81920
    s_nop 0
    buffer_load_dwordx4 v14, s[28:31], s53 offen lds
    s_add_u32 m0, s41, 90112
    s_nop 0
    buffer_load_dwordx4 v15, s[28:31], s53 offen lds
    s_add_u32 s53, s53, 114688
    s_waitcnt vmcnt(16) lgkmcnt(0)
    s_barrier
    ds_read_b64_tr_b16 v[88:89], v12 offset:16384
    ds_read_b64_tr_b16 v[90:91], v12 offset:16896
    v_mfma_f32_32x32x16_bf16 v[136:151], v[72:75], v[24:27], v[136:151]
    ds_read_b64_tr_b16 v[92:93], v13 offset:16384
    ds_read_b64_tr_b16 v[94:95], v13 offset:16896
    v_mfma_f32_32x32x16_bf16 v[152:167], v[76:79], v[24:27], v[152:167]
    ds_read_b64_tr_b16 v[96:97], v12 offset:18432
    ds_read_b64_tr_b16 v[98:99], v12 offset:18944
    v_mfma_f32_32x32x16_bf16 v[136:151], v[80:83], v[28:31], v[136:151]
    ds_read_b64_tr_b16 v[100:101], v13 offset:18432
    ds_read_b64_tr_b16 v[102:103], v13 offset:18944
    v_mfma_f32_32x32x16_bf16 v[152:167], v[84:87], v[28:31], v[152:167]
    buffer_load_dwordx4 v[24:27], v9, s[24:27], s52 offen offset:0
    buffer_load_dwordx4 v[28:31], v9, s[24:27], s52 offen offset:1024
    s_add_u32 s52, s52, 8192
    s_add_u32 m0, s41, 0
    s_nop 0
    buffer_load_dwordx4 v14, s[28:31], s53 offen lds
    s_add_u32 m0, s41, 8192
    s_nop 0
    buffer_load_dwordx4 v15, s[28:31], s53 offen lds
    s_add_u32 s53, s53, 114688
    s_waitcnt vmcnt(16) lgkmcnt(0)
    s_barrier
    ds_read_b64_tr_b16 v[72:73], v12 offset:32768
    ds_read_b64_tr_b16 v[74:75], v12 offset:33280
    v_mfma_f32_32x32x16_bf16 v[104:119], v[88:91], v[32:35], 0
    ds_read_b64_tr_b16 v[76:77], v13 offset:32768
    ds_read_b64_tr_b16 v[78:79], v13 offset:33280
    v_mfma_f32_32x32x16_bf16 v[120:135], v[92:95], v[32:35], 0
    ds_read_b64_tr_b16 v[80:81], v12 offset:34816
    ds_read_b64_tr_b16 v[82:83], v12 offset:35328
    v_mfma_f32_32x32x16_bf16 v[104:119], v[96:99], v[36:39], v[104:119]
    ds_read_b64_tr_b16 v[84:85], v13 offset:34816
    ds_read_b64_tr_b16 v[86:87], v13 offset:35328
    v_mfma_f32_32x32x16_bf16 v[120:135], v[100:103], v[36:39], v[120:135]
    buffer_load_dwordx4 v[32:35], v9, s[24:27], s52 offen offset:0
    buffer_load_dwordx4 v[36:39], v9, s[24:27], s52 offen offset:1024
    s_add_u32 s52, s52, 8192
    s_add_u32 m0, s41, 16384
    s_nop 0
    buffer_load_dwordx4 v14, s[28:31], s53 offen lds
    s_add_u32 m0, s41, 24576
    s_nop 0
    buffer_load_dwordx4 v15, s[28:31], s53 offen lds
    s_add_u32 s53, s53, 114688
    s_mov_b32 s40, 4
L_fin_loop:
    s_waitcnt vmcnt(16) lgkmcnt(0)
    s_barrier
    ds_read_b64_tr_b16 v[88:89], v12 offset:49152
    ds_read_b64_tr_b16 v[90:91], v12 offset:49664
    v_mfma_f32_32x32x16_bf16 v[104:119], v[72:75], v[40:43], v[104:119]
    ds_read_b64_tr_b16 v[92:93], v13 offset:49152
    ds_read_b64_tr_b16 v[94:95], v13 offset:49664
    v_mfma_f32_32x32x16_bf16 v[120:135], v[76:79], v[40:43], v[120:135]
    ds_read_b64_tr_b16 v[96:97], v12 offset:51200
    ds_read_b64_tr_b16 v[98:99], v12 offset:51712
    v_mfma_f32_32x32x16_bf16 v[104:119], v[80:83], v[44:47], v[104:119]
    ds_read_b64_tr_b16 v[100:101], v13 offset:51200
    ds_read_b64_tr_b16 v[102:103], v13 offset:51712
    v_mfma_f32_32x32x16_bf16 v[120:135], v[84:87], v[44:47], v[120:135]
    buffer_load_dwordx4 v[40:43], v9, s[24:27], s52 offen offset:0
    buffer_load_dwordx4 v[44:47], v9, s[24:27], s52 offen offset:1024
    s_add_u32 s52, s52, 8192
    s_add_u32 m0, s41, 32768
    s_nop 0
    buffer_load_dwordx4 v14, s[28:31], s53 offen lds
    s_add_u32 m0, s41, 40960
    s_nop 0
    buffer_load_dwordx4 v15, s[28:31], s53 offen lds
    s_add_u32 s53, s53, 114688
    s_waitcnt vmcnt(16) lgkmcnt(0)
    s_barrier
    ds_read_b64_tr_b16 v[72:73], v16 offset:0
    ds_read_b64_tr_b16 v[74:75], v16 offset:512
    v_mfma_f32_32x32x16_bf16 v[104:119], v[88:91], v[48:51], v[104:119]
    ds_read_b64_tr_b16 v[76:77], v17 offset:0
    ds_read_b64_tr_b16 v[78:79], v17 offset:512
    v_mfma_f32_32x32x16_bf16 v[120:135], v[92:95], v[48:51], v[120:135]
    ds_read_b64_tr_b16 v[80:81], v16 offset:2048
    ds_read_b64_tr_b16 v[82:83], v16 offset:2560
    v_mfma_f32_32x32x16_bf16 v[104:119], v[96:99], v[52:55], v[104:119]
    ds_read_b64_tr_b16 v[84:85], v17 offset:2048
    ds_read_b64_tr_b16 v[86:87], v17 offset:2560
    v_mfma_f32_32x32x16_bf16 v[120:135], v[100:103], v[52:55], v[120:135]
    buffer_load_dwordx4 v[48:51], v9, s[24:27], s52 offen offset:0
    buffer_load_dwordx4 v[52:55], v9, s[24:27], s52 offen offset:1024
    s_add_u32 s52, s52, 8192
    s_add_u32 m0, s41, 49152
    s_nop 0
    buffer_load_dwordx4 v14, s[28:31], s53 offen lds
    s_add_u32 m0, s41, 57344
    s_nop 0
    buffer_load_dwordx4 v15, s[28:31], s53 offen lds
    s_add_u32 s53, s53, 114688
    s_waitcnt vmcnt(16) lgkmcnt(0)
    s_barrier
    ds_read_b64_tr_b16 v[88:89], v16 offset:16384
    ds_read_b64_tr_b16 v[90:91], v16 offset:16896
    v_mfma_f32_32x32x16_bf16 v[104:119], v[72:75], v[56:59], v[104:119]
    ds_read_b64_tr_b16 v[92:93], v17 offset:16384
    ds_read_b64_tr_b16 v[94:95], v17 offset:16896
    v_mfma_f32_32x32x16_bf16 v[120:135], v[76:79], v[56:59], v[120:135]
    ds_read_b64_tr_b16 v[96:97], v16 offset:18432
    ds_read_b64_tr_b16 v[98:99], v16 offset:18944
    v_mfma_f32_32x32x16_bf16 v[104:119], v[80:83], v[60:63], v[104:119]
    ds_read_b64_tr_b16 v[100:101], v17 offset:18432
    ds_read_b64_tr_b16 v[102:103], v17 offset:18944
    v_mfma_f32_32x32x16_bf16 v[120:135], v[84:87], v[60:63], v[120:135]
    buffer_load_dwordx4 v[56:59], v9, s[24:27], s52 offen offset:0
    buffer_load_dwordx4 v[60:63], v9, s[24:27], s52 offen offset:1024
    s_add_u32 s52, s52, 8192
    s_add_u32 m0, s41, 65536
    s_nop 0
    buffer_load_dwordx4 v14, s[28:31], s53 offen lds
    s_add_u32 m0, s41, 73728
    s_nop 0
    buffer_load_dwordx4 v15, s[28:31], s53 offen lds
    s_add_u32 s53, s53, 114688
    s_waitcnt vmcnt(16) lgkmcnt(0)
    s_barrier
    ds_read_b64_tr_b16 v[72:73], v12 offset:0
    ds_read_b64_tr_b16 v[74:75], v12 offset:512
    v_mfma_f32_32x32x16_bf16 v[104:119], v[88:91], v[64:67], v[104:119]
    ds_read_b64_tr_b16 v[76:77], v13 offset:0
    ds_read_b64_tr_b16 v[78:79], v13 offset:512
    v_mfma_f32_32x32x16_bf16 v[120:135], v[92:95], v[64:67], v[120:135]
    ds_read_b64_tr_b16 v[80:81], v12 offset:2048
    ds_read_b64_tr_b16 v[82:83], v12 offset:2560
    v_mfma_f32_32x32x16_bf16 v[104:119], v[96:99], v[68:71], v[104:119]
    ds_read_b64_tr_b16 v[84:85], v13 offset:2048
    ds_read_b64_tr_b16 v[86:87], v13 offset:2560
    v_mfma_f32_32x32x16_bf16 v[120:135], v[100:103], v[68:71], v[120:135]
    buffer_load_dwordx4 v[64:67], v9, s[24:27], s52 offen offset:0
    buffer_load_dwordx4 v[68:71], v9, s[24:27], s52 offen offset:1024
    s_add_u32 s52, s52, 8192
    s_add_u32 m0, s41, 81920
    s_nop 0
    buffer_load_dwordx4 v14, s[28:31], s53 offen lds
    s_add_u32 m0, s41, 90112
    s_nop 0
    buffer_load_dwordx4 v15, s[28:31], s53 offen lds
    s_add_u32 s53, s53, 114688
    s_waitcnt vmcnt(16) lgkmcnt(0)
    s_barrier
    ds_read_b64_tr_b16 v[88:89], v12 offset:16384
    ds_read_b64_tr_b16 v[90:91], v12 offset:16896
    v_mfma_f32_32x32x16_bf16 v[104:119], v[72:75], v[24:27], v[104:119]
    ds_read_b64_tr_b16 v[92:93], v13 offset:16384
    ds_read_b64_tr_b16 v[94:95], v13 offset:16896
    v_mfma_f32_32x32x16_bf16 v[120:135], v[76:79], v[24:27], v[120:135]
    ds_read_b64_tr_b16 v[96:97], v12 offset:18432
    ds_read_b64_tr_b16 v[98:99], v12 offset:18944
    v_mfma_f32_32x32x16_bf16 v[104:119], v[80:83], v[28:31], v[104:119]
    ds_read_b64_tr_b16 v[100:101], v13 offset:18432
    ds_read_b64_tr_b16 v[102:103], v13 offset:18944
    v_mfma_f32_32x32x16_bf16 v[120:135], v[84:87], v[28:31], v[120:135]
    buffer_load_dwordx4 v[24:27], v9, s[24:27], s52 offen offset:0
    buffer_load_dwordx4 v[28:31], v9, s[24:27], s52 offen offset:1024
    s_add_u32 s52, s52, 8192
    s_add_u32 m0, s41, 0
    s_nop 0
    buffer_load_dwordx4 v14, s[28:31], s53 offen lds
    s_add_u32 m0, s41, 8192
    s_nop 0
    buffer_load_dwordx4 v15, s[28:31], s53 offen lds
    s_add_u32 s53, s53, 114688
    s_waitcnt vmcnt(16) lgkmcnt(0)
    s_barrier
    ds_read_b64_tr_b16 v[72:73], v12 offset:32768
    ds_read_b64_tr_b16 v[74:75], v12 offset:33280
    v_mfma_f32_32x32x16_bf16 v[104:119], v[88:91], v[32:35], v[104:119]
    ds_read_b64_tr_b16 v[76:77], v13 offset:32768
    ds_read_b64_tr_b16 v[78:79], v13 offset:33280
    v_mfma_f32_32x32x16_bf16 v[120:135], v[92:95], v[32:35], v[120:135]
    ds_read_b64_tr_b16 v[80:81], v12 offset:34816
    ds_read_b64_tr_b16 v[82:83], v12 offset:35328
    v_mfma_f32_32x32x16_bf16 v[104:119], v[96:99], v[36:39], v[104:119]
    ds_read_b64_tr_b16 v[84:85], v13 offset:34816
    ds_read_b64_tr_b16 v[86:87], v13 offset:35328
    v_mfma_f32_32x32x16_bf16 v[120:135], v[100:103], v[36:39], v[120:135]
    buffer_load_dwordx4 v[32:35], v9, s[24:27], s52 offen offset:0
    buffer_load_dwordx4 v[36:39], v9, s[24:27], s52 offen offset:1024
    s_add_u32 s52, s52, 8192
    s_add_u32 m0, s41, 16384
    s_nop 0
    buffer_load_dwordx4 v14, s[28:31], s53 offen lds
    s_add_u32 m0, s41, 24576
    s_nop 0
    buffer_load_dwordx4 v15, s[28:31], s53 offen lds
    s_add_u32 s53, s53, 114688
    s_sub_u32 s40, s40, 1
    s_cmp_lg_u32 s40, 0
    s_cbranch_scc1 L_fin_loop
    s_waitcnt vmcnt(16) lgkmcnt(0)
    s_barrier
    ds_read_b64_tr_b16 v[88:89], v12 offset:49152
    ds_read_b64_tr_b16 v[90:91], v12 offset:49664
    v_mfma_f32_32x32x16_bf16 v[104:119], v[72:75], v[40:43], v[104:119]
    ds_read_b64_tr_b16 v[92:93], v13 offset:49152
    ds_read_b64_tr_b16 v[94:95], v13 offset:49664
    v_mfma_f32_32x32x16_bf16 v[120:135], v[76:79], v[40:43], v[120:135]
    ds_read_b64_tr_b16 v[96:97], v12 offset:51200
    ds_read_b64_tr_b16 v[98:99], v12 offset:51712
    v_mfma_f32_32x32x16_bf16 v[104:119], v[80:83], v[44:47], v[104:119]
    ds_read_b64_tr_b16 v[100:101], v13 offset:51200
    ds_read_b64_tr_b16 v[102:103], v13 offset:51712
    v_mfma_f32_32x32x16_bf16 v[120:135], v[84:87], v[44:47], v[120:135]
    buffer_load_dwordx4 v[40:43], v9, s[24:27], s52 offen offset:0
    buffer_load_dwordx4 v[44:47], v9, s[24:27], s52 offen offset:1024
    s_add_u32 s52, s52, 8192
    s_add_u32 m0, s41, 32768
    s_nop 0
    buffer_load_dwordx4 v14, s[28:31], s53 offen lds
    s_add_u32 m0, s41, 40960
    s_nop 0
    buffer_load_dwordx4 v15, s[28:31], s53 offen lds
    s_add_u32 s53, s53, 114688
    s_waitcnt vmcnt(16) lgkmcnt(0)
    s_barrier
    ds_read_b64_tr_b16 v[72:73], v16 offset:0
    ds_read_b64_tr_b16 v[74:75], v16 offset:512
    v_mfma_f32_32x32x16_bf16 v[104:119], v[88:91], v[48:51], v[104:119]
    ds_read_b64_tr_b16 v[76:77], v17 offset:0
    ds_read_b64_tr_b16 v[78:79], v17 offset:512
    v_mfma_f32_32x32x16_bf16 v[120:135], v[92:95], v[48:51], v[120:135]
    ds_read_b64_tr_b16 v[80:81], v16 offset:2048
    ds_read_b64_tr_b16 v[82:83], v16 offset:2560
    v_mfma_f32_32x32x16_bf16 v[104:119], v[96:99], v[52:55], v[104:119]
    ds_read_b64_tr_b16 v[84:85], v17 offset:2048
    ds_read_b64_tr_b16 v[86:87], v17 offset:2560
    v_mfma_f32_32x32x16_bf16 v[120:135], v[100:103], v[52:55], v[120:135]
    s_waitcnt vmcnt(12) lgkmcnt(0)
    s_barrier
    ds_read_b64_tr_b16 v[88:89], v16 offset:16384
    ds_read_b64_tr_b16 v[90:91], v16 offset:16896
    v_mfma_f32_32x32x16_bf16 v[104:119], v[72:75], v[56:59], v[104:119]
    ds_read_b64_tr_b16 v[92:93], v17 offset:16384
    ds_read_b64_tr_b16 v[94:95], v17 offset:16896
    v_mfma_f32_32x32x16_bf16 v[120:135], v[76:79], v[56:59], v[120:135]
    ds_read_b64_tr_b16 v[96:97], v16 offset:18432
    ds_read_b64_tr_b16 v[98:99], v16 offset:18944
    v_mfma_f32_32x32x16_bf16 v[104:119], v[80:83], v[60:63], v[104:119]
    ds_read_b64_tr_b16 v[100:101], v17 offset:18432
    ds_read_b64_tr_b16 v[102:103], v17 offset:18944
    v_mfma_f32_32x32x16_bf16 v[120:135], v[84:87], v[60:63], v[120:135]
    s_waitcnt vmcnt(8) lgkmcnt(0)
    s_barrier
    ds_read_b64_tr_b16 v[72:73], v12 offset:0
    ds_read_b64_tr_b16 v[74:75], v12 offset:512
    v_mfma_f32_32x32x16_bf16 v[104:119], v[88:91], v[64:67], v[104:119]
    ds_read_b64_tr_b16 v[76:77], v13 offset:0
    ds_read_b64_tr_b16 v[78:79], v13 offset:512
    v_mfma_f32_32x32x16_bf16 v[120:135], v[92:95], v[64:67], v[120:135]
    ds_read_b64_tr_b16 v[80:81], v12 offset:2048
    ds_read_b64_tr_b16 v[82:83], v12 offset:2560
    v_mfma_f32_32x32x16_bf16 v[104:119], v[96:99], v[68:71], v[104:119]
    ds_read_b64_tr_b16 v[84:85], v13 offset:2048
    ds_read_b64_tr_b16 v[86:87], v13 offset:2560
    v_mfma_f32_32x32x16_bf16 v[120:135], v[100:103], v[68:71], v[120:135]
    s_waitcnt vmcnt(4) lgkmcnt(0)
    s_barrier
    ds_read_b64_tr_b16 v[88:89], v12 offset:16384
    ds_read_b64_tr_b16 v[90:91], v12 offset:16896
    v_mfma_f32_32x32x16_bf16 v[104:119], v[72:75], v[24:27], v[104:119]
    ds_read_b64_tr_b16 v[92:93], v13 offset:16384
    ds_read_b64_tr_b16 v[94:95], v13 offset:16896
    v_mfma_f32_32x32x16_bf16 v[120:135], v[76:79], v[24:27], v[120:135]
    ds_read_b64_tr_b16 v[96:97], v12 offset:18432
    ds_read_b64_tr_b16 v[98:99], v12 offset:18944
    v_mfma_f32_32x32x16_bf16 v[104:119], v[80:83], v[28:31], v[104:119]
    ds_read_b64_tr_b16 v[100:101], v13 offset:18432
    ds_read_b64_tr_b16 v[102:103], v13 offset:18944
    v_mfma_f32_32x32x16_bf16 v[120:135], v[84:87], v[28:31], v[120:135]
    s_waitcnt vmcnt(0) lgkmcnt(0)
    s_barrier
    ds_read_b64_tr_b16 v[72:73], v12 offset:32768
    ds_read_b64_tr_b16 v[74:75], v12 offset:33280
    v_mfma_f32_32x32x16_bf16 v[104:119], v[88:91], v[32:35], v[104:119]
    ds_read_b64_tr_b16 v[76:77], v13 offset:32768
    ds_read_b64_tr_b16 v[78:79], v13 offset:33280
    v_mfma_f32_32x32x16_bf16 v[120:135], v[92:95], v[32:35], v[120:135]
    ds_read_b64_tr_b16 v[80:81], v12 offset:34816
    ds_read_b64_tr_b16 v[82:83], v12 offset:35328
    v_mfma_f32_32x32x16_bf16 v[104:119], v[96:99], v[36:39], v[104:119]
    ds_read_b64_tr_b16 v[84:85], v13 offset:34816
    ds_read_b64_tr_b16 v[86:87], v13 offset:35328
    v_mfma_f32_32x32x16_bf16 v[120:135], v[100:103], v[36:39], v[120:135]
    s_waitcnt lgkmcnt(0)
    v_mfma_f32_32x32x16_bf16 v[104:119], v[72:75], v[40:43], v[104:119]
    v_mfma_f32_32x32x16_bf16 v[120:135], v[76:79], v[40:43], v[120:135]
    v_mfma_f32_32x32x16_bf16 v[104:119], v[80:83], v[44:47], v[104:119]
    v_mfma_f32_32x32x16_bf16 v[120:135], v[84:87], v[44:47], v[120:135]
    s_waitcnt vmcnt(0)
    s_barrier
    s_mov_b32 s24, s8
    s_mov_b32 s25, s9
    s_mov_b32 s26, 1835008
    s_mov_b32 s27, 0x00020000
    s_mov_b32 s28, s50
    s_mov_b32 s29, s51
    s_mov_b32 s30, 1835008
    s_mov_b32 s31, 0x00020000
    s_lshl_b32 s14, s44, 5
    v_add_u32 v4, s14, v2
    s_and_b32 s14, s47, 1
    s_lshl_b32 s14, s14, 6
    s_lshr_b32 s15, s47, 1
    s_lshl_b32 s15, s15, 5
    s_add_u32 s14, s14, s15
    s_lshl_b32 s15, s38, 7
    s_add_u32 s14, s14, s15
    v_mul_u32_u24 v5, 896, v4
    v_add_u32 v5, s14, v5
    v_lshl_add_u32 v5, v3, 3, v5
    buffer_load_dwordx2 v[72:73], v5, s[24:27], 0 offen offset:0
    buffer_load_dwordx2 v[74:75], v5, s[24:27], 0 offen offset:16
    s_lshl_b32 s14, s3, 14
    v_add_u32 v6, s14, v9
    ds_write_b128 v6, v[104:107] offset:0
    ds_write_b128 v6, v[108:111] offset:1024
    ds_write_b128 v6, v[112:115] offset:2048
    ds_write_b128 v6, v[116:119] offset:3072
    ds_write_b128 v6, v[120:123] offset:4096
    ds_write_b128 v6, v[124:127] offset:5120
    ds_write_b128 v6, v[128:131] offset:6144
    ds_write_b128 v6, v[132:135] offset:7168
    ds_write_b128 v6, v[136:139] offset:8192
    ds_write_b128 v6, v[140:143] offset:9216
    ds_write_b128 v6, v[144:147] offset:10240
    ds_write_b128 v6, v[148:151] offset:11264
    ds_write_b128 v6, v[152:155] offset:12288
    ds_write_b128 v6, v[156:159] offset:13312
    ds_write_b128 v6, v[160:163] offset:14336
    ds_write_b128 v6, v[164:167] offset:15360
    s_lshl_b32 s14, s46, 14
    s_and_b32 s15, s47, 1
    s_lshl_b32 s15, s15, 12
    s_add_u32 s14, s14, s15
    s_lshr_b32 s15, s47, 1
    s_lshl_b32 s15, s15, 11
    s_add_u32 s14, s14, s15
    v_add_u32 v6, s14, v9
    v_add_u32 v7, 0x10000, v6
    s_waitcnt lgkmcnt(0)
    s_barrier
    ds_read_b128 v[104:107], v6 offset:0
    ds_read_b128 v[108:111], v6 offset:1024
    ds_read_b128 v[112:115], v6 offset:32768
    ds_read_b128 v[116:119], v6 offset:33792
    ds_read_b128 v[120:123], v7 offset:0
    ds_read_b128 v[124:127], v7 offset:1024
    ds_read_b128 v[128:131], v7 offset:32768
    ds_read_b128 v[132:135], v7 offset:33792
    ds_read_b128 v[136:139], v6 offset:8192
    ds_read_b128 v[140:143], v6 offset:9216
    ds_read_b128 v[144:147], v6 offset:40960
    ds_read_b128 v[148:151], v6 offset:41984
    ds_read_b128 v[152:155], v7 offset:8192
    ds_read_b128 v[156:159], v7 offset:9216
    ds_read_b128 v[160:163], v7 offset:40960
    ds_read_b128 v[164:167], v7 offset:41984
    s_waitcnt vmcnt(0) lgkmcnt(0)
    v_add_f32 v104, v104, v112
    v_add_f32 v120, v120, v128
    v_add_f32 v104, v104, v120
    v_add_f32 v105, v105, v113
    v_add_f32 v121, v121, v129
    v_add_f32 v105, v105, v121
    v_add_f32 v106, v106, v114
    v_add_f32 v122, v122, v130
    v_add_f32 v106, v106, v122
    v_add_f32 v107, v107, v115
    v_add_f32 v123, v123, v131
    v_add_f32 v107, v107, v123
    v_add_f32 v108, v108, v116
    v_add_f32 v124, v124, v132
    v_add_f32 v108, v108, v124
    v_add_f32 v109, v109, v117
    v_add_f32 v125, v125, v133
    v_add_f32 v109, v109, v125
    v_add_f32 v110, v110, v118
    v_add_f32 v126, v126, v134
    v_add_f32 v110, v110, v126
    v_add_f32 v111, v111, v119
    v_add_f32 v127, v127, v135
    v_add_f32 v111, v111, v127
    v_add_f32 v136, v136, v144
    v_add_f32 v152, v152, v160
    v_add_f32 v136, v136, v152
    v_add_f32 v137, v137, v145
    v_add_f32 v153, v153, v161
    v_add_f32 v137, v137, v153
    v_add_f32 v138, v138, v146
    v_add_f32 v154, v154, v162
    v_add_f32 v138, v138, v154
    v_add_f32 v139, v139, v147
    v_add_f32 v155, v155, v163
    v_add_f32 v139, v139, v155
    v_add_f32 v140, v140, v148
    v_add_f32 v156, v156, v164
    v_add_f32 v140, v140, v156
    v_add_f32 v141, v141, v149
    v_add_f32 v157, v157, v165
    v_add_f32 v141, v141, v157
    v_add_f32 v142, v142, v150
    v_add_f32 v158, v158, v166
    v_add_f32 v142, v142, v158
    v_add_f32 v143, v143, v151
    v_add_f32 v159, v159, v167
    v_add_f32 v143, v143, v159
    v_cvt_pk_bf16_f32 v104, v104, v104
    v_and_b32 v104, 0xffff0000, v104
    v_cvt_pk_bf16_f32 v136, v136, v136
    v_and_b32 v136, 0xffff0000, v136
    v_mul_f32 v168, 0xbfb8aa3b, v136
    v_exp_f32 v168, v168
    s_nop 0
    v_add_f32 v168, 1.0, v168
    v_rcp_f32 v168, v168
    s_nop 0
    v_mul_f32 v136, v136, v168
    v_cvt_pk_bf16_f32 v136, v136, v136
    v_and_b32 v136, 0xffff0000, v136
    v_mul_f32 v104, v104, v136
    v_cvt_pk_bf16_f32 v104, v104, v104
    v_and_b32 v104, 0xffff0000, v104
    v_lshlrev_b32 v168, 16, v72
    v_add_f32 v104, v104, v168
    v_cvt_pk_bf16_f32 v105, v105, v105
    v_and_b32 v105, 0xffff0000, v105
    v_cvt_pk_bf16_f32 v137, v137, v137
    v_and_b32 v137, 0xffff0000, v137
    v_mul_f32 v168, 0xbfb8aa3b, v137
    v_exp_f32 v168, v168
    s_nop 0
    v_add_f32 v168, 1.0, v168
    v_rcp_f32 v168, v168
    s_nop 0
    v_mul_f32 v137, v137, v168
    v_cvt_pk_bf16_f32 v137, v137, v137
    v_and_b32 v137, 0xffff0000, v137
    v_mul_f32 v105, v105, v137
    v_cvt_pk_bf16_f32 v105, v105, v105
    v_and_b32 v105, 0xffff0000, v105
    v_and_b32 v168, 0xffff0000, v72
    v_add_f32 v105, v105, v168
    v_cvt_pk_bf16_f32 v106, v106, v106
    v_and_b32 v106, 0xffff0000, v106
    v_cvt_pk_bf16_f32 v138, v138, v138
    v_and_b32 v138, 0xffff0000, v138
    v_mul_f32 v168, 0xbfb8aa3b, v138
    v_exp_f32 v168, v168
    s_nop 0
    v_add_f32 v168, 1.0, v168
    v_rcp_f32 v168, v168
    s_nop 0
    v_mul_f32 v138, v138, v168
    v_cvt_pk_bf16_f32 v138, v138, v138
    v_and_b32 v138, 0xffff0000, v138
    v_mul_f32 v106, v106, v138
    v_cvt_pk_bf16_f32 v106, v106, v106
    v_and_b32 v106, 0xffff0000, v106
    v_lshlrev_b32 v168, 16, v73
    v_add_f32 v106, v106, v168
    v_cvt_pk_bf16_f32 v107, v107, v107
    v_and_b32 v107, 0xffff0000, v107
    v_cvt_pk_bf16_f32 v139, v139, v139
    v_and_b32 v139, 0xffff0000, v139
    v_mul_f32 v168, 0xbfb8aa3b, v139
    v_exp_f32 v168, v168
    s_nop 0
    v_add_f32 v168, 1.0, v168
    v_rcp_f32 v168, v168
    s_nop 0
    v_mul_f32 v139, v139, v168
    v_cvt_pk_bf16_f32 v139, v139, v139
    v_and_b32 v139, 0xffff0000, v139
    v_mul_f32 v107, v107, v139
    v_cvt_pk_bf16_f32 v107, v107, v107
    v_and_b32 v107, 0xffff0000, v107
    v_and_b32 v168, 0xffff0000, v73
    v_add_f32 v107, v107, v168
    v_cvt_pk_bf16_f32 v170, v104, v105
    v_cvt_pk_bf16_f32 v171, v106, v107
    buffer_store_dwordx2 v[170:171], v5, s[28:31], 0 offen offset:0
    s_nop 1
    v_cvt_pk_bf16_f32 v108, v108, v108
    v_and_b32 v108, 0xffff0000, v108
    v_cvt_pk_bf16_f32 v140, v140, v140
    v_and_b32 v140, 0xffff0000, v140
    v_mul_f32 v168, 0xbfb8aa3b, v140
    v_exp_f32 v168, v168
    s_nop 0
    v_add_f32 v168, 1.0, v168
    v_rcp_f32 v168, v168
    s_nop 0
    v_mul_f32 v140, v140, v168
    v_cvt_pk_bf16_f32 v140, v140, v140
    v_and_b32 v140, 0xffff0000, v140
    v_mul_f32 v108, v108, v140
    v_cvt_pk_bf16_f32 v108, v108, v108
    v_and_b32 v108, 0xffff0000, v108
    v_lshlrev_b32 v168, 16, v74
    v_add_f32 v108, v108, v168
    v_cvt_pk_bf16_f32 v109, v109, v109
    v_and_b32 v109, 0xffff0000, v109
    v_cvt_pk_bf16_f32 v141, v141, v141
    v_and_b32 v141, 0xffff0000, v141
    v_mul_f32 v168, 0xbfb8aa3b, v141
    v_exp_f32 v168, v168
    s_nop 0
    v_add_f32 v168, 1.0, v168
    v_rcp_f32 v168, v168
    s_nop 0
    v_mul_f32 v141, v141, v168
    v_cvt_pk_bf16_f32 v141, v141, v141
    v_and_b32 v141, 0xffff0000, v141
    v_mul_f32 v109, v109, v141
    v_cvt_pk_bf16_f32 v109, v109, v109
    v_and_b32 v109, 0xffff0000, v109
    v_and_b32 v168, 0xffff0000, v74
    v_add_f32 v109, v109, v168
    v_cvt_pk_bf16_f32 v110, v110, v110
    v_and_b32 v110, 0xffff0000, v110
    v_cvt_pk_bf16_f32 v142, v142, v142
    v_and_b32 v142, 0xffff0000, v142
    v_mul_f32 v168, 0xbfb8aa3b, v142
    v_exp_f32 v168, v168
    s_nop 0
    v_add_f32 v168, 1.0, v168
    v_rcp_f32 v168, v168
    s_nop 0
    v_mul_f32 v142, v142, v168
    v_cvt_pk_bf16_f32 v142, v142, v142
    v_and_b32 v142, 0xffff0000, v142
    v_mul_f32 v110, v110, v142
    v_cvt_pk_bf16_f32 v110, v110, v110
    v_and_b32 v110, 0xffff0000, v110
    v_lshlrev_b32 v168, 16, v75
    v_add_f32 v110, v110, v168
    v_cvt_pk_bf16_f32 v111, v111, v111
    v_and_b32 v111, 0xffff0000, v111
    v_cvt_pk_bf16_f32 v143, v143, v143
    v_and_b32 v143, 0xffff0000, v143
    v_mul_f32 v168, 0xbfb8aa3b, v143
    v_exp_f32 v168, v168
    s_nop 0
    v_add_f32 v168, 1.0, v168
    v_rcp_f32 v168, v168
    s_nop 0
    v_mul_f32 v143, v143, v168
    v_cvt_pk_bf16_f32 v143, v143, v143
    v_and_b32 v143, 0xffff0000, v143
    v_mul_f32 v111, v111, v143
    v_cvt_pk_bf16_f32 v111, v111, v111
    v_and_b32 v111, 0xffff0000, v111
    v_and_b32 v168, 0xffff0000, v75
    v_add_f32 v111, v111, v168
    v_cvt_pk_bf16_f32 v170, v108, v109
    v_cvt_pk_bf16_f32 v171, v110, v111
    buffer_store_dwordx2 v[170:171], v5, s[28:31], 0 offen offset:16
    s_nop 1
L_fin_done:
    s_endpgm
L_text_end:
    s_endpgm
.section .rodata,"a"
.p2align 6
.amdhsa_kernel ln_kernel
  .amdhsa_next_free_vgpr 32
  .amdhsa_next_free_sgpr 32
  .amdhsa_accum_offset 32
  .amdhsa_group_segment_fixed_size 0
  .amdhsa_kernarg_size 104
  .amdhsa_user_sgpr_count 2
  .amdhsa_user_sgpr_kernarg_segment_ptr 1
  .amdhsa_system_sgpr_workgroup_id_x 1
.end_amdhsa_kernel
.p2align 6
.amdhsa_kernel front_kernel
  .amdhsa_next_free_vgpr 512
  .amdhsa_next_free_sgpr 96
  .amdhsa_accum_offset 256
  .amdhsa_group_segment_fixed_size 0
  .amdhsa_kernarg_size 104
  .amdhsa_user_sgpr_count 2
  .amdhsa_user_sgpr_kernarg_segment_ptr 1
  .amdhsa_system_sgpr_workgroup_id_x 1
.end_amdhsa_kernel
.p2align 6
.amdhsa_kernel ln2_kernel
  .amdhsa_next_free_vgpr 40
  .amdhsa_next_free_sgpr 32
  .amdhsa_accum_offset 40
  .amdhsa_group_segment_fixed_size 0
  .amdhsa_kernarg_size 104
  .amdhsa_user_sgpr_count 2
  .amdhsa_user_sgpr_kernarg_segment_ptr 1
  .amdhsa_system_sgpr_workgroup_id_x 1
.end_amdhsa_kernel
.p2align 6
.amdhsa_kernel g2_kernel
  .amdhsa_next_free_vgpr 128
  .amdhsa_next_free_sgpr 64
  .amdhsa_accum_offset 128
  .amdhsa_group_segment_fixed_size 0
  .amdhsa_kernarg_size 104
  .amdhsa_user_sgpr_count 2
  .amdhsa_user_sgpr_kernarg_segment_ptr 1
  .amdhsa_system_sgpr_workgroup_id_x 1
.end_amdhsa_kernel
.p2align 6
.amdhsa_kernel fin_kernel
  .amdhsa_next_free_vgpr 176
  .amdhsa_next_free_sgpr 64
  .amdhsa_accum_offset 176
  .amdhsa_group_segment_fixed_size 0
  .amdhsa_kernarg_size 104
  .amdhsa_user_sgpr_count 2
  .amdhsa_user_sgpr_kernarg_segment_ptr 1
  .amdhsa_system_sgpr_workgroup_id_x 1
.end_amdhsa_kernel
```
